```python
import torch

def _softmax(x, axis=-1):
    return torch.softmax(x, dim=axis)
def _gelu(x):
    return torch.nn.functional.gelu(x, approximate="tanh")
def _silu(x):
    return torch.nn.functional.silu(x)
def _sigmoid(x):
    return torch.sigmoid(x)
def _layernorm(x, axis=-1, eps=1e-5):
    m = x.mean(dim=axis, keepdim=True)
    v = x.var(dim=axis, keepdim=True, unbiased=False)
    return (x - m) / torch.sqrt(v + eps)
def _scatter_add(tgt, idx, src, axis=0):
    return tgt.clone().index_add_(axis, idx, src)
def _segment_sum(src, seg, n):
    out = torch.zeros((n,) + src.shape[1:], dtype=src.dtype)
    return out.index_add_(0, seg, src)
def _pad(x, pw):
    flat = tuple(v for pair in reversed(pw) for v in pair)
    return torch.nn.functional.pad(x, flat)

kernel_name = 'recurrent_scan__mha_block_cached__dense_activation_relu__prompt'

def setup_inputs():

    _w = (lambda a: (lambda t: t.to(torch.bfloat16) if t.is_floating_point() else t)(torch.as_tensor(a)))
    def _A_setup():
        B, Sq, D = 1, 2048, 512
        H, Sk, Dh = 32, 2048, 128
        return {
            "x": _w((lambda *s: torch.randn(*s, dtype=torch.bfloat16) * 0.05)(B, Sq, D)),
            "k_cache": _w((lambda *s: torch.randn(*s, dtype=torch.bfloat16) * 1.6)(B, H, Sk, Dh)),
            "v_cache": _w((lambda *s: torch.randn(*s, dtype=torch.bfloat16) * 0.2)(B, H, Sk, Dh)),
            "wq": _w((lambda *s: torch.randn(*s, dtype=torch.bfloat16) * 1.6)(D, H * Dh) * (D ** -0.5)),
            "wo": _w((lambda *s: torch.randn(*s, dtype=torch.bfloat16) * 0.2)(H * Dh, D) * ((H * Dh) ** -0.5)),
        }
    _A_in = _A_setup()

    def _B_setup():
        B, S, D, Dff = 1, 2048, 512, 1792
        return {
            "x": _w((lambda *s: torch.randn(*s, dtype=torch.bfloat16) * 0.05)(B, S, D)),
            "w1": _w((lambda *s: torch.randn(*s, dtype=torch.bfloat16) * 0.1)(D, Dff)),
            "w2": _w((lambda *s: torch.randn(*s, dtype=torch.bfloat16) * 0.1)(Dff, D)),
        }
    _B_in = _B_setup()

    return {
        "A_x": _A_in["x"],
        "A_k_cache": _A_in["k_cache"],
        "A_v_cache": _A_in["v_cache"],
        "A_wq": _A_in["wq"],
        "A_wo": _A_in["wo"],
        "B_x": _B_in["x"],
        "B_w1": _B_in["w1"],
        "B_w2": _B_in["w2"],
    }

def reference(A_x, A_k_cache, A_v_cache, A_wq, A_wo, B_x, B_w1, B_w2):
    def _A_ref(x, k_cache, v_cache, wq, wo):
        B, Sq, D = x.shape
        H, Dh = 32, 128
        q = (lambda x, *d: x.permute(*d))((x @ wq).reshape(B, Sq, H, Dh), 0, 2, 1, 3)
        scores = torch.einsum("bhqd,bhkd->bhqk", q, k_cache) * (Dh ** -0.5)
        p = _softmax(scores, axis=-1)
        o = torch.einsum("bhqk,bhkd->bhqd", p, v_cache)
        return (lambda x, *d: x.permute(*d))(o, 0, 2, 1, 3).reshape(B, Sq, H * Dh) @ wo

    def _B_ref(x, w1, w2):
        h = torch.einsum("bsd,df->bsf", x, w1)
        zero = torch.zeros_like(h)
        h = torch.maximum(h, zero)
        return torch.einsum("bsf,fd->bsd", h, w2)

    x = A_x
    xn = _layernorm(x, axis=-1)
    s = _A_ref(xn, A_k_cache, A_v_cache, A_wq, A_wo)
    g = _silu(_B_ref(xn, B_w1, B_w2))
    return x + s * g
```

```asm
; @launch grid=(256,1,1) block=(256,1,1) lds=163840
.amdgcn_target "amdgcn-amd-amdhsa--gfx950"
.text
.globl recurrent_scan__mha_block_cached__dense_activation_relu__prompt_kernel
.p2align 8
.type recurrent_scan__mha_block_cached__dense_activation_relu__prompt_kernel,@function
recurrent_scan__mha_block_cached__dense_activation_relu__prompt_kernel:
    s_cmp_ge_u32 s2, 256
    s_cbranch_scc1 attn_end
    s_load_dwordx2 s[64:65], s[0:1], 0
    s_load_dwordx2 s[28:29], s[0:1], 80
    s_load_dwordx4 s[36:39], s[0:1], 8
    s_load_dwordx2 s[56:57], s[0:1], 24
    s_load_dwordx2 s[58:59], s[0:1], 48
    s_and_b32 s33, s2, 7
    s_lshl_b32 s33, s33, 2
    s_lshr_b32 s34, s2, 3
    s_and_b32 s26, s34, 3
    s_add_u32 s33, s33, s26
    s_lshr_b32 s34, s34, 2
    v_lshrrev_b32 v84, 4, v0
    v_and_b32 v85, 15, v0
    v_lshlrev_b32 v86, 10, v84
    v_lshl_add_u32 v86, v85, 6, v86
    v_lshrrev_b32 v87, 7, v0
    s_lshl_b32 s62, s34, 8
    s_lshl_b32 s27, s33, 3
    s_add_u32 s62, s62, s27
    s_lshl_b32 s61, s62, 10
    v_readfirstlane_b32 s27, v87
    s_waitcnt lgkmcnt(0)
    s_add_u32 s64, s64, s61
    s_addc_u32 s65, s65, 0
    s_mov_b32 s66, 8192
    s_mov_b32 s67, 0x20000
    s_lshl_b32 s60, s34, 10
    s_add_u32 s60, s60, 50332544
    s_add_u32 s60, s28, s60
    s_addc_u32 s61, s29, 0
    s_cmp_lg_u32 s27, 0
    s_cbranch_scc1 ln_skip_load
    buffer_load_dwordx4 v[64:67], v86, s[64:67], 0 offen offset:0
    buffer_load_dwordx4 v[68:71], v86, s[64:67], 0 offen offset:16
    buffer_load_dwordx4 v[72:75], v86, s[64:67], 0 offen offset:32
    buffer_load_dwordx4 v[76:79], v86, s[64:67], 0 offen offset:48
    s_load_dword s63, s[60:61], 0
    s_load_dwordx2 s[68:69], s[0:1], 32
    s_load_dwordx2 s[72:73], s[0:1], 56
    s_mov_b32 s12, s28
    s_mov_b32 s13, s29
    s_mov_b32 s14, 2097152
    s_mov_b32 s15, 0x20000
    s_lshr_b32 s27, s62, 4
    s_lshl_b32 s27, s27, 14
    s_and_b32 s61, s62, 15
    v_add_u32 v84, s61, v84
    v_lshlrev_b32 v87, 10, v85
    v_lshl_add_u32 v87, v84, 4, v87
    s_waitcnt vmcnt(0)
    v_lshlrev_b32 v96, 16, v64
    v_and_b32 v97, 0xffff0000, v64
    v_lshlrev_b32 v98, 16, v65
    v_and_b32 v99, 0xffff0000, v65
    v_lshlrev_b32 v100, 16, v66
    v_and_b32 v101, 0xffff0000, v66
    v_lshlrev_b32 v102, 16, v67
    v_and_b32 v103, 0xffff0000, v67
    v_lshlrev_b32 v104, 16, v68
    v_and_b32 v105, 0xffff0000, v68
    v_lshlrev_b32 v106, 16, v69
    v_and_b32 v107, 0xffff0000, v69
    v_lshlrev_b32 v108, 16, v70
    v_and_b32 v109, 0xffff0000, v70
    v_lshlrev_b32 v110, 16, v71
    v_and_b32 v111, 0xffff0000, v71
    v_lshlrev_b32 v112, 16, v72
    v_and_b32 v113, 0xffff0000, v72
    v_lshlrev_b32 v114, 16, v73
    v_and_b32 v115, 0xffff0000, v73
    v_lshlrev_b32 v116, 16, v74
    v_and_b32 v117, 0xffff0000, v74
    v_lshlrev_b32 v118, 16, v75
    v_and_b32 v119, 0xffff0000, v75
    v_lshlrev_b32 v120, 16, v76
    v_and_b32 v121, 0xffff0000, v76
    v_lshlrev_b32 v122, 16, v77
    v_and_b32 v123, 0xffff0000, v77
    v_lshlrev_b32 v124, 16, v78
    v_and_b32 v125, 0xffff0000, v78
    v_lshlrev_b32 v126, 16, v79
    v_and_b32 v127, 0xffff0000, v79
    v_add_f32 v80, v96, v97
    v_add_f32 v81, v98, v99
    v_add_f32 v80, v80, v100
    v_add_f32 v81, v81, v101
    v_add_f32 v80, v80, v102
    v_add_f32 v81, v81, v103
    v_add_f32 v80, v80, v104
    v_add_f32 v81, v81, v105
    v_add_f32 v80, v80, v106
    v_add_f32 v81, v81, v107
    v_add_f32 v80, v80, v108
    v_add_f32 v81, v81, v109
    v_add_f32 v80, v80, v110
    v_add_f32 v81, v81, v111
    v_add_f32 v80, v80, v112
    v_add_f32 v81, v81, v113
    v_add_f32 v80, v80, v114
    v_add_f32 v81, v81, v115
    v_add_f32 v80, v80, v116
    v_add_f32 v81, v81, v117
    v_add_f32 v80, v80, v118
    v_add_f32 v81, v81, v119
    v_add_f32 v80, v80, v120
    v_add_f32 v81, v81, v121
    v_add_f32 v80, v80, v122
    v_add_f32 v81, v81, v123
    v_add_f32 v80, v80, v124
    v_add_f32 v81, v81, v125
    v_add_f32 v80, v80, v126
    v_add_f32 v81, v81, v127
    v_add_f32 v80, v80, v81
    s_nop 1
    v_add_f32_dpp v80, v80, v80 row_ror:8 row_mask:0xf bank_mask:0xf
    s_nop 1
    v_add_f32_dpp v80, v80, v80 row_ror:4 row_mask:0xf bank_mask:0xf
    s_nop 1
    v_add_f32_dpp v80, v80, v80 row_ror:2 row_mask:0xf bank_mask:0xf
    s_nop 1
    v_add_f32_dpp v80, v80, v80 row_ror:1 row_mask:0xf bank_mask:0xf
    v_mul_f32 v80, 0x3b000000, v80
    v_sub_f32 v81, v96, v80
    v_mul_f32 v82, v81, v81
    v_sub_f32 v81, v97, v80
    v_fmac_f32 v82, v81, v81
    v_sub_f32 v81, v98, v80
    v_fmac_f32 v82, v81, v81
    v_sub_f32 v81, v99, v80
    v_fmac_f32 v82, v81, v81
    v_sub_f32 v81, v100, v80
    v_fmac_f32 v82, v81, v81
    v_sub_f32 v81, v101, v80
    v_fmac_f32 v82, v81, v81
    v_sub_f32 v81, v102, v80
    v_fmac_f32 v82, v81, v81
    v_sub_f32 v81, v103, v80
    v_fmac_f32 v82, v81, v81
    v_sub_f32 v81, v104, v80
    v_fmac_f32 v82, v81, v81
    v_sub_f32 v81, v105, v80
    v_fmac_f32 v82, v81, v81
    v_sub_f32 v81, v106, v80
    v_fmac_f32 v82, v81, v81
    v_sub_f32 v81, v107, v80
    v_fmac_f32 v82, v81, v81
    v_sub_f32 v81, v108, v80
    v_fmac_f32 v82, v81, v81
    v_sub_f32 v81, v109, v80
    v_fmac_f32 v82, v81, v81
    v_sub_f32 v81, v110, v80
    v_fmac_f32 v82, v81, v81
    v_sub_f32 v81, v111, v80
    v_fmac_f32 v82, v81, v81
    v_sub_f32 v81, v112, v80
    v_fmac_f32 v82, v81, v81
    v_sub_f32 v81, v113, v80
    v_fmac_f32 v82, v81, v81
    v_sub_f32 v81, v114, v80
    v_fmac_f32 v82, v81, v81
    v_sub_f32 v81, v115, v80
    v_fmac_f32 v82, v81, v81
    v_sub_f32 v81, v116, v80
    v_fmac_f32 v82, v81, v81
    v_sub_f32 v81, v117, v80
    v_fmac_f32 v82, v81, v81
    v_sub_f32 v81, v118, v80
    v_fmac_f32 v82, v81, v81
    v_sub_f32 v81, v119, v80
    v_fmac_f32 v82, v81, v81
    v_sub_f32 v81, v120, v80
    v_fmac_f32 v82, v81, v81
    v_sub_f32 v81, v121, v80
    v_fmac_f32 v82, v81, v81
    v_sub_f32 v81, v122, v80
    v_fmac_f32 v82, v81, v81
    v_sub_f32 v81, v123, v80
    v_fmac_f32 v82, v81, v81
    v_sub_f32 v81, v124, v80
    v_fmac_f32 v82, v81, v81
    v_sub_f32 v81, v125, v80
    v_fmac_f32 v82, v81, v81
    v_sub_f32 v81, v126, v80
    v_fmac_f32 v82, v81, v81
    v_sub_f32 v81, v127, v80
    v_fmac_f32 v82, v81, v81
    s_nop 1
    v_add_f32_dpp v82, v82, v82 row_ror:8 row_mask:0xf bank_mask:0xf
    s_nop 1
    v_add_f32_dpp v82, v82, v82 row_ror:4 row_mask:0xf bank_mask:0xf
    s_nop 1
    v_add_f32_dpp v82, v82, v82 row_ror:2 row_mask:0xf bank_mask:0xf
    s_nop 1
    v_add_f32_dpp v82, v82, v82 row_ror:1 row_mask:0xf bank_mask:0xf
    v_mul_f32 v82, 0x3b000000, v82
    v_cvt_pk_bf16_f32 v80, v80, v82
    v_and_b32 v82, 0xffff0000, v80
    v_lshlrev_b32 v80, 16, v80
    v_add_f32 v82, 0x3727c5ac, v82
    v_cvt_pk_bf16_f32 v82, v82, v82
    v_lshlrev_b32 v82, 16, v82
    v_sqrt_f32 v82, v82
    s_nop 0
    v_cvt_pk_bf16_f32 v82, v82, v82
    v_lshlrev_b32 v82, 16, v82
    v_rcp_f32 v82, v82
    v_sub_f32 v96, v96, v80
    v_sub_f32 v97, v97, v80
    v_sub_f32 v98, v98, v80
    v_sub_f32 v99, v99, v80
    v_sub_f32 v100, v100, v80
    v_sub_f32 v101, v101, v80
    v_sub_f32 v102, v102, v80
    v_sub_f32 v103, v103, v80
    v_sub_f32 v104, v104, v80
    v_sub_f32 v105, v105, v80
    v_sub_f32 v106, v106, v80
    v_sub_f32 v107, v107, v80
    v_sub_f32 v108, v108, v80
    v_sub_f32 v109, v109, v80
    v_sub_f32 v110, v110, v80
    v_sub_f32 v111, v111, v80
    v_sub_f32 v112, v112, v80
    v_sub_f32 v113, v113, v80
    v_sub_f32 v114, v114, v80
    v_sub_f32 v115, v115, v80
    v_sub_f32 v116, v116, v80
    v_sub_f32 v117, v117, v80
    v_sub_f32 v118, v118, v80
    v_sub_f32 v119, v119, v80
    v_sub_f32 v120, v120, v80
    v_sub_f32 v121, v121, v80
    v_sub_f32 v122, v122, v80
    v_sub_f32 v123, v123, v80
    v_sub_f32 v124, v124, v80
    v_sub_f32 v125, v125, v80
    v_sub_f32 v126, v126, v80
    v_sub_f32 v127, v127, v80
    v_cvt_pk_bf16_f32 v64, v96, v97
    v_cvt_pk_bf16_f32 v65, v98, v99
    v_cvt_pk_bf16_f32 v66, v100, v101
    v_cvt_pk_bf16_f32 v67, v102, v103
    v_cvt_pk_bf16_f32 v68, v104, v105
    v_cvt_pk_bf16_f32 v69, v106, v107
    v_cvt_pk_bf16_f32 v70, v108, v109
    v_cvt_pk_bf16_f32 v71, v110, v111
    v_cvt_pk_bf16_f32 v72, v112, v113
    v_cvt_pk_bf16_f32 v73, v114, v115
    v_cvt_pk_bf16_f32 v74, v116, v117
    v_cvt_pk_bf16_f32 v75, v118, v119
    v_cvt_pk_bf16_f32 v76, v120, v121
    v_cvt_pk_bf16_f32 v77, v122, v123
    v_cvt_pk_bf16_f32 v78, v124, v125
    v_cvt_pk_bf16_f32 v79, v126, v127
    v_lshlrev_b32 v96, 16, v64
    v_and_b32 v97, 0xffff0000, v64
    v_lshlrev_b32 v98, 16, v65
    v_and_b32 v99, 0xffff0000, v65
    v_lshlrev_b32 v100, 16, v66
    v_and_b32 v101, 0xffff0000, v66
    v_lshlrev_b32 v102, 16, v67
    v_and_b32 v103, 0xffff0000, v67
    v_lshlrev_b32 v104, 16, v68
    v_and_b32 v105, 0xffff0000, v68
    v_lshlrev_b32 v106, 16, v69
    v_and_b32 v107, 0xffff0000, v69
    v_lshlrev_b32 v108, 16, v70
    v_and_b32 v109, 0xffff0000, v70
    v_lshlrev_b32 v110, 16, v71
    v_and_b32 v111, 0xffff0000, v71
    v_lshlrev_b32 v112, 16, v72
    v_and_b32 v113, 0xffff0000, v72
    v_lshlrev_b32 v114, 16, v73
    v_and_b32 v115, 0xffff0000, v73
    v_lshlrev_b32 v116, 16, v74
    v_and_b32 v117, 0xffff0000, v74
    v_lshlrev_b32 v118, 16, v75
    v_and_b32 v119, 0xffff0000, v75
    v_lshlrev_b32 v120, 16, v76
    v_and_b32 v121, 0xffff0000, v76
    v_lshlrev_b32 v122, 16, v77
    v_and_b32 v123, 0xffff0000, v77
    v_lshlrev_b32 v124, 16, v78
    v_and_b32 v125, 0xffff0000, v78
    v_lshlrev_b32 v126, 16, v79
    v_and_b32 v127, 0xffff0000, v79
    v_pk_mul_f32 v[96:97], v[96:97], v[82:83] op_sel_hi:[1,0]
    v_pk_mul_f32 v[98:99], v[98:99], v[82:83] op_sel_hi:[1,0]
    v_pk_mul_f32 v[100:101], v[100:101], v[82:83] op_sel_hi:[1,0]
    v_pk_mul_f32 v[102:103], v[102:103], v[82:83] op_sel_hi:[1,0]
    v_pk_mul_f32 v[104:105], v[104:105], v[82:83] op_sel_hi:[1,0]
    v_pk_mul_f32 v[106:107], v[106:107], v[82:83] op_sel_hi:[1,0]
    v_pk_mul_f32 v[108:109], v[108:109], v[82:83] op_sel_hi:[1,0]
    v_pk_mul_f32 v[110:111], v[110:111], v[82:83] op_sel_hi:[1,0]
    v_pk_mul_f32 v[112:113], v[112:113], v[82:83] op_sel_hi:[1,0]
    v_pk_mul_f32 v[114:115], v[114:115], v[82:83] op_sel_hi:[1,0]
    v_pk_mul_f32 v[116:117], v[116:117], v[82:83] op_sel_hi:[1,0]
    v_pk_mul_f32 v[118:119], v[118:119], v[82:83] op_sel_hi:[1,0]
    v_pk_mul_f32 v[120:121], v[120:121], v[82:83] op_sel_hi:[1,0]
    v_pk_mul_f32 v[122:123], v[122:123], v[82:83] op_sel_hi:[1,0]
    v_pk_mul_f32 v[124:125], v[124:125], v[82:83] op_sel_hi:[1,0]
    v_pk_mul_f32 v[126:127], v[126:127], v[82:83] op_sel_hi:[1,0]
    v_cvt_pk_bf16_f32 v128, v96, v97
    v_cvt_pk_bf16_f32 v129, v98, v99
    v_cvt_pk_bf16_f32 v130, v112, v113
    v_cvt_pk_bf16_f32 v131, v114, v115
    v_cvt_pk_bf16_f32 v132, v100, v101
    v_cvt_pk_bf16_f32 v133, v102, v103
    v_cvt_pk_bf16_f32 v134, v116, v117
    v_cvt_pk_bf16_f32 v135, v118, v119
    v_cvt_pk_bf16_f32 v136, v104, v105
    v_cvt_pk_bf16_f32 v137, v106, v107
    v_cvt_pk_bf16_f32 v138, v120, v121
    v_cvt_pk_bf16_f32 v139, v122, v123
    v_cvt_pk_bf16_f32 v140, v108, v109
    v_cvt_pk_bf16_f32 v141, v110, v111
    v_cvt_pk_bf16_f32 v142, v124, v125
    v_cvt_pk_bf16_f32 v143, v126, v127
    buffer_store_dwordx4 v[128:131], v87, s[12:15], s27 offen offset:0 sc1
    buffer_store_dwordx4 v[132:135], v87, s[12:15], s27 offen offset:256 sc1
    buffer_store_dwordx4 v[136:139], v87, s[12:15], s27 offen offset:512 sc1
    buffer_store_dwordx4 v[140:143], v87, s[12:15], s27 offen offset:768 sc1
    s_branch ln_setup
ln_skip_load:
    s_load_dword s63, s[60:61], 0
    s_load_dwordx2 s[68:69], s[0:1], 32
    s_load_dwordx2 s[72:73], s[0:1], 56
ln_setup:
    v_and_b32 v1, 63, v0
    v_lshrrev_b32 v224, 6, v0
    s_nop 0
    v_readfirstlane_b32 s32, v224
    v_and_b32 v224, 15, v1
    v_lshrrev_b32 v225, 4, v1
    v_lshrrev_b32 v226, 2, v224
    v_and_b32 v227, 3, v224
    v_mul_u32_u24 v228, 1088, v226
    v_lshlrev_b32 v26, 4, v1
    v_lshl_add_u32 v229, v227, 8, v228
    v_xor_b32 v230, v225, v227
    v_lshl_add_u32 v2, v230, 4, v229
    v_lshl_add_u32 v229, v225, 8, v228
    v_and_b32 v230, 1, v225
    v_lshlrev_b32 v231, 1, v230
    v_xor_b32 v231, v231, v227
    v_lshl_add_u32 v231, v231, 4, v229
    v_add_u32 v36, 69632, v231
    v_lshl_add_u32 v229, v227, 3, v229
    v_lshlrev_b32 v230, 5, v230
    v_add_u32 v231, v229, v230
    v_sub_u32 v232, v229, v230
    v_add_u32 v4, 69632, v231
    v_add_u32 v5, 69632, v232
    v_add_u32 v6, 104448, v231
    v_add_u32 v7, 104448, v232
    v_lshl_add_u32 v229, v225, 2, v226
    v_bfe_u32 v230, v229, 1, 2
    v_lshlrev_b32 v229, 7, v229
    v_lshl_add_u32 v229, v227, 3, v229
    v_add_u32 v229, 34816, v229
    v_xor_b32 v231, 0, v230
    v_lshl_add_u32 v56, v231, 5, v229
    v_xor_b32 v231, 1, v230
    v_lshl_add_u32 v57, v231, 5, v229
    v_xor_b32 v231, 2, v230
    v_lshl_add_u32 v58, v231, 5, v229
    v_xor_b32 v231, 3, v230
    v_lshl_add_u32 v59, v231, 5, v229
    s_lshl_b32 s60, s32, 12
    v_xor_b32 v226, v224, v225
    v_lshlrev_b32 v226, 4, v226
    v_lshl_add_u32 v226, v225, 8, v226
    v_add_u32 v226, s60, v226
    v_add_u32 v8, 256, v226
    v_add_u32 v9, 192, v226
    v_add_u32 v10, 128, v226
    v_add_u32 v11, 64, v226
    v_and_b32 v226, 1, v225
    v_lshlrev_b32 v226, 1, v226
    v_xor_b32 v226, v226, v224
    v_lshlrev_b32 v226, 4, v226
    v_lshl_add_u32 v227, v225, 10, v226
    v_add_u32 v227, s60, v227
    v_add_u32 v12, 2560, v227
    v_add_u32 v13, 1728, v227
    v_add_u32 v14, 896, v227
    v_add_u32 v15, 64, v227
    s_lshl_b32 s60, s32, 17
    v_lshl_add_u32 v227, v225, 15, v226
    v_add_u32 v227, s60, v227
    v_add_u32 v60, 0, v227
    v_add_u32 v61, 7104, v227
    v_add_u32 v62, 14208, v227
    v_add_u32 v63, 21312, v227
    v_lshrrev_b32 v226, 3, v1
    s_lshl_b32 s60, s32, 4
    v_add_u32 v226, s60, v226
    v_mul_u32_u24 v226, 3584, v226
    v_and_b32 v227, 7, v1
    v_lshlrev_b32 v228, 1, v225
    v_xor_b32 v227, v227, v228
    v_lshl_add_u32 v38, v227, 4, v226
    v_add_u32 v39, 27648, v38
    s_mul_i32 s22, s32, 4352
    s_add_u32 s23, s22, 69632
    s_lshl_b32 s55, s32, 11
    s_add_u32 s55, s55, 34816
    s_waitcnt lgkmcnt(0)
    s_lshl_b32 s26, s33, 19
    s_add_u32 s4, s36, s26
    s_addc_u32 s5, s37, 0
    s_sub_u32 s4, s4, 256
    s_subb_u32 s5, s5, 0
    s_mov_b32 s6, 524544
    s_mov_b32 s7, 0x20000
    s_add_u32 s8, s38, s26
    s_addc_u32 s9, s39, 0
    s_sub_u32 s8, s8, 2560
    s_subb_u32 s9, s9, 0
    s_mov_b32 s10, 526848
    s_mov_b32 s11, 0x20000
    s_mov_b32 s40, s56
    s_mov_b32 s41, s57
    s_mov_b32 s42, 4194304
    s_mov_b32 s43, 0x20000
    s_mov_b32 s44, s58
    s_mov_b32 s45, s59
    s_mov_b32 s46, 1835008
    s_mov_b32 s47, 0x20000
    s_mov_b32 s12, s28
    s_mov_b32 s13, s29
    s_mov_b32 s14, 2097152
    s_mov_b32 s15, 0x20000
    s_add_u32 s16, s28, 10485760
    s_addc_u32 s17, s29, 0
    s_mov_b32 s18, 16777216
    s_mov_b32 s19, 0x20000
    s_add_u32 s48, s28, 2097152
    s_addc_u32 s49, s29, 0
    s_mov_b32 s50, 7340032
    s_mov_b32 s51, 0x20000
    s_mov_b32 s68, s68
    s_mov_b32 s69, s69
    s_mov_b32 s70, 4194304
    s_mov_b32 s71, 0x20000
    s_mov_b32 s72, s72
    s_mov_b32 s73, s73
    s_mov_b32 s74, 1835008
    s_mov_b32 s75, 0x20000
    s_lshl_b32 s52, s33, 8
    s_lshl_b32 s53, s33, 7
    s_lshl_b32 s26, s34, 4
    s_lshl_b32 s27, s32, 2
    s_add_u32 s35, s26, s27
    s_lshl_b32 s54, s35, 14
    s_mov_b32 s20, 0
    s_mov_b32 s21, 0
    s_mov_b32 s25, 0x4b800000
    s_lshl_b32 s26, s34, 10
    s_add_u32 s26, s26, 50331648
    s_add_u32 s38, s28, s26
    s_addc_u32 s39, s29, 0
    s_add_u32 s63, s63, 1
    s_cmp_ge_u32 s32, 2
    s_cbranch_scc1 ln_w23
    s_waitcnt vmcnt(0)
    s_branch ln_pub
ln_w23:
    s_add_u32 m0, s23, 0
    s_nop 0
    buffer_load_dwordx4 v60, s[40:43], s52 offen offset:0 lds
    buffer_load_dwordx4 v61, s[40:43], s52 offen offset:1088 lds
    buffer_load_dwordx4 v62, s[40:43], s52 offen offset:2176 lds
    buffer_load_dwordx4 v63, s[40:43], s52 offen offset:3264 lds
    s_add_u32 m0, s55, 0
    s_nop 0
    buffer_load_dwordx4 v38, s[44:47], s53 offen offset:0 lds
    buffer_load_dwordx4 v39, s[44:47], s53 offen offset:1024 lds
    s_add_u32 s52, s52, 524288
    s_add_u32 s53, s53, 229376
    s_add_u32 m0, s23, 17408
    s_nop 0
    buffer_load_dwordx4 v60, s[40:43], s52 offen offset:0 lds
    buffer_load_dwordx4 v61, s[40:43], s52 offen offset:1088 lds
    buffer_load_dwordx4 v62, s[40:43], s52 offen offset:2176 lds
    buffer_load_dwordx4 v63, s[40:43], s52 offen offset:3264 lds
    s_add_u32 m0, s55, 8704
    s_nop 0
    buffer_load_dwordx4 v38, s[44:47], s53 offen offset:0 lds
    buffer_load_dwordx4 v39, s[44:47], s53 offen offset:1024 lds
    s_add_u32 s52, s52, 524288
    s_add_u32 s53, s53, 229376
    s_cmp_lg_u32 s32, 2
    s_cbranch_scc1 ln_pub
    s_getpc_b64 s[60:61]
pc_anchor:
    s_sub_u32 s60, s60, pc_anchor-recurrent_scan__mha_block_cached__dense_activation_relu__prompt_kernel
    s_subb_u32 s61, s61, 0
    s_lshr_b32 s26, s2, 3
    s_lshl_b32 s26, s26, 12
    s_min_u32 s26, s26, code_end-recurrent_scan__mha_block_cached__dense_activation_relu__prompt_kernel-4096
    s_add_u32 s60, s60, s26
    s_addc_u32 s61, s61, 0
    v_mov_b32 v251, s61
    v_add_co_u32 v250, vcc, s60, v26
    s_nop 1
    v_addc_co_u32 v251, vcc, 0, v251, vcc
    global_load_dwordx4 v[252:255], v[250:251], off offset:0
    global_load_dwordx4 v[252:255], v[250:251], off offset:1024
    global_load_dwordx4 v[252:255], v[250:251], off offset:2048
    global_load_dwordx4 v[252:255], v[250:251], off offset:3072
ln_pub:
    s_barrier
    s_cmp_lg_u32 s32, 0
    s_cbranch_scc1 ln_no_signal
    s_mov_b64 exec, 1
    s_lshl_b32 s61, s33, 2
    v_mov_b32 v248, s61
    v_mov_b32 v249, s63
    global_store_dword v248, v249, s[38:39] offset:0 sc1
    s_mov_b64 exec, -1
ln_no_signal:
    s_cmp_ge_u32 s32, 2
    s_cbranch_scc1 ln_skip_wdma
    s_add_u32 m0, s23, 0
    s_nop 0
    buffer_load_dwordx4 v60, s[40:43], s52 offen offset:0 lds
    buffer_load_dwordx4 v61, s[40:43], s52 offen offset:1088 lds
    buffer_load_dwordx4 v62, s[40:43], s52 offen offset:2176 lds
    buffer_load_dwordx4 v63, s[40:43], s52 offen offset:3264 lds
    s_add_u32 m0, s55, 0
    s_nop 0
    buffer_load_dwordx4 v38, s[44:47], s53 offen offset:0 lds
    buffer_load_dwordx4 v39, s[44:47], s53 offen offset:1024 lds
    s_add_u32 s52, s52, 524288
    s_add_u32 s53, s53, 229376
    s_add_u32 m0, s23, 17408
    s_nop 0
    buffer_load_dwordx4 v60, s[40:43], s52 offen offset:0 lds
    buffer_load_dwordx4 v61, s[40:43], s52 offen offset:1088 lds
    buffer_load_dwordx4 v62, s[40:43], s52 offen offset:2176 lds
    buffer_load_dwordx4 v63, s[40:43], s52 offen offset:3264 lds
    s_add_u32 m0, s55, 8704
    s_nop 0
    buffer_load_dwordx4 v38, s[44:47], s53 offen offset:0 lds
    buffer_load_dwordx4 v39, s[44:47], s53 offen offset:1024 lds
    s_add_u32 s52, s52, 524288
    s_add_u32 s53, s53, 229376
ln_skip_wdma:
    s_cmp_lg_u32 s32, 3
    s_cbranch_scc1 ln_join
    s_mov_b64 exec, 0xffffffff
    v_lshlrev_b32 v248, 2, v1
    s_mov_b32 s61, 0
    global_load_dword v250, v248, s[38:39] offset:0 sc1
    s_sleep 2
    global_load_dword v251, v248, s[38:39] offset:0 sc1
    s_sleep 2
ln_poll:
    global_load_dword v252, v248, s[38:39] offset:0 sc1
    s_waitcnt vmcnt(2)
    v_cmp_ne_u32 vcc, s63, v250
    s_cbranch_vccz ln_poll_out
    global_load_dword v250, v248, s[38:39] offset:0 sc1
    s_waitcnt vmcnt(2)
    v_cmp_ne_u32 vcc, s63, v251
    s_cbranch_vccz ln_poll_out
    global_load_dword v251, v248, s[38:39] offset:0 sc1
    s_waitcnt vmcnt(2)
    v_cmp_ne_u32 vcc, s63, v252
    s_cbranch_vccz ln_poll_out
    s_add_u32 s61, s61, 1
    s_cmp_lt_u32 s61, 0x20000
    s_cbranch_scc1 ln_poll
ln_poll_out:
    s_mov_b64 exec, -1
ln_join:
    s_barrier
    s_add_u32 s27, s54, 0
    buffer_load_dwordx4 a[0:3], v26, s[12:15], s27 offen sc1
    s_add_u32 s27, s54, 16384
    buffer_load_dwordx4 a[4:7], v26, s[12:15], s27 offen sc1
    s_add_u32 s27, s54, 32768
    buffer_load_dwordx4 a[8:11], v26, s[12:15], s27 offen sc1
    s_add_u32 s27, s54, 49152
    buffer_load_dwordx4 a[12:15], v26, s[12:15], s27 offen sc1
    s_add_u32 s27, s54, 1024
    buffer_load_dwordx4 a[16:19], v26, s[12:15], s27 offen sc1
    s_add_u32 s27, s54, 17408
    buffer_load_dwordx4 a[20:23], v26, s[12:15], s27 offen sc1
    s_add_u32 s27, s54, 33792
    buffer_load_dwordx4 a[24:27], v26, s[12:15], s27 offen sc1
    s_add_u32 s27, s54, 50176
    buffer_load_dwordx4 a[28:31], v26, s[12:15], s27 offen sc1
    s_add_u32 s27, s54, 2048
    buffer_load_dwordx4 a[32:35], v26, s[12:15], s27 offen sc1
    s_add_u32 s27, s54, 18432
    buffer_load_dwordx4 a[36:39], v26, s[12:15], s27 offen sc1
    s_add_u32 s27, s54, 34816
    buffer_load_dwordx4 a[40:43], v26, s[12:15], s27 offen sc1
    s_add_u32 s27, s54, 51200
    buffer_load_dwordx4 a[44:47], v26, s[12:15], s27 offen sc1
    s_add_u32 s27, s54, 3072
    buffer_load_dwordx4 a[48:51], v26, s[12:15], s27 offen sc1
    s_add_u32 s27, s54, 19456
    buffer_load_dwordx4 a[52:55], v26, s[12:15], s27 offen sc1
    s_add_u32 s27, s54, 35840
    buffer_load_dwordx4 a[56:59], v26, s[12:15], s27 offen sc1
    s_add_u32 s27, s54, 52224
    buffer_load_dwordx4 a[60:63], v26, s[12:15], s27 offen sc1
    s_waitcnt vmcnt(22)
    s_barrier
    ds_read_b64_tr_b16 a[192:193], v36 offset:0
    ds_read_b64_tr_b16 a[194:195], v36 offset:4352
    ds_read_b64_tr_b16 a[196:197], v36 offset:8
    ds_read_b64_tr_b16 a[198:199], v36 offset:4360
    ds_read_b64_tr_b16 a[200:201], v36 offset:64
    ds_read_b64_tr_b16 a[202:203], v36 offset:4416
    ds_read_b64_tr_b16 a[204:205], v36 offset:72
    ds_read_b64_tr_b16 a[206:207], v36 offset:4424
    ds_read_b64_tr_b16 a[208:209], v36 offset:128
    ds_read_b64_tr_b16 a[210:211], v36 offset:4480
    ds_read_b64_tr_b16 a[212:213], v36 offset:136
    ds_read_b64_tr_b16 a[214:215], v36 offset:4488
    s_waitcnt vmcnt(12)
    s_waitcnt lgkmcnt(10)
    v_mfma_f32_16x16x32_bf16 v[128:131], a[192:195], a[0:3], 0
    ds_read_b64_tr_b16 a[216:217], v36 offset:192
    v_mfma_f32_16x16x32_bf16 v[132:135], a[192:195], a[4:7], 0
    ds_read_b64_tr_b16 a[218:219], v36 offset:4544
    v_mfma_f32_16x16x32_bf16 v[136:139], a[192:195], a[8:11], 0
    s_add_u32 m0, s23, 34816
    v_mfma_f32_16x16x32_bf16 v[140:143], a[192:195], a[12:15], 0
    buffer_load_dwordx4 v60, s[40:43], s52 offen offset:0 lds
    s_waitcnt lgkmcnt(10)
    v_mfma_f32_16x16x32_bf16 v[144:147], a[196:199], a[0:3], 0
    ds_read_b64_tr_b16 a[220:221], v36 offset:200
    v_mfma_f32_16x16x32_bf16 v[148:151], a[196:199], a[4:7], 0
    ds_read_b64_tr_b16 a[222:223], v36 offset:4552
    v_mfma_f32_16x16x32_bf16 v[152:155], a[196:199], a[8:11], 0
    buffer_load_dwordx4 v61, s[40:43], s52 offen offset:1088 lds
    v_mfma_f32_16x16x32_bf16 v[156:159], a[196:199], a[12:15], 0
    s_waitcnt lgkmcnt(10)
    v_mfma_f32_16x16x32_bf16 v[160:163], a[200:203], a[0:3], 0
    ds_read_b64_tr_b16 a[224:225], v56 offset:0
    v_mfma_f32_16x16x32_bf16 v[164:167], a[200:203], a[4:7], 0
    ds_read_b64_tr_b16 a[226:227], v56 offset:2048
    v_mfma_f32_16x16x32_bf16 v[168:171], a[200:203], a[8:11], 0
    v_mfma_f32_16x16x32_bf16 v[172:175], a[200:203], a[12:15], 0
    s_waitcnt lgkmcnt(10)
    v_mfma_f32_16x16x32_bf16 v[176:179], a[204:207], a[0:3], 0
    ds_read_b64_tr_b16 a[228:229], v57 offset:0
    v_mfma_f32_16x16x32_bf16 v[180:183], a[204:207], a[4:7], 0
    ds_read_b64_tr_b16 a[230:231], v57 offset:2048
    v_mfma_f32_16x16x32_bf16 v[184:187], a[204:207], a[8:11], 0
    buffer_load_dwordx4 v62, s[40:43], s52 offen offset:2176 lds
    v_mfma_f32_16x16x32_bf16 v[188:191], a[204:207], a[12:15], 0
    s_waitcnt lgkmcnt(10)
    v_mfma_f32_16x16x32_bf16 v[192:195], a[208:211], a[0:3], 0
    ds_read_b64_tr_b16 a[232:233], v58 offset:0
    v_mfma_f32_16x16x32_bf16 v[196:199], a[208:211], a[4:7], 0
    ds_read_b64_tr_b16 a[234:235], v58 offset:2048
    v_mfma_f32_16x16x32_bf16 v[200:203], a[208:211], a[8:11], 0
    buffer_load_dwordx4 v63, s[40:43], s52 offen offset:3264 lds
    v_mfma_f32_16x16x32_bf16 v[204:207], a[208:211], a[12:15], 0
    s_waitcnt lgkmcnt(10)
    v_mfma_f32_16x16x32_bf16 v[208:211], a[212:215], a[0:3], 0
    ds_read_b64_tr_b16 a[236:237], v59 offset:0
    v_mfma_f32_16x16x32_bf16 v[212:215], a[212:215], a[4:7], 0
    ds_read_b64_tr_b16 a[238:239], v59 offset:2048
    v_mfma_f32_16x16x32_bf16 v[216:219], a[212:215], a[8:11], 0
    v_mfma_f32_16x16x32_bf16 v[220:223], a[212:215], a[12:15], 0
    s_waitcnt lgkmcnt(10)
    v_mfma_f32_16x16x32_bf16 v[224:227], a[216:219], a[0:3], 0
    ds_read_b64_tr_b16 a[240:241], v36 offset:8704
    v_mfma_f32_16x16x32_bf16 v[228:231], a[216:219], a[4:7], 0
    ds_read_b64_tr_b16 a[242:243], v36 offset:13056
    v_mfma_f32_16x16x32_bf16 v[232:235], a[216:219], a[8:11], 0
    s_add_u32 m0, s55, 17408
    v_mfma_f32_16x16x32_bf16 v[236:239], a[216:219], a[12:15], 0
    buffer_load_dwordx4 v38, s[44:47], s53 offen offset:0 lds
    s_waitcnt lgkmcnt(10)
    v_mfma_f32_16x16x32_bf16 v[240:243], a[220:223], a[0:3], 0
    ds_read_b64_tr_b16 a[244:245], v36 offset:8712
    v_mfma_f32_16x16x32_bf16 v[244:247], a[220:223], a[4:7], 0
    ds_read_b64_tr_b16 a[246:247], v36 offset:13064
    v_mfma_f32_16x16x32_bf16 v[248:251], a[220:223], a[8:11], 0
    buffer_load_dwordx4 v39, s[44:47], s53 offen offset:1024 lds
    v_mfma_f32_16x16x32_bf16 v[252:255], a[220:223], a[12:15], 0
    s_add_u32 s52, s52, 524288
    s_waitcnt lgkmcnt(10)
    v_mfma_f32_16x16x32_bf16 v[64:67], a[224:227], a[0:3], 0
    ds_read_b64_tr_b16 a[248:249], v36 offset:8768
    v_mfma_f32_16x16x32_bf16 v[68:71], a[224:227], a[4:7], 0
    ds_read_b64_tr_b16 a[250:251], v36 offset:13120
    v_mfma_f32_16x16x32_bf16 v[72:75], a[224:227], a[8:11], 0
    v_mfma_f32_16x16x32_bf16 v[76:79], a[224:227], a[12:15], 0
    s_waitcnt lgkmcnt(10)
    v_mfma_f32_16x16x32_bf16 v[80:83], a[228:231], a[0:3], 0
    ds_read_b64_tr_b16 a[252:253], v36 offset:8776
    v_mfma_f32_16x16x32_bf16 v[84:87], a[228:231], a[4:7], 0
    ds_read_b64_tr_b16 a[254:255], v36 offset:13128
    v_mfma_f32_16x16x32_bf16 v[88:91], a[228:231], a[8:11], 0
    s_add_u32 s53, s53, 229376
    v_mfma_f32_16x16x32_bf16 v[92:95], a[228:231], a[12:15], 0
    s_add_u32 s27, s54, 4096
    s_waitcnt lgkmcnt(10)
    v_mfma_f32_16x16x32_bf16 v[96:99], a[232:235], a[0:3], 0
    ds_read_b64_tr_b16 a[192:193], v36 offset:8832
    v_mfma_f32_16x16x32_bf16 v[100:103], a[232:235], a[4:7], 0
    ds_read_b64_tr_b16 a[194:195], v36 offset:13184
    v_mfma_f32_16x16x32_bf16 v[104:107], a[232:235], a[8:11], 0
    buffer_load_dwordx4 a[64:67], v26, s[12:15], s27 offen sc1
    v_mfma_f32_16x16x32_bf16 v[108:111], a[232:235], a[12:15], 0
    s_add_u32 s27, s54, 20480
    s_waitcnt lgkmcnt(10)
    v_mfma_f32_16x16x32_bf16 v[112:115], a[236:239], a[0:3], 0
    ds_read_b64_tr_b16 a[196:197], v36 offset:8840
    v_mfma_f32_16x16x32_bf16 v[116:119], a[236:239], a[4:7], 0
    ds_read_b64_tr_b16 a[198:199], v36 offset:13192
    v_mfma_f32_16x16x32_bf16 v[120:123], a[236:239], a[8:11], 0
    v_mfma_f32_16x16x32_bf16 v[124:127], a[236:239], a[12:15], 0
    s_waitcnt vmcnt(15)
    s_waitcnt lgkmcnt(10)
    v_mfma_f32_16x16x32_bf16 v[128:131], a[240:243], a[16:19], v[128:131]
    ds_read_b64_tr_b16 a[200:201], v36 offset:8896
    v_mfma_f32_16x16x32_bf16 v[132:135], a[240:243], a[20:23], v[132:135]
    ds_read_b64_tr_b16 a[202:203], v36 offset:13248
    v_mfma_f32_16x16x32_bf16 v[136:139], a[240:243], a[24:27], v[136:139]
    buffer_load_dwordx4 a[68:71], v26, s[12:15], s27 offen sc1
    v_mfma_f32_16x16x32_bf16 v[140:143], a[240:243], a[28:31], v[140:143]
    s_add_u32 s27, s54, 36864
    s_waitcnt lgkmcnt(10)
    v_mfma_f32_16x16x32_bf16 v[144:147], a[244:247], a[16:19], v[144:147]
    ds_read_b64_tr_b16 a[204:205], v36 offset:8904
    v_mfma_f32_16x16x32_bf16 v[148:151], a[244:247], a[20:23], v[148:151]
    ds_read_b64_tr_b16 a[206:207], v36 offset:13256
    v_mfma_f32_16x16x32_bf16 v[152:155], a[244:247], a[24:27], v[152:155]
    buffer_load_dwordx4 a[72:75], v26, s[12:15], s27 offen sc1
    v_mfma_f32_16x16x32_bf16 v[156:159], a[244:247], a[28:31], v[156:159]
    s_add_u32 s27, s54, 53248
    s_waitcnt lgkmcnt(10)
    v_mfma_f32_16x16x32_bf16 v[160:163], a[248:251], a[16:19], v[160:163]
    ds_read_b64_tr_b16 a[208:209], v56 offset:4096
    v_mfma_f32_16x16x32_bf16 v[164:167], a[248:251], a[20:23], v[164:167]
    ds_read_b64_tr_b16 a[210:211], v56 offset:6144
    v_mfma_f32_16x16x32_bf16 v[168:171], a[248:251], a[24:27], v[168:171]
    v_mfma_f32_16x16x32_bf16 v[172:175], a[248:251], a[28:31], v[172:175]
    s_waitcnt lgkmcnt(10)
    v_mfma_f32_16x16x32_bf16 v[176:179], a[252:255], a[16:19], v[176:179]
    ds_read_b64_tr_b16 a[212:213], v57 offset:4096
    v_mfma_f32_16x16x32_bf16 v[180:183], a[252:255], a[20:23], v[180:183]
    ds_read_b64_tr_b16 a[214:215], v57 offset:6144
    v_mfma_f32_16x16x32_bf16 v[184:187], a[252:255], a[24:27], v[184:187]
    buffer_load_dwordx4 a[76:79], v26, s[12:15], s27 offen sc1
    v_mfma_f32_16x16x32_bf16 v[188:191], a[252:255], a[28:31], v[188:191]
    s_waitcnt lgkmcnt(10)
    v_mfma_f32_16x16x32_bf16 v[192:195], a[192:195], a[16:19], v[192:195]
    ds_read_b64_tr_b16 a[216:217], v58 offset:4096
    v_mfma_f32_16x16x32_bf16 v[196:199], a[192:195], a[20:23], v[196:199]
    ds_read_b64_tr_b16 a[218:219], v58 offset:6144
    v_mfma_f32_16x16x32_bf16 v[200:203], a[192:195], a[24:27], v[200:203]
    s_add_u32 s27, s54, 5120
    v_mfma_f32_16x16x32_bf16 v[204:207], a[192:195], a[28:31], v[204:207]
    buffer_load_dwordx4 a[80:83], v26, s[12:15], s27 offen sc1
    s_waitcnt lgkmcnt(10)
    v_mfma_f32_16x16x32_bf16 v[208:211], a[196:199], a[16:19], v[208:211]
    ds_read_b64_tr_b16 a[220:221], v59 offset:4096
    v_mfma_f32_16x16x32_bf16 v[212:215], a[196:199], a[20:23], v[212:215]
    ds_read_b64_tr_b16 a[222:223], v59 offset:6144
    v_mfma_f32_16x16x32_bf16 v[216:219], a[196:199], a[24:27], v[216:219]
    v_mfma_f32_16x16x32_bf16 v[220:223], a[196:199], a[28:31], v[220:223]
    s_waitcnt lgkmcnt(10)
    s_waitcnt vmcnt(27)
    s_barrier
    v_mfma_f32_16x16x32_bf16 v[224:227], a[200:203], a[16:19], v[224:227]
    ds_read_b64_tr_b16 a[224:225], v36 offset:17408
    v_mfma_f32_16x16x32_bf16 v[228:231], a[200:203], a[20:23], v[228:231]
    ds_read_b64_tr_b16 a[226:227], v36 offset:21760
    v_mfma_f32_16x16x32_bf16 v[232:235], a[200:203], a[24:27], v[232:235]
    s_add_u32 s27, s54, 21504
    v_mfma_f32_16x16x32_bf16 v[236:239], a[200:203], a[28:31], v[236:239]
    buffer_load_dwordx4 a[84:87], v26, s[12:15], s27 offen sc1
    s_waitcnt lgkmcnt(10)
    v_mfma_f32_16x16x32_bf16 v[240:243], a[204:207], a[16:19], v[240:243]
    ds_read_b64_tr_b16 a[228:229], v36 offset:17416
    v_mfma_f32_16x16x32_bf16 v[244:247], a[204:207], a[20:23], v[244:247]
    ds_read_b64_tr_b16 a[230:231], v36 offset:21768
    v_mfma_f32_16x16x32_bf16 v[248:251], a[204:207], a[24:27], v[248:251]
    s_add_u32 s27, s54, 37888
    v_mfma_f32_16x16x32_bf16 v[252:255], a[204:207], a[28:31], v[252:255]
    buffer_load_dwordx4 a[88:91], v26, s[12:15], s27 offen sc1
    s_waitcnt lgkmcnt(10)
    v_mfma_f32_16x16x32_bf16 v[64:67], a[208:211], a[16:19], v[64:67]
    ds_read_b64_tr_b16 a[232:233], v36 offset:17472
    v_mfma_f32_16x16x32_bf16 v[68:71], a[208:211], a[20:23], v[68:71]
    ds_read_b64_tr_b16 a[234:235], v36 offset:21824
    v_mfma_f32_16x16x32_bf16 v[72:75], a[208:211], a[24:27], v[72:75]
    v_mfma_f32_16x16x32_bf16 v[76:79], a[208:211], a[28:31], v[76:79]
    s_waitcnt lgkmcnt(10)
    v_mfma_f32_16x16x32_bf16 v[80:83], a[212:215], a[16:19], v[80:83]
    ds_read_b64_tr_b16 a[236:237], v36 offset:17480
    v_mfma_f32_16x16x32_bf16 v[84:87], a[212:215], a[20:23], v[84:87]
    ds_read_b64_tr_b16 a[238:239], v36 offset:21832
    v_mfma_f32_16x16x32_bf16 v[88:91], a[212:215], a[24:27], v[88:91]
    s_add_u32 s27, s54, 54272
    v_mfma_f32_16x16x32_bf16 v[92:95], a[212:215], a[28:31], v[92:95]
    buffer_load_dwordx4 a[92:95], v26, s[12:15], s27 offen sc1
    s_waitcnt lgkmcnt(10)
    v_mfma_f32_16x16x32_bf16 v[96:99], a[216:219], a[16:19], v[96:99]
    ds_read_b64_tr_b16 a[240:241], v36 offset:17536
    v_mfma_f32_16x16x32_bf16 v[100:103], a[216:219], a[20:23], v[100:103]
    ds_read_b64_tr_b16 a[242:243], v36 offset:21888
    v_mfma_f32_16x16x32_bf16 v[104:107], a[216:219], a[24:27], v[104:107]
    s_add_u32 m0, s23, 52224
    v_mfma_f32_16x16x32_bf16 v[108:111], a[216:219], a[28:31], v[108:111]
    buffer_load_dwordx4 v60, s[40:43], s52 offen offset:0 lds
    s_waitcnt lgkmcnt(10)
    v_mfma_f32_16x16x32_bf16 v[112:115], a[220:223], a[16:19], v[112:115]
    ds_read_b64_tr_b16 a[244:245], v36 offset:17544
    v_mfma_f32_16x16x32_bf16 v[116:119], a[220:223], a[20:23], v[116:119]
    ds_read_b64_tr_b16 a[246:247], v36 offset:21896
    v_mfma_f32_16x16x32_bf16 v[120:123], a[220:223], a[24:27], v[120:123]
    v_mfma_f32_16x16x32_bf16 v[124:127], a[220:223], a[28:31], v[124:127]
    s_waitcnt vmcnt(19)
    s_waitcnt lgkmcnt(10)
    v_mfma_f32_16x16x32_bf16 v[128:131], a[224:227], a[32:35], v[128:131]
    ds_read_b64_tr_b16 a[248:249], v36 offset:17600
    v_mfma_f32_16x16x32_bf16 v[132:135], a[224:227], a[36:39], v[132:135]
    ds_read_b64_tr_b16 a[250:251], v36 offset:21952
    v_mfma_f32_16x16x32_bf16 v[136:139], a[224:227], a[40:43], v[136:139]
    buffer_load_dwordx4 v61, s[40:43], s52 offen offset:1088 lds
    v_mfma_f32_16x16x32_bf16 v[140:143], a[224:227], a[44:47], v[140:143]
    s_waitcnt lgkmcnt(10)
    v_mfma_f32_16x16x32_bf16 v[144:147], a[228:231], a[32:35], v[144:147]
    ds_read_b64_tr_b16 a[252:253], v36 offset:17608
    v_mfma_f32_16x16x32_bf16 v[148:151], a[228:231], a[36:39], v[148:151]
    ds_read_b64_tr_b16 a[254:255], v36 offset:21960
    v_mfma_f32_16x16x32_bf16 v[152:155], a[228:231], a[40:43], v[152:155]
    buffer_load_dwordx4 v62, s[40:43], s52 offen offset:2176 lds
    v_mfma_f32_16x16x32_bf16 v[156:159], a[228:231], a[44:47], v[156:159]
    s_waitcnt lgkmcnt(10)
    v_mfma_f32_16x16x32_bf16 v[160:163], a[232:235], a[32:35], v[160:163]
    ds_read_b64_tr_b16 a[192:193], v56 offset:8704
    v_mfma_f32_16x16x32_bf16 v[164:167], a[232:235], a[36:39], v[164:167]
    ds_read_b64_tr_b16 a[194:195], v56 offset:10752
    v_mfma_f32_16x16x32_bf16 v[168:171], a[232:235], a[40:43], v[168:171]
    v_mfma_f32_16x16x32_bf16 v[172:175], a[232:235], a[44:47], v[172:175]
    s_waitcnt lgkmcnt(10)
    v_mfma_f32_16x16x32_bf16 v[176:179], a[236:239], a[32:35], v[176:179]
    ds_read_b64_tr_b16 a[196:197], v57 offset:8704
    v_mfma_f32_16x16x32_bf16 v[180:183], a[236:239], a[36:39], v[180:183]
    ds_read_b64_tr_b16 a[198:199], v57 offset:10752
    v_mfma_f32_16x16x32_bf16 v[184:187], a[236:239], a[40:43], v[184:187]
    buffer_load_dwordx4 v63, s[40:43], s52 offen offset:3264 lds
    v_mfma_f32_16x16x32_bf16 v[188:191], a[236:239], a[44:47], v[188:191]
    s_waitcnt lgkmcnt(10)
    v_mfma_f32_16x16x32_bf16 v[192:195], a[240:243], a[32:35], v[192:195]
    ds_read_b64_tr_b16 a[200:201], v58 offset:8704
    v_mfma_f32_16x16x32_bf16 v[196:199], a[240:243], a[36:39], v[196:199]
    ds_read_b64_tr_b16 a[202:203], v58 offset:10752
    v_mfma_f32_16x16x32_bf16 v[200:203], a[240:243], a[40:43], v[200:203]
    s_add_u32 m0, s55, 26112
    v_mfma_f32_16x16x32_bf16 v[204:207], a[240:243], a[44:47], v[204:207]
    buffer_load_dwordx4 v38, s[44:47], s53 offen offset:0 lds
    s_waitcnt lgkmcnt(10)
    v_mfma_f32_16x16x32_bf16 v[208:211], a[244:247], a[32:35], v[208:211]
    ds_read_b64_tr_b16 a[204:205], v59 offset:8704
    v_mfma_f32_16x16x32_bf16 v[212:215], a[244:247], a[36:39], v[212:215]
    ds_read_b64_tr_b16 a[206:207], v59 offset:10752
    v_mfma_f32_16x16x32_bf16 v[216:219], a[244:247], a[40:43], v[216:219]
    v_mfma_f32_16x16x32_bf16 v[220:223], a[244:247], a[44:47], v[220:223]
    s_waitcnt lgkmcnt(10)
    v_mfma_f32_16x16x32_bf16 v[224:227], a[248:251], a[32:35], v[224:227]
    ds_read_b64_tr_b16 a[208:209], v36 offset:26112
    v_mfma_f32_16x16x32_bf16 v[228:231], a[248:251], a[36:39], v[228:231]
    ds_read_b64_tr_b16 a[210:211], v36 offset:30464
    v_mfma_f32_16x16x32_bf16 v[232:235], a[248:251], a[40:43], v[232:235]
    buffer_load_dwordx4 v39, s[44:47], s53 offen offset:1024 lds
    v_mfma_f32_16x16x32_bf16 v[236:239], a[248:251], a[44:47], v[236:239]
    s_add_u32 s52, s52, 524288
    s_waitcnt lgkmcnt(10)
    v_mfma_f32_16x16x32_bf16 v[240:243], a[252:255], a[32:35], v[240:243]
    ds_read_b64_tr_b16 a[212:213], v36 offset:26120
    v_mfma_f32_16x16x32_bf16 v[244:247], a[252:255], a[36:39], v[244:247]
    ds_read_b64_tr_b16 a[214:215], v36 offset:30472
    v_mfma_f32_16x16x32_bf16 v[248:251], a[252:255], a[40:43], v[248:251]
    s_add_u32 s53, s53, 229376
    v_mfma_f32_16x16x32_bf16 v[252:255], a[252:255], a[44:47], v[252:255]
    s_add_u32 s27, s54, 6144
    s_waitcnt lgkmcnt(10)
    v_mfma_f32_16x16x32_bf16 v[64:67], a[192:195], a[32:35], v[64:67]
    ds_read_b64_tr_b16 a[216:217], v36 offset:26176
    v_mfma_f32_16x16x32_bf16 v[68:71], a[192:195], a[36:39], v[68:71]
    ds_read_b64_tr_b16 a[218:219], v36 offset:30528
    v_mfma_f32_16x16x32_bf16 v[72:75], a[192:195], a[40:43], v[72:75]
    v_mfma_f32_16x16x32_bf16 v[76:79], a[192:195], a[44:47], v[76:79]
    s_waitcnt lgkmcnt(10)
    v_mfma_f32_16x16x32_bf16 v[80:83], a[196:199], a[32:35], v[80:83]
    ds_read_b64_tr_b16 a[220:221], v36 offset:26184
    v_mfma_f32_16x16x32_bf16 v[84:87], a[196:199], a[36:39], v[84:87]
    ds_read_b64_tr_b16 a[222:223], v36 offset:30536
    v_mfma_f32_16x16x32_bf16 v[88:91], a[196:199], a[40:43], v[88:91]
    buffer_load_dwordx4 a[96:99], v26, s[12:15], s27 offen sc1
    v_mfma_f32_16x16x32_bf16 v[92:95], a[196:199], a[44:47], v[92:95]
    s_add_u32 s27, s54, 22528
    s_waitcnt lgkmcnt(10)
    v_mfma_f32_16x16x32_bf16 v[96:99], a[200:203], a[32:35], v[96:99]
    ds_read_b64_tr_b16 a[224:225], v36 offset:26240
    v_mfma_f32_16x16x32_bf16 v[100:103], a[200:203], a[36:39], v[100:103]
    ds_read_b64_tr_b16 a[226:227], v36 offset:30592
    v_mfma_f32_16x16x32_bf16 v[104:107], a[200:203], a[40:43], v[104:107]
    buffer_load_dwordx4 a[100:103], v26, s[12:15], s27 offen sc1
    v_mfma_f32_16x16x32_bf16 v[108:111], a[200:203], a[44:47], v[108:111]
    s_add_u32 s27, s54, 38912
    s_waitcnt lgkmcnt(10)
    v_mfma_f32_16x16x32_bf16 v[112:115], a[204:207], a[32:35], v[112:115]
    ds_read_b64_tr_b16 a[228:229], v36 offset:26248
    v_mfma_f32_16x16x32_bf16 v[116:119], a[204:207], a[36:39], v[116:119]
    ds_read_b64_tr_b16 a[230:231], v36 offset:30600
    v_mfma_f32_16x16x32_bf16 v[120:123], a[204:207], a[40:43], v[120:123]
    v_mfma_f32_16x16x32_bf16 v[124:127], a[204:207], a[44:47], v[124:127]
    s_waitcnt vmcnt(22)
    s_waitcnt lgkmcnt(10)
    v_mfma_f32_16x16x32_bf16 v[128:131], a[208:211], a[48:51], v[128:131]
    ds_read_b64_tr_b16 a[232:233], v36 offset:26304
    v_mfma_f32_16x16x32_bf16 v[132:135], a[208:211], a[52:55], v[132:135]
    ds_read_b64_tr_b16 a[234:235], v36 offset:30656
    v_mfma_f32_16x16x32_bf16 v[136:139], a[208:211], a[56:59], v[136:139]
    buffer_load_dwordx4 a[104:107], v26, s[12:15], s27 offen sc1
    v_mfma_f32_16x16x32_bf16 v[140:143], a[208:211], a[60:63], v[140:143]
    s_add_u32 s27, s54, 55296
    s_waitcnt lgkmcnt(10)
    v_mfma_f32_16x16x32_bf16 v[144:147], a[212:215], a[48:51], v[144:147]
    ds_read_b64_tr_b16 a[236:237], v36 offset:26312
    v_mfma_f32_16x16x32_bf16 v[148:151], a[212:215], a[52:55], v[148:151]
    ds_read_b64_tr_b16 a[238:239], v36 offset:30664
    v_mfma_f32_16x16x32_bf16 v[152:155], a[212:215], a[56:59], v[152:155]
    buffer_load_dwordx4 a[108:111], v26, s[12:15], s27 offen sc1
    v_mfma_f32_16x16x32_bf16 v[156:159], a[212:215], a[60:63], v[156:159]
    s_waitcnt lgkmcnt(10)
    v_mfma_f32_16x16x32_bf16 v[160:163], a[216:219], a[48:51], v[160:163]
    ds_read_b64_tr_b16 a[240:241], v56 offset:12800
    v_mfma_f32_16x16x32_bf16 v[164:167], a[216:219], a[52:55], v[164:167]
    ds_read_b64_tr_b16 a[242:243], v56 offset:14848
    v_mfma_f32_16x16x32_bf16 v[168:171], a[216:219], a[56:59], v[168:171]
    v_mfma_f32_16x16x32_bf16 v[172:175], a[216:219], a[60:63], v[172:175]
    s_waitcnt lgkmcnt(10)
    v_mfma_f32_16x16x32_bf16 v[176:179], a[220:223], a[48:51], v[176:179]
    ds_read_b64_tr_b16 a[244:245], v57 offset:12800
    v_mfma_f32_16x16x32_bf16 v[180:183], a[220:223], a[52:55], v[180:183]
    ds_read_b64_tr_b16 a[246:247], v57 offset:14848
    v_mfma_f32_16x16x32_bf16 v[184:187], a[220:223], a[56:59], v[184:187]
    s_add_u32 s27, s54, 7168
    v_mfma_f32_16x16x32_bf16 v[188:191], a[220:223], a[60:63], v[188:191]
    buffer_load_dwordx4 a[112:115], v26, s[12:15], s27 offen sc1
    s_waitcnt lgkmcnt(10)
    v_mfma_f32_16x16x32_bf16 v[192:195], a[224:227], a[48:51], v[192:195]
    ds_read_b64_tr_b16 a[248:249], v58 offset:12800
    v_mfma_f32_16x16x32_bf16 v[196:199], a[224:227], a[52:55], v[196:199]
    ds_read_b64_tr_b16 a[250:251], v58 offset:14848
    v_mfma_f32_16x16x32_bf16 v[200:203], a[224:227], a[56:59], v[200:203]
    s_add_u32 s27, s54, 23552
    v_mfma_f32_16x16x32_bf16 v[204:207], a[224:227], a[60:63], v[204:207]
    buffer_load_dwordx4 a[116:119], v26, s[12:15], s27 offen sc1
    s_waitcnt lgkmcnt(10)
    v_mfma_f32_16x16x32_bf16 v[208:211], a[228:231], a[48:51], v[208:211]
    ds_read_b64_tr_b16 a[252:253], v59 offset:12800
    v_mfma_f32_16x16x32_bf16 v[212:215], a[228:231], a[52:55], v[212:215]
    ds_read_b64_tr_b16 a[254:255], v59 offset:14848
    v_mfma_f32_16x16x32_bf16 v[216:219], a[228:231], a[56:59], v[216:219]
    v_mfma_f32_16x16x32_bf16 v[220:223], a[228:231], a[60:63], v[220:223]
    s_waitcnt lgkmcnt(10)
    s_waitcnt vmcnt(20)
    s_barrier
    v_mfma_f32_16x16x32_bf16 v[224:227], a[232:235], a[48:51], v[224:227]
    ds_read_b64_tr_b16 a[192:193], v36 offset:34816
    v_mfma_f32_16x16x32_bf16 v[228:231], a[232:235], a[52:55], v[228:231]
    ds_read_b64_tr_b16 a[194:195], v36 offset:39168
    v_mfma_f32_16x16x32_bf16 v[232:235], a[232:235], a[56:59], v[232:235]
    s_add_u32 s27, s54, 39936
    v_mfma_f32_16x16x32_bf16 v[236:239], a[232:235], a[60:63], v[236:239]
    buffer_load_dwordx4 a[120:123], v26, s[12:15], s27 offen sc1
    s_waitcnt lgkmcnt(10)
    v_mfma_f32_16x16x32_bf16 v[240:243], a[236:239], a[48:51], v[240:243]
    ds_read_b64_tr_b16 a[196:197], v36 offset:34824
    v_mfma_f32_16x16x32_bf16 v[244:247], a[236:239], a[52:55], v[244:247]
    ds_read_b64_tr_b16 a[198:199], v36 offset:39176
    v_mfma_f32_16x16x32_bf16 v[248:251], a[236:239], a[56:59], v[248:251]
    s_add_u32 s27, s54, 56320
    v_mfma_f32_16x16x32_bf16 v[252:255], a[236:239], a[60:63], v[252:255]
    buffer_load_dwordx4 a[124:127], v26, s[12:15], s27 offen sc1
    s_waitcnt lgkmcnt(10)
    v_mfma_f32_16x16x32_bf16 v[64:67], a[240:243], a[48:51], v[64:67]
    ds_read_b64_tr_b16 a[200:201], v36 offset:34880
    v_mfma_f32_16x16x32_bf16 v[68:71], a[240:243], a[52:55], v[68:71]
    ds_read_b64_tr_b16 a[202:203], v36 offset:39232
    v_mfma_f32_16x16x32_bf16 v[72:75], a[240:243], a[56:59], v[72:75]
    v_mfma_f32_16x16x32_bf16 v[76:79], a[240:243], a[60:63], v[76:79]
    s_waitcnt lgkmcnt(10)
    v_mfma_f32_16x16x32_bf16 v[80:83], a[244:247], a[48:51], v[80:83]
    ds_read_b64_tr_b16 a[204:205], v36 offset:34888
    v_mfma_f32_16x16x32_bf16 v[84:87], a[244:247], a[52:55], v[84:87]
    ds_read_b64_tr_b16 a[206:207], v36 offset:39240
    v_mfma_f32_16x16x32_bf16 v[88:91], a[244:247], a[56:59], v[88:91]
    s_add_u32 m0, s23, 0
    v_mfma_f32_16x16x32_bf16 v[92:95], a[244:247], a[60:63], v[92:95]
    buffer_load_dwordx4 v60, s[40:43], s52 offen offset:0 lds
    s_waitcnt lgkmcnt(10)
    v_mfma_f32_16x16x32_bf16 v[96:99], a[248:251], a[48:51], v[96:99]
    ds_read_b64_tr_b16 a[208:209], v36 offset:34944
    v_mfma_f32_16x16x32_bf16 v[100:103], a[248:251], a[52:55], v[100:103]
    ds_read_b64_tr_b16 a[210:211], v36 offset:39296
    v_mfma_f32_16x16x32_bf16 v[104:107], a[248:251], a[56:59], v[104:107]
    buffer_load_dwordx4 v61, s[40:43], s52 offen offset:1088 lds
    v_mfma_f32_16x16x32_bf16 v[108:111], a[248:251], a[60:63], v[108:111]
    s_waitcnt lgkmcnt(10)
    v_mfma_f32_16x16x32_bf16 v[112:115], a[252:255], a[48:51], v[112:115]
    ds_read_b64_tr_b16 a[212:213], v36 offset:34952
    v_mfma_f32_16x16x32_bf16 v[116:119], a[252:255], a[52:55], v[116:119]
    ds_read_b64_tr_b16 a[214:215], v36 offset:39304
    v_mfma_f32_16x16x32_bf16 v[120:123], a[252:255], a[56:59], v[120:123]
    v_mfma_f32_16x16x32_bf16 v[124:127], a[252:255], a[60:63], v[124:127]
    s_waitcnt vmcnt(20)
    s_waitcnt lgkmcnt(10)
    v_mfma_f32_16x16x32_bf16 v[128:131], a[192:195], a[64:67], v[128:131]
    ds_read_b64_tr_b16 a[216:217], v36 offset:35008
    v_mfma_f32_16x16x32_bf16 v[132:135], a[192:195], a[68:71], v[132:135]
    ds_read_b64_tr_b16 a[218:219], v36 offset:39360
    v_mfma_f32_16x16x32_bf16 v[136:139], a[192:195], a[72:75], v[136:139]
    buffer_load_dwordx4 v62, s[40:43], s52 offen offset:2176 lds
    v_mfma_f32_16x16x32_bf16 v[140:143], a[192:195], a[76:79], v[140:143]
    s_waitcnt lgkmcnt(10)
    v_mfma_f32_16x16x32_bf16 v[144:147], a[196:199], a[64:67], v[144:147]
    ds_read_b64_tr_b16 a[220:221], v36 offset:35016
    v_mfma_f32_16x16x32_bf16 v[148:151], a[196:199], a[68:71], v[148:151]
    ds_read_b64_tr_b16 a[222:223], v36 offset:39368
    v_mfma_f32_16x16x32_bf16 v[152:155], a[196:199], a[72:75], v[152:155]
    buffer_load_dwordx4 v63, s[40:43], s52 offen offset:3264 lds
    v_mfma_f32_16x16x32_bf16 v[156:159], a[196:199], a[76:79], v[156:159]
    s_waitcnt lgkmcnt(10)
    v_mfma_f32_16x16x32_bf16 v[160:163], a[200:203], a[64:67], v[160:163]
    ds_read_b64_tr_b16 a[224:225], v56 offset:17408
    v_mfma_f32_16x16x32_bf16 v[164:167], a[200:203], a[68:71], v[164:167]
    ds_read_b64_tr_b16 a[226:227], v56 offset:19456
    v_mfma_f32_16x16x32_bf16 v[168:171], a[200:203], a[72:75], v[168:171]
    v_mfma_f32_16x16x32_bf16 v[172:175], a[200:203], a[76:79], v[172:175]
    s_waitcnt lgkmcnt(10)
    v_mfma_f32_16x16x32_bf16 v[176:179], a[204:207], a[64:67], v[176:179]
    ds_read_b64_tr_b16 a[228:229], v57 offset:17408
    v_mfma_f32_16x16x32_bf16 v[180:183], a[204:207], a[68:71], v[180:183]
    ds_read_b64_tr_b16 a[230:231], v57 offset:19456
    v_mfma_f32_16x16x32_bf16 v[184:187], a[204:207], a[72:75], v[184:187]
    s_add_u32 m0, s55, 0
    v_mfma_f32_16x16x32_bf16 v[188:191], a[204:207], a[76:79], v[188:191]
    buffer_load_dwordx4 v38, s[44:47], s53 offen offset:0 lds
    s_waitcnt lgkmcnt(10)
    v_mfma_f32_16x16x32_bf16 v[192:195], a[208:211], a[64:67], v[192:195]
    ds_read_b64_tr_b16 a[232:233], v58 offset:17408
    v_mfma_f32_16x16x32_bf16 v[196:199], a[208:211], a[68:71], v[196:199]
    ds_read_b64_tr_b16 a[234:235], v58 offset:19456
    v_mfma_f32_16x16x32_bf16 v[200:203], a[208:211], a[72:75], v[200:203]
    buffer_load_dwordx4 v39, s[44:47], s53 offen offset:1024 lds
    v_mfma_f32_16x16x32_bf16 v[204:207], a[208:211], a[76:79], v[204:207]
    s_add_u32 s52, s52, 524288
    s_waitcnt lgkmcnt(10)
    v_mfma_f32_16x16x32_bf16 v[208:211], a[212:215], a[64:67], v[208:211]
    ds_read_b64_tr_b16 a[236:237], v59 offset:17408
    v_mfma_f32_16x16x32_bf16 v[212:215], a[212:215], a[68:71], v[212:215]
    ds_read_b64_tr_b16 a[238:239], v59 offset:19456
    v_mfma_f32_16x16x32_bf16 v[216:219], a[212:215], a[72:75], v[216:219]
    v_mfma_f32_16x16x32_bf16 v[220:223], a[212:215], a[76:79], v[220:223]
    s_waitcnt lgkmcnt(10)
    v_mfma_f32_16x16x32_bf16 v[224:227], a[216:219], a[64:67], v[224:227]
    ds_read_b64_tr_b16 a[240:241], v36 offset:43520
    v_mfma_f32_16x16x32_bf16 v[228:231], a[216:219], a[68:71], v[228:231]
    ds_read_b64_tr_b16 a[242:243], v36 offset:47872
    v_mfma_f32_16x16x32_bf16 v[232:235], a[216:219], a[72:75], v[232:235]
    s_add_u32 s53, s53, 229376
    v_mfma_f32_16x16x32_bf16 v[236:239], a[216:219], a[76:79], v[236:239]
    s_add_u32 s27, s54, 8192
    s_waitcnt lgkmcnt(10)
    v_mfma_f32_16x16x32_bf16 v[240:243], a[220:223], a[64:67], v[240:243]
    ds_read_b64_tr_b16 a[244:245], v36 offset:43528
    v_mfma_f32_16x16x32_bf16 v[244:247], a[220:223], a[68:71], v[244:247]
    ds_read_b64_tr_b16 a[246:247], v36 offset:47880
    v_mfma_f32_16x16x32_bf16 v[248:251], a[220:223], a[72:75], v[248:251]
    buffer_load_dwordx4 a[0:3], v26, s[12:15], s27 offen sc1
    v_mfma_f32_16x16x32_bf16 v[252:255], a[220:223], a[76:79], v[252:255]
    s_add_u32 s27, s54, 24576
    s_waitcnt lgkmcnt(10)
    v_mfma_f32_16x16x32_bf16 v[64:67], a[224:227], a[64:67], v[64:67]
    ds_read_b64_tr_b16 a[248:249], v36 offset:43584
    v_mfma_f32_16x16x32_bf16 v[68:71], a[224:227], a[68:71], v[68:71]
    ds_read_b64_tr_b16 a[250:251], v36 offset:47936
    v_mfma_f32_16x16x32_bf16 v[72:75], a[224:227], a[72:75], v[72:75]
    v_mfma_f32_16x16x32_bf16 v[76:79], a[224:227], a[76:79], v[76:79]
    s_waitcnt lgkmcnt(10)
    v_mfma_f32_16x16x32_bf16 v[80:83], a[228:231], a[64:67], v[80:83]
    ds_read_b64_tr_b16 a[252:253], v36 offset:43592
    v_mfma_f32_16x16x32_bf16 v[84:87], a[228:231], a[68:71], v[84:87]
    ds_read_b64_tr_b16 a[254:255], v36 offset:47944
    v_mfma_f32_16x16x32_bf16 v[88:91], a[228:231], a[72:75], v[88:91]
    buffer_load_dwordx4 a[4:7], v26, s[12:15], s27 offen sc1
    v_mfma_f32_16x16x32_bf16 v[92:95], a[228:231], a[76:79], v[92:95]
    s_add_u32 s27, s54, 40960
    s_waitcnt lgkmcnt(10)
    v_mfma_f32_16x16x32_bf16 v[96:99], a[232:235], a[64:67], v[96:99]
    ds_read_b64_tr_b16 a[192:193], v36 offset:43648
    v_mfma_f32_16x16x32_bf16 v[100:103], a[232:235], a[68:71], v[100:103]
    ds_read_b64_tr_b16 a[194:195], v36 offset:48000
    v_mfma_f32_16x16x32_bf16 v[104:107], a[232:235], a[72:75], v[104:107]
    buffer_load_dwordx4 a[8:11], v26, s[12:15], s27 offen sc1
    v_mfma_f32_16x16x32_bf16 v[108:111], a[232:235], a[76:79], v[108:111]
    s_add_u32 s27, s54, 57344
    s_waitcnt lgkmcnt(10)
    v_mfma_f32_16x16x32_bf16 v[112:115], a[236:239], a[64:67], v[112:115]
    ds_read_b64_tr_b16 a[196:197], v36 offset:43656
    v_mfma_f32_16x16x32_bf16 v[116:119], a[236:239], a[68:71], v[116:119]
    ds_read_b64_tr_b16 a[198:199], v36 offset:48008
    v_mfma_f32_16x16x32_bf16 v[120:123], a[236:239], a[72:75], v[120:123]
    v_mfma_f32_16x16x32_bf16 v[124:127], a[236:239], a[76:79], v[124:127]
    s_waitcnt vmcnt(23)
    s_waitcnt lgkmcnt(10)
    v_mfma_f32_16x16x32_bf16 v[128:131], a[240:243], a[80:83], v[128:131]
    ds_read_b64_tr_b16 a[200:201], v36 offset:43712
    v_mfma_f32_16x16x32_bf16 v[132:135], a[240:243], a[84:87], v[132:135]
    ds_read_b64_tr_b16 a[202:203], v36 offset:48064
    v_mfma_f32_16x16x32_bf16 v[136:139], a[240:243], a[88:91], v[136:139]
    buffer_load_dwordx4 a[12:15], v26, s[12:15], s27 offen sc1
    v_mfma_f32_16x16x32_bf16 v[140:143], a[240:243], a[92:95], v[140:143]
    s_waitcnt lgkmcnt(10)
    v_mfma_f32_16x16x32_bf16 v[144:147], a[244:247], a[80:83], v[144:147]
    ds_read_b64_tr_b16 a[204:205], v36 offset:43720
    v_mfma_f32_16x16x32_bf16 v[148:151], a[244:247], a[84:87], v[148:151]
    ds_read_b64_tr_b16 a[206:207], v36 offset:48072
    v_mfma_f32_16x16x32_bf16 v[152:155], a[244:247], a[88:91], v[152:155]
    s_add_u32 s27, s54, 9216
    v_mfma_f32_16x16x32_bf16 v[156:159], a[244:247], a[92:95], v[156:159]
    buffer_load_dwordx4 a[16:19], v26, s[12:15], s27 offen sc1
    s_waitcnt lgkmcnt(10)
    v_mfma_f32_16x16x32_bf16 v[160:163], a[248:251], a[80:83], v[160:163]
    ds_read_b64_tr_b16 a[208:209], v56 offset:21504
    v_mfma_f32_16x16x32_bf16 v[164:167], a[248:251], a[84:87], v[164:167]
    ds_read_b64_tr_b16 a[210:211], v56 offset:23552
    v_mfma_f32_16x16x32_bf16 v[168:171], a[248:251], a[88:91], v[168:171]
    v_mfma_f32_16x16x32_bf16 v[172:175], a[248:251], a[92:95], v[172:175]
    s_waitcnt lgkmcnt(10)
    v_mfma_f32_16x16x32_bf16 v[176:179], a[252:255], a[80:83], v[176:179]
    ds_read_b64_tr_b16 a[212:213], v57 offset:21504
    v_mfma_f32_16x16x32_bf16 v[180:183], a[252:255], a[84:87], v[180:183]
    ds_read_b64_tr_b16 a[214:215], v57 offset:23552
    v_mfma_f32_16x16x32_bf16 v[184:187], a[252:255], a[88:91], v[184:187]
    s_add_u32 s27, s54, 25600
    v_mfma_f32_16x16x32_bf16 v[188:191], a[252:255], a[92:95], v[188:191]
    buffer_load_dwordx4 a[20:23], v26, s[12:15], s27 offen sc1
    s_waitcnt lgkmcnt(10)
    v_mfma_f32_16x16x32_bf16 v[192:195], a[192:195], a[80:83], v[192:195]
    ds_read_b64_tr_b16 a[216:217], v58 offset:21504
    v_mfma_f32_16x16x32_bf16 v[196:199], a[192:195], a[84:87], v[196:199]
    ds_read_b64_tr_b16 a[218:219], v58 offset:23552
    v_mfma_f32_16x16x32_bf16 v[200:203], a[192:195], a[88:91], v[200:203]
    s_add_u32 s27, s54, 41984
    v_mfma_f32_16x16x32_bf16 v[204:207], a[192:195], a[92:95], v[204:207]
    buffer_load_dwordx4 a[24:27], v26, s[12:15], s27 offen sc1
    s_waitcnt lgkmcnt(10)
    v_mfma_f32_16x16x32_bf16 v[208:211], a[196:199], a[80:83], v[208:211]
    ds_read_b64_tr_b16 a[220:221], v59 offset:21504
    v_mfma_f32_16x16x32_bf16 v[212:215], a[196:199], a[84:87], v[212:215]
    ds_read_b64_tr_b16 a[222:223], v59 offset:23552
    v_mfma_f32_16x16x32_bf16 v[216:219], a[196:199], a[88:91], v[216:219]
    v_mfma_f32_16x16x32_bf16 v[220:223], a[196:199], a[92:95], v[220:223]
    s_waitcnt lgkmcnt(10)
    s_waitcnt vmcnt(21)
    s_barrier
    v_mfma_f32_16x16x32_bf16 v[224:227], a[200:203], a[80:83], v[224:227]
    ds_read_b64_tr_b16 a[224:225], v36 offset:52224
    v_mfma_f32_16x16x32_bf16 v[228:231], a[200:203], a[84:87], v[228:231]
    ds_read_b64_tr_b16 a[226:227], v36 offset:56576
    v_mfma_f32_16x16x32_bf16 v[232:235], a[200:203], a[88:91], v[232:235]
    s_add_u32 s27, s54, 58368
    v_mfma_f32_16x16x32_bf16 v[236:239], a[200:203], a[92:95], v[236:239]
    buffer_load_dwordx4 a[28:31], v26, s[12:15], s27 offen sc1
    s_waitcnt lgkmcnt(10)
    v_mfma_f32_16x16x32_bf16 v[240:243], a[204:207], a[80:83], v[240:243]
    ds_read_b64_tr_b16 a[228:229], v36 offset:52232
    v_mfma_f32_16x16x32_bf16 v[244:247], a[204:207], a[84:87], v[244:247]
    ds_read_b64_tr_b16 a[230:231], v36 offset:56584
    v_mfma_f32_16x16x32_bf16 v[248:251], a[204:207], a[88:91], v[248:251]
    s_add_u32 m0, s23, 17408
    v_mfma_f32_16x16x32_bf16 v[252:255], a[204:207], a[92:95], v[252:255]
    buffer_load_dwordx4 v60, s[40:43], s52 offen offset:0 lds
    s_waitcnt lgkmcnt(10)
    v_mfma_f32_16x16x32_bf16 v[64:67], a[208:211], a[80:83], v[64:67]
    ds_read_b64_tr_b16 a[232:233], v36 offset:52288
    v_mfma_f32_16x16x32_bf16 v[68:71], a[208:211], a[84:87], v[68:71]
    ds_read_b64_tr_b16 a[234:235], v36 offset:56640
    v_mfma_f32_16x16x32_bf16 v[72:75], a[208:211], a[88:91], v[72:75]
    v_mfma_f32_16x16x32_bf16 v[76:79], a[208:211], a[92:95], v[76:79]
    s_waitcnt lgkmcnt(10)
    v_mfma_f32_16x16x32_bf16 v[80:83], a[212:215], a[80:83], v[80:83]
    ds_read_b64_tr_b16 a[236:237], v36 offset:52296
    v_mfma_f32_16x16x32_bf16 v[84:87], a[212:215], a[84:87], v[84:87]
    ds_read_b64_tr_b16 a[238:239], v36 offset:56648
    v_mfma_f32_16x16x32_bf16 v[88:91], a[212:215], a[88:91], v[88:91]
    buffer_load_dwordx4 v61, s[40:43], s52 offen offset:1088 lds
    v_mfma_f32_16x16x32_bf16 v[92:95], a[212:215], a[92:95], v[92:95]
    s_waitcnt lgkmcnt(10)
    v_mfma_f32_16x16x32_bf16 v[96:99], a[216:219], a[80:83], v[96:99]
    ds_read_b64_tr_b16 a[240:241], v36 offset:52352
    v_mfma_f32_16x16x32_bf16 v[100:103], a[216:219], a[84:87], v[100:103]
    ds_read_b64_tr_b16 a[242:243], v36 offset:56704
    v_mfma_f32_16x16x32_bf16 v[104:107], a[216:219], a[88:91], v[104:107]
    buffer_load_dwordx4 v62, s[40:43], s52 offen offset:2176 lds
    v_mfma_f32_16x16x32_bf16 v[108:111], a[216:219], a[92:95], v[108:111]
    s_waitcnt lgkmcnt(10)
    v_mfma_f32_16x16x32_bf16 v[112:115], a[220:223], a[80:83], v[112:115]
    ds_read_b64_tr_b16 a[244:245], v36 offset:52360
    v_mfma_f32_16x16x32_bf16 v[116:119], a[220:223], a[84:87], v[116:119]
    ds_read_b64_tr_b16 a[246:247], v36 offset:56712
    v_mfma_f32_16x16x32_bf16 v[120:123], a[220:223], a[88:91], v[120:123]
    v_mfma_f32_16x16x32_bf16 v[124:127], a[220:223], a[92:95], v[124:127]
    s_waitcnt vmcnt(21)
    s_waitcnt lgkmcnt(10)
    v_mfma_f32_16x16x32_bf16 v[128:131], a[224:227], a[96:99], v[128:131]
    ds_read_b64_tr_b16 a[248:249], v36 offset:52416
    v_mfma_f32_16x16x32_bf16 v[132:135], a[224:227], a[100:103], v[132:135]
    ds_read_b64_tr_b16 a[250:251], v36 offset:56768
    v_mfma_f32_16x16x32_bf16 v[136:139], a[224:227], a[104:107], v[136:139]
    buffer_load_dwordx4 v63, s[40:43], s52 offen offset:3264 lds
    v_mfma_f32_16x16x32_bf16 v[140:143], a[224:227], a[108:111], v[140:143]
    s_waitcnt lgkmcnt(10)
    v_mfma_f32_16x16x32_bf16 v[144:147], a[228:231], a[96:99], v[144:147]
    ds_read_b64_tr_b16 a[252:253], v36 offset:52424
    v_mfma_f32_16x16x32_bf16 v[148:151], a[228:231], a[100:103], v[148:151]
    ds_read_b64_tr_b16 a[254:255], v36 offset:56776
    v_mfma_f32_16x16x32_bf16 v[152:155], a[228:231], a[104:107], v[152:155]
    s_add_u32 m0, s55, 8704
    v_mfma_f32_16x16x32_bf16 v[156:159], a[228:231], a[108:111], v[156:159]
    buffer_load_dwordx4 v38, s[44:47], s53 offen offset:0 lds
    s_waitcnt lgkmcnt(10)
    v_mfma_f32_16x16x32_bf16 v[160:163], a[232:235], a[96:99], v[160:163]
    ds_read_b64_tr_b16 a[192:193], v56 offset:26112
    v_mfma_f32_16x16x32_bf16 v[164:167], a[232:235], a[100:103], v[164:167]
    ds_read_b64_tr_b16 a[194:195], v56 offset:28160
    v_mfma_f32_16x16x32_bf16 v[168:171], a[232:235], a[104:107], v[168:171]
    v_mfma_f32_16x16x32_bf16 v[172:175], a[232:235], a[108:111], v[172:175]
    s_waitcnt lgkmcnt(10)
    v_mfma_f32_16x16x32_bf16 v[176:179], a[236:239], a[96:99], v[176:179]
    ds_read_b64_tr_b16 a[196:197], v57 offset:26112
    v_mfma_f32_16x16x32_bf16 v[180:183], a[236:239], a[100:103], v[180:183]
    ds_read_b64_tr_b16 a[198:199], v57 offset:28160
    v_mfma_f32_16x16x32_bf16 v[184:187], a[236:239], a[104:107], v[184:187]
    buffer_load_dwordx4 v39, s[44:47], s53 offen offset:1024 lds
    v_mfma_f32_16x16x32_bf16 v[188:191], a[236:239], a[108:111], v[188:191]
    s_add_u32 s52, s52, 524288
    s_waitcnt lgkmcnt(10)
    v_mfma_f32_16x16x32_bf16 v[192:195], a[240:243], a[96:99], v[192:195]
    ds_read_b64_tr_b16 a[200:201], v58 offset:26112
    v_mfma_f32_16x16x32_bf16 v[196:199], a[240:243], a[100:103], v[196:199]
    ds_read_b64_tr_b16 a[202:203], v58 offset:28160
    v_mfma_f32_16x16x32_bf16 v[200:203], a[240:243], a[104:107], v[200:203]
    s_add_u32 s53, s53, 229376
    v_mfma_f32_16x16x32_bf16 v[204:207], a[240:243], a[108:111], v[204:207]
    s_add_u32 s27, s54, 10240
    s_waitcnt lgkmcnt(10)
    v_mfma_f32_16x16x32_bf16 v[208:211], a[244:247], a[96:99], v[208:211]
    ds_read_b64_tr_b16 a[204:205], v59 offset:26112
    v_mfma_f32_16x16x32_bf16 v[212:215], a[244:247], a[100:103], v[212:215]
    ds_read_b64_tr_b16 a[206:207], v59 offset:28160
    v_mfma_f32_16x16x32_bf16 v[216:219], a[244:247], a[104:107], v[216:219]
    v_mfma_f32_16x16x32_bf16 v[220:223], a[244:247], a[108:111], v[220:223]
    s_waitcnt lgkmcnt(10)
    v_mfma_f32_16x16x32_bf16 v[224:227], a[248:251], a[96:99], v[224:227]
    ds_read_b64_tr_b16 a[208:209], v36 offset:60928
    v_mfma_f32_16x16x32_bf16 v[228:231], a[248:251], a[100:103], v[228:231]
    ds_read_b64_tr_b16 a[210:211], v36 offset:65280
    v_mfma_f32_16x16x32_bf16 v[232:235], a[248:251], a[104:107], v[232:235]
    buffer_load_dwordx4 a[32:35], v26, s[12:15], s27 offen sc1
    v_mfma_f32_16x16x32_bf16 v[236:239], a[248:251], a[108:111], v[236:239]
    s_add_u32 s27, s54, 26624
    s_waitcnt lgkmcnt(10)
    v_mfma_f32_16x16x32_bf16 v[240:243], a[252:255], a[96:99], v[240:243]
    ds_read_b64_tr_b16 a[212:213], v36 offset:60936
    v_mfma_f32_16x16x32_bf16 v[244:247], a[252:255], a[100:103], v[244:247]
    ds_read_b64_tr_b16 a[214:215], v36 offset:65288
    v_mfma_f32_16x16x32_bf16 v[248:251], a[252:255], a[104:107], v[248:251]
    buffer_load_dwordx4 a[36:39], v26, s[12:15], s27 offen sc1
    v_mfma_f32_16x16x32_bf16 v[252:255], a[252:255], a[108:111], v[252:255]
    s_add_u32 s27, s54, 43008
    s_waitcnt lgkmcnt(10)
    v_mfma_f32_16x16x32_bf16 v[64:67], a[192:195], a[96:99], v[64:67]
    ds_read_b64_tr_b16 a[216:217], v36 offset:60992
    v_mfma_f32_16x16x32_bf16 v[68:71], a[192:195], a[100:103], v[68:71]
    ds_read_b64_tr_b16 a[218:219], v36 offset:65344
    v_mfma_f32_16x16x32_bf16 v[72:75], a[192:195], a[104:107], v[72:75]
    v_mfma_f32_16x16x32_bf16 v[76:79], a[192:195], a[108:111], v[76:79]
    s_waitcnt lgkmcnt(10)
    v_mfma_f32_16x16x32_bf16 v[80:83], a[196:199], a[96:99], v[80:83]
    ds_read_b64_tr_b16 a[220:221], v36 offset:61000
    v_mfma_f32_16x16x32_bf16 v[84:87], a[196:199], a[100:103], v[84:87]
    ds_read_b64_tr_b16 a[222:223], v36 offset:65352
    v_mfma_f32_16x16x32_bf16 v[88:91], a[196:199], a[104:107], v[88:91]
    buffer_load_dwordx4 a[40:43], v26, s[12:15], s27 offen sc1
    v_mfma_f32_16x16x32_bf16 v[92:95], a[196:199], a[108:111], v[92:95]
    s_add_u32 s27, s54, 59392
    s_waitcnt lgkmcnt(10)
    v_mfma_f32_16x16x32_bf16 v[96:99], a[200:203], a[96:99], v[96:99]
    ds_read_b64_tr_b16 a[224:225], v36 offset:61056
    v_mfma_f32_16x16x32_bf16 v[100:103], a[200:203], a[100:103], v[100:103]
    ds_read_b64_tr_b16 a[226:227], v36 offset:65408
    v_mfma_f32_16x16x32_bf16 v[104:107], a[200:203], a[104:107], v[104:107]
    buffer_load_dwordx4 a[44:47], v26, s[12:15], s27 offen sc1
    v_mfma_f32_16x16x32_bf16 v[108:111], a[200:203], a[108:111], v[108:111]
    s_waitcnt lgkmcnt(10)
    v_mfma_f32_16x16x32_bf16 v[112:115], a[204:207], a[96:99], v[112:115]
    ds_read_b64_tr_b16 a[228:229], v36 offset:61064
    v_mfma_f32_16x16x32_bf16 v[116:119], a[204:207], a[100:103], v[116:119]
    ds_read_b64_tr_b16 a[230:231], v36 offset:65416
    v_mfma_f32_16x16x32_bf16 v[120:123], a[204:207], a[104:107], v[120:123]
    v_mfma_f32_16x16x32_bf16 v[124:127], a[204:207], a[108:111], v[124:127]
    s_waitcnt vmcnt(24)
    s_waitcnt lgkmcnt(10)
    v_mfma_f32_16x16x32_bf16 v[128:131], a[208:211], a[112:115], v[128:131]
    ds_read_b64_tr_b16 a[232:233], v36 offset:61120
    v_mfma_f32_16x16x32_bf16 v[132:135], a[208:211], a[116:119], v[132:135]
    ds_read_b64_tr_b16 a[234:235], v36 offset:65472
    v_mfma_f32_16x16x32_bf16 v[136:139], a[208:211], a[120:123], v[136:139]
    s_add_u32 s27, s54, 11264
    v_mfma_f32_16x16x32_bf16 v[140:143], a[208:211], a[124:127], v[140:143]
    buffer_load_dwordx4 a[48:51], v26, s[12:15], s27 offen sc1
    s_waitcnt lgkmcnt(10)
    v_mfma_f32_16x16x32_bf16 v[144:147], a[212:215], a[112:115], v[144:147]
    ds_read_b64_tr_b16 a[236:237], v36 offset:61128
    v_mfma_f32_16x16x32_bf16 v[148:151], a[212:215], a[116:119], v[148:151]
    ds_read_b64_tr_b16 a[238:239], v36 offset:65480
    v_mfma_f32_16x16x32_bf16 v[152:155], a[212:215], a[120:123], v[152:155]
    s_add_u32 s27, s54, 27648
    v_mfma_f32_16x16x32_bf16 v[156:159], a[212:215], a[124:127], v[156:159]
    buffer_load_dwordx4 a[52:55], v26, s[12:15], s27 offen sc1
    s_waitcnt lgkmcnt(10)
    v_mfma_f32_16x16x32_bf16 v[160:163], a[216:219], a[112:115], v[160:163]
    ds_read_b64_tr_b16 a[240:241], v56 offset:30208
    v_mfma_f32_16x16x32_bf16 v[164:167], a[216:219], a[116:119], v[164:167]
    ds_read_b64_tr_b16 a[242:243], v56 offset:32256
    v_mfma_f32_16x16x32_bf16 v[168:171], a[216:219], a[120:123], v[168:171]
    v_mfma_f32_16x16x32_bf16 v[172:175], a[216:219], a[124:127], v[172:175]
    s_waitcnt lgkmcnt(10)
    v_mfma_f32_16x16x32_bf16 v[176:179], a[220:223], a[112:115], v[176:179]
    ds_read_b64_tr_b16 a[244:245], v57 offset:30208
    v_mfma_f32_16x16x32_bf16 v[180:183], a[220:223], a[116:119], v[180:183]
    ds_read_b64_tr_b16 a[246:247], v57 offset:32256
    v_mfma_f32_16x16x32_bf16 v[184:187], a[220:223], a[120:123], v[184:187]
    s_add_u32 s27, s54, 44032
    v_mfma_f32_16x16x32_bf16 v[188:191], a[220:223], a[124:127], v[188:191]
    buffer_load_dwordx4 a[56:59], v26, s[12:15], s27 offen sc1
    s_waitcnt lgkmcnt(10)
    v_mfma_f32_16x16x32_bf16 v[192:195], a[224:227], a[112:115], v[192:195]
    ds_read_b64_tr_b16 a[248:249], v58 offset:30208
    v_mfma_f32_16x16x32_bf16 v[196:199], a[224:227], a[116:119], v[196:199]
    ds_read_b64_tr_b16 a[250:251], v58 offset:32256
    v_mfma_f32_16x16x32_bf16 v[200:203], a[224:227], a[120:123], v[200:203]
    s_add_u32 s27, s54, 60416
    v_mfma_f32_16x16x32_bf16 v[204:207], a[224:227], a[124:127], v[204:207]
    buffer_load_dwordx4 a[60:63], v26, s[12:15], s27 offen sc1
    s_waitcnt lgkmcnt(10)
    v_mfma_f32_16x16x32_bf16 v[208:211], a[228:231], a[112:115], v[208:211]
    ds_read_b64_tr_b16 a[252:253], v59 offset:30208
    v_mfma_f32_16x16x32_bf16 v[212:215], a[228:231], a[116:119], v[212:215]
    ds_read_b64_tr_b16 a[254:255], v59 offset:32256
    v_mfma_f32_16x16x32_bf16 v[216:219], a[228:231], a[120:123], v[216:219]
    v_mfma_f32_16x16x32_bf16 v[220:223], a[228:231], a[124:127], v[220:223]
    s_waitcnt lgkmcnt(10)
    s_waitcnt vmcnt(22)
    s_barrier
    v_mfma_f32_16x16x32_bf16 v[224:227], a[232:235], a[112:115], v[224:227]
    ds_read_b64_tr_b16 a[192:193], v36 offset:0
    v_mfma_f32_16x16x32_bf16 v[228:231], a[232:235], a[116:119], v[228:231]
    ds_read_b64_tr_b16 a[194:195], v36 offset:4352
    v_mfma_f32_16x16x32_bf16 v[232:235], a[232:235], a[120:123], v[232:235]
    s_add_u32 m0, s23, 34816
    v_mfma_f32_16x16x32_bf16 v[236:239], a[232:235], a[124:127], v[236:239]
    buffer_load_dwordx4 v60, s[40:43], s52 offen offset:0 lds
    s_waitcnt lgkmcnt(10)
    v_mfma_f32_16x16x32_bf16 v[240:243], a[236:239], a[112:115], v[240:243]
    ds_read_b64_tr_b16 a[196:197], v36 offset:8
    v_mfma_f32_16x16x32_bf16 v[244:247], a[236:239], a[116:119], v[244:247]
    ds_read_b64_tr_b16 a[198:199], v36 offset:4360
    v_mfma_f32_16x16x32_bf16 v[248:251], a[236:239], a[120:123], v[248:251]
    buffer_load_dwordx4 v61, s[40:43], s52 offen offset:1088 lds
    v_mfma_f32_16x16x32_bf16 v[252:255], a[236:239], a[124:127], v[252:255]
    s_waitcnt lgkmcnt(10)
    v_mfma_f32_16x16x32_bf16 v[64:67], a[240:243], a[112:115], v[64:67]
    ds_read_b64_tr_b16 a[200:201], v36 offset:64
    v_mfma_f32_16x16x32_bf16 v[68:71], a[240:243], a[116:119], v[68:71]
    ds_read_b64_tr_b16 a[202:203], v36 offset:4416
    v_mfma_f32_16x16x32_bf16 v[72:75], a[240:243], a[120:123], v[72:75]
    v_mfma_f32_16x16x32_bf16 v[76:79], a[240:243], a[124:127], v[76:79]
    s_waitcnt lgkmcnt(10)
    v_mfma_f32_16x16x32_bf16 v[80:83], a[244:247], a[112:115], v[80:83]
    ds_read_b64_tr_b16 a[204:205], v36 offset:72
    v_mfma_f32_16x16x32_bf16 v[84:87], a[244:247], a[116:119], v[84:87]
    ds_read_b64_tr_b16 a[206:207], v36 offset:4424
    v_mfma_f32_16x16x32_bf16 v[88:91], a[244:247], a[120:123], v[88:91]
    buffer_load_dwordx4 v62, s[40:43], s52 offen offset:2176 lds
    v_mfma_f32_16x16x32_bf16 v[92:95], a[244:247], a[124:127], v[92:95]
    s_waitcnt lgkmcnt(10)
    v_mfma_f32_16x16x32_bf16 v[96:99], a[248:251], a[112:115], v[96:99]
    ds_read_b64_tr_b16 a[208:209], v36 offset:128
    v_mfma_f32_16x16x32_bf16 v[100:103], a[248:251], a[116:119], v[100:103]
    ds_read_b64_tr_b16 a[210:211], v36 offset:4480
    v_mfma_f32_16x16x32_bf16 v[104:107], a[248:251], a[120:123], v[104:107]
    buffer_load_dwordx4 v63, s[40:43], s52 offen offset:3264 lds
    v_mfma_f32_16x16x32_bf16 v[108:111], a[248:251], a[124:127], v[108:111]
    s_waitcnt lgkmcnt(10)
    v_mfma_f32_16x16x32_bf16 v[112:115], a[252:255], a[112:115], v[112:115]
    ds_read_b64_tr_b16 a[212:213], v36 offset:136
    v_mfma_f32_16x16x32_bf16 v[116:119], a[252:255], a[116:119], v[116:119]
    ds_read_b64_tr_b16 a[214:215], v36 offset:4488
    v_mfma_f32_16x16x32_bf16 v[120:123], a[252:255], a[120:123], v[120:123]
    v_mfma_f32_16x16x32_bf16 v[124:127], a[252:255], a[124:127], v[124:127]
    s_waitcnt vmcnt(22)
    s_waitcnt lgkmcnt(10)
    v_mfma_f32_16x16x32_bf16 v[128:131], a[192:195], a[0:3], v[128:131]
    ds_read_b64_tr_b16 a[216:217], v36 offset:192
    v_mfma_f32_16x16x32_bf16 v[132:135], a[192:195], a[4:7], v[132:135]
    ds_read_b64_tr_b16 a[218:219], v36 offset:4544
    v_mfma_f32_16x16x32_bf16 v[136:139], a[192:195], a[8:11], v[136:139]
    s_add_u32 m0, s55, 17408
    v_mfma_f32_16x16x32_bf16 v[140:143], a[192:195], a[12:15], v[140:143]
    buffer_load_dwordx4 v38, s[44:47], s53 offen offset:0 lds
    s_waitcnt lgkmcnt(10)
    v_mfma_f32_16x16x32_bf16 v[144:147], a[196:199], a[0:3], v[144:147]
    ds_read_b64_tr_b16 a[220:221], v36 offset:200
    v_mfma_f32_16x16x32_bf16 v[148:151], a[196:199], a[4:7], v[148:151]
    ds_read_b64_tr_b16 a[222:223], v36 offset:4552
    v_mfma_f32_16x16x32_bf16 v[152:155], a[196:199], a[8:11], v[152:155]
    buffer_load_dwordx4 v39, s[44:47], s53 offen offset:1024 lds
    v_mfma_f32_16x16x32_bf16 v[156:159], a[196:199], a[12:15], v[156:159]
    s_add_u32 s52, s52, 524288
    s_waitcnt lgkmcnt(10)
    v_mfma_f32_16x16x32_bf16 v[160:163], a[200:203], a[0:3], v[160:163]
    ds_read_b64_tr_b16 a[224:225], v56 offset:0
    v_mfma_f32_16x16x32_bf16 v[164:167], a[200:203], a[4:7], v[164:167]
    ds_read_b64_tr_b16 a[226:227], v56 offset:2048
    v_mfma_f32_16x16x32_bf16 v[168:171], a[200:203], a[8:11], v[168:171]
    v_mfma_f32_16x16x32_bf16 v[172:175], a[200:203], a[12:15], v[172:175]
    s_waitcnt lgkmcnt(10)
    v_mfma_f32_16x16x32_bf16 v[176:179], a[204:207], a[0:3], v[176:179]
    ds_read_b64_tr_b16 a[228:229], v57 offset:0
    v_mfma_f32_16x16x32_bf16 v[180:183], a[204:207], a[4:7], v[180:183]
    ds_read_b64_tr_b16 a[230:231], v57 offset:2048
    v_mfma_f32_16x16x32_bf16 v[184:187], a[204:207], a[8:11], v[184:187]
    s_add_u32 s53, s53, 229376
    v_mfma_f32_16x16x32_bf16 v[188:191], a[204:207], a[12:15], v[188:191]
    s_add_u32 s27, s54, 12288
    s_waitcnt lgkmcnt(10)
    v_mfma_f32_16x16x32_bf16 v[192:195], a[208:211], a[0:3], v[192:195]
    ds_read_b64_tr_b16 a[232:233], v58 offset:0
    v_mfma_f32_16x16x32_bf16 v[196:199], a[208:211], a[4:7], v[196:199]
    ds_read_b64_tr_b16 a[234:235], v58 offset:2048
    v_mfma_f32_16x16x32_bf16 v[200:203], a[208:211], a[8:11], v[200:203]
    buffer_load_dwordx4 a[64:67], v26, s[12:15], s27 offen sc1
    v_mfma_f32_16x16x32_bf16 v[204:207], a[208:211], a[12:15], v[204:207]
    s_add_u32 s27, s54, 28672
    s_waitcnt lgkmcnt(10)
    v_mfma_f32_16x16x32_bf16 v[208:211], a[212:215], a[0:3], v[208:211]
    ds_read_b64_tr_b16 a[236:237], v59 offset:0
    v_mfma_f32_16x16x32_bf16 v[212:215], a[212:215], a[4:7], v[212:215]
    ds_read_b64_tr_b16 a[238:239], v59 offset:2048
    v_mfma_f32_16x16x32_bf16 v[216:219], a[212:215], a[8:11], v[216:219]
    v_mfma_f32_16x16x32_bf16 v[220:223], a[212:215], a[12:15], v[220:223]
    s_waitcnt lgkmcnt(10)
    v_mfma_f32_16x16x32_bf16 v[224:227], a[216:219], a[0:3], v[224:227]
    ds_read_b64_tr_b16 a[240:241], v36 offset:8704
    v_mfma_f32_16x16x32_bf16 v[228:231], a[216:219], a[4:7], v[228:231]
    ds_read_b64_tr_b16 a[242:243], v36 offset:13056
    v_mfma_f32_16x16x32_bf16 v[232:235], a[216:219], a[8:11], v[232:235]
    buffer_load_dwordx4 a[68:71], v26, s[12:15], s27 offen sc1
    v_mfma_f32_16x16x32_bf16 v[236:239], a[216:219], a[12:15], v[236:239]
    s_add_u32 s27, s54, 45056
    s_waitcnt lgkmcnt(10)
    v_mfma_f32_16x16x32_bf16 v[240:243], a[220:223], a[0:3], v[240:243]
    ds_read_b64_tr_b16 a[244:245], v36 offset:8712
    v_mfma_f32_16x16x32_bf16 v[244:247], a[220:223], a[4:7], v[244:247]
    ds_read_b64_tr_b16 a[246:247], v36 offset:13064
    v_mfma_f32_16x16x32_bf16 v[248:251], a[220:223], a[8:11], v[248:251]
    buffer_load_dwordx4 a[72:75], v26, s[12:15], s27 offen sc1
    v_mfma_f32_16x16x32_bf16 v[252:255], a[220:223], a[12:15], v[252:255]
    s_add_u32 s27, s54, 61440
    s_waitcnt lgkmcnt(10)
    v_mfma_f32_16x16x32_bf16 v[64:67], a[224:227], a[0:3], v[64:67]
    ds_read_b64_tr_b16 a[248:249], v36 offset:8768
    v_mfma_f32_16x16x32_bf16 v[68:71], a[224:227], a[4:7], v[68:71]
    ds_read_b64_tr_b16 a[250:251], v36 offset:13120
    v_mfma_f32_16x16x32_bf16 v[72:75], a[224:227], a[8:11], v[72:75]
    v_mfma_f32_16x16x32_bf16 v[76:79], a[224:227], a[12:15], v[76:79]
    s_waitcnt lgkmcnt(10)
    v_mfma_f32_16x16x32_bf16 v[80:83], a[228:231], a[0:3], v[80:83]
    ds_read_b64_tr_b16 a[252:253], v36 offset:8776
    v_mfma_f32_16x16x32_bf16 v[84:87], a[228:231], a[4:7], v[84:87]
    ds_read_b64_tr_b16 a[254:255], v36 offset:13128
    v_mfma_f32_16x16x32_bf16 v[88:91], a[228:231], a[8:11], v[88:91]
    buffer_load_dwordx4 a[76:79], v26, s[12:15], s27 offen sc1
    v_mfma_f32_16x16x32_bf16 v[92:95], a[228:231], a[12:15], v[92:95]
    s_waitcnt lgkmcnt(10)
    v_mfma_f32_16x16x32_bf16 v[96:99], a[232:235], a[0:3], v[96:99]
    ds_read_b64_tr_b16 a[192:193], v36 offset:8832
    v_mfma_f32_16x16x32_bf16 v[100:103], a[232:235], a[4:7], v[100:103]
    ds_read_b64_tr_b16 a[194:195], v36 offset:13184
    v_mfma_f32_16x16x32_bf16 v[104:107], a[232:235], a[8:11], v[104:107]
    s_add_u32 s27, s54, 13312
    v_mfma_f32_16x16x32_bf16 v[108:111], a[232:235], a[12:15], v[108:111]
    buffer_load_dwordx4 a[80:83], v26, s[12:15], s27 offen sc1
    s_waitcnt lgkmcnt(10)
    v_mfma_f32_16x16x32_bf16 v[112:115], a[236:239], a[0:3], v[112:115]
    ds_read_b64_tr_b16 a[196:197], v36 offset:8840
    v_mfma_f32_16x16x32_bf16 v[116:119], a[236:239], a[4:7], v[116:119]
    ds_read_b64_tr_b16 a[198:199], v36 offset:13192
    v_mfma_f32_16x16x32_bf16 v[120:123], a[236:239], a[8:11], v[120:123]
    v_mfma_f32_16x16x32_bf16 v[124:127], a[236:239], a[12:15], v[124:127]
    s_waitcnt vmcnt(25)
    s_waitcnt lgkmcnt(10)
    v_mfma_f32_16x16x32_bf16 v[128:131], a[240:243], a[16:19], v[128:131]
    ds_read_b64_tr_b16 a[200:201], v36 offset:8896
    v_mfma_f32_16x16x32_bf16 v[132:135], a[240:243], a[20:23], v[132:135]
    ds_read_b64_tr_b16 a[202:203], v36 offset:13248
    v_mfma_f32_16x16x32_bf16 v[136:139], a[240:243], a[24:27], v[136:139]
    s_add_u32 s27, s54, 29696
    v_mfma_f32_16x16x32_bf16 v[140:143], a[240:243], a[28:31], v[140:143]
    buffer_load_dwordx4 a[84:87], v26, s[12:15], s27 offen sc1
    s_waitcnt lgkmcnt(10)
    v_mfma_f32_16x16x32_bf16 v[144:147], a[244:247], a[16:19], v[144:147]
    ds_read_b64_tr_b16 a[204:205], v36 offset:8904
    v_mfma_f32_16x16x32_bf16 v[148:151], a[244:247], a[20:23], v[148:151]
    ds_read_b64_tr_b16 a[206:207], v36 offset:13256
    v_mfma_f32_16x16x32_bf16 v[152:155], a[244:247], a[24:27], v[152:155]
    s_add_u32 s27, s54, 46080
    v_mfma_f32_16x16x32_bf16 v[156:159], a[244:247], a[28:31], v[156:159]
    buffer_load_dwordx4 a[88:91], v26, s[12:15], s27 offen sc1
    s_waitcnt lgkmcnt(10)
    v_mfma_f32_16x16x32_bf16 v[160:163], a[248:251], a[16:19], v[160:163]
    ds_read_b64_tr_b16 a[208:209], v56 offset:4096
    v_mfma_f32_16x16x32_bf16 v[164:167], a[248:251], a[20:23], v[164:167]
    ds_read_b64_tr_b16 a[210:211], v56 offset:6144
    v_mfma_f32_16x16x32_bf16 v[168:171], a[248:251], a[24:27], v[168:171]
    v_mfma_f32_16x16x32_bf16 v[172:175], a[248:251], a[28:31], v[172:175]
    s_waitcnt lgkmcnt(10)
    v_mfma_f32_16x16x32_bf16 v[176:179], a[252:255], a[16:19], v[176:179]
    ds_read_b64_tr_b16 a[212:213], v57 offset:4096
    v_mfma_f32_16x16x32_bf16 v[180:183], a[252:255], a[20:23], v[180:183]
    ds_read_b64_tr_b16 a[214:215], v57 offset:6144
    v_mfma_f32_16x16x32_bf16 v[184:187], a[252:255], a[24:27], v[184:187]
    s_add_u32 s27, s54, 62464
    v_mfma_f32_16x16x32_bf16 v[188:191], a[252:255], a[28:31], v[188:191]
    buffer_load_dwordx4 a[92:95], v26, s[12:15], s27 offen sc1
    s_waitcnt lgkmcnt(10)
    v_mfma_f32_16x16x32_bf16 v[192:195], a[192:195], a[16:19], v[192:195]
    ds_read_b64_tr_b16 a[216:217], v58 offset:4096
    v_mfma_f32_16x16x32_bf16 v[196:199], a[192:195], a[20:23], v[196:199]
    ds_read_b64_tr_b16 a[218:219], v58 offset:6144
    v_mfma_f32_16x16x32_bf16 v[200:203], a[192:195], a[24:27], v[200:203]
    s_add_u32 s27, s54, 14336
    v_mfma_f32_16x16x32_bf16 v[204:207], a[192:195], a[28:31], v[204:207]
    buffer_load_dwordx4 a[96:99], v26, s[12:15], s27 offen sc1
    s_waitcnt lgkmcnt(10)
    v_mfma_f32_16x16x32_bf16 v[208:211], a[196:199], a[16:19], v[208:211]
    ds_read_b64_tr_b16 a[220:221], v59 offset:4096
    v_mfma_f32_16x16x32_bf16 v[212:215], a[196:199], a[20:23], v[212:215]
    ds_read_b64_tr_b16 a[222:223], v59 offset:6144
    v_mfma_f32_16x16x32_bf16 v[216:219], a[196:199], a[24:27], v[216:219]
    v_mfma_f32_16x16x32_bf16 v[220:223], a[196:199], a[28:31], v[220:223]
    s_waitcnt lgkmcnt(10)
    s_waitcnt vmcnt(23)
    s_barrier
    v_mfma_f32_16x16x32_bf16 v[224:227], a[200:203], a[16:19], v[224:227]
    ds_read_b64_tr_b16 a[224:225], v36 offset:17408
    v_mfma_f32_16x16x32_bf16 v[228:231], a[200:203], a[20:23], v[228:231]
    ds_read_b64_tr_b16 a[226:227], v36 offset:21760
    v_mfma_f32_16x16x32_bf16 v[232:235], a[200:203], a[24:27], v[232:235]
    s_add_u32 s27, s54, 30720
    v_mfma_f32_16x16x32_bf16 v[236:239], a[200:203], a[28:31], v[236:239]
    buffer_load_dwordx4 a[100:103], v26, s[12:15], s27 offen sc1
    s_waitcnt lgkmcnt(10)
    v_mfma_f32_16x16x32_bf16 v[240:243], a[204:207], a[16:19], v[240:243]
    ds_read_b64_tr_b16 a[228:229], v36 offset:17416
    v_mfma_f32_16x16x32_bf16 v[244:247], a[204:207], a[20:23], v[244:247]
    ds_read_b64_tr_b16 a[230:231], v36 offset:21768
    v_mfma_f32_16x16x32_bf16 v[248:251], a[204:207], a[24:27], v[248:251]
    s_add_u32 s27, s54, 47104
    v_mfma_f32_16x16x32_bf16 v[252:255], a[204:207], a[28:31], v[252:255]
    buffer_load_dwordx4 a[104:107], v26, s[12:15], s27 offen sc1
    s_waitcnt lgkmcnt(10)
    v_mfma_f32_16x16x32_bf16 v[64:67], a[208:211], a[16:19], v[64:67]
    ds_read_b64_tr_b16 a[232:233], v36 offset:17472
    v_mfma_f32_16x16x32_bf16 v[68:71], a[208:211], a[20:23], v[68:71]
    ds_read_b64_tr_b16 a[234:235], v36 offset:21824
    v_mfma_f32_16x16x32_bf16 v[72:75], a[208:211], a[24:27], v[72:75]
    v_mfma_f32_16x16x32_bf16 v[76:79], a[208:211], a[28:31], v[76:79]
    s_waitcnt lgkmcnt(10)
    v_mfma_f32_16x16x32_bf16 v[80:83], a[212:215], a[16:19], v[80:83]
    ds_read_b64_tr_b16 a[236:237], v36 offset:17480
    v_mfma_f32_16x16x32_bf16 v[84:87], a[212:215], a[20:23], v[84:87]
    ds_read_b64_tr_b16 a[238:239], v36 offset:21832
    v_mfma_f32_16x16x32_bf16 v[88:91], a[212:215], a[24:27], v[88:91]
    s_add_u32 s27, s54, 63488
    v_mfma_f32_16x16x32_bf16 v[92:95], a[212:215], a[28:31], v[92:95]
    buffer_load_dwordx4 a[108:111], v26, s[12:15], s27 offen sc1
    s_waitcnt lgkmcnt(10)
    v_mfma_f32_16x16x32_bf16 v[96:99], a[216:219], a[16:19], v[96:99]
    ds_read_b64_tr_b16 a[240:241], v36 offset:17536
    v_mfma_f32_16x16x32_bf16 v[100:103], a[216:219], a[20:23], v[100:103]
    ds_read_b64_tr_b16 a[242:243], v36 offset:21888
    v_mfma_f32_16x16x32_bf16 v[104:107], a[216:219], a[24:27], v[104:107]
    s_add_u32 m0, s23, 52224
    v_mfma_f32_16x16x32_bf16 v[108:111], a[216:219], a[28:31], v[108:111]
    buffer_load_dwordx4 v60, s[40:43], s52 offen offset:0 lds
    s_waitcnt lgkmcnt(10)
    v_mfma_f32_16x16x32_bf16 v[112:115], a[220:223], a[16:19], v[112:115]
    ds_read_b64_tr_b16 a[244:245], v36 offset:17544
    v_mfma_f32_16x16x32_bf16 v[116:119], a[220:223], a[20:23], v[116:119]
    ds_read_b64_tr_b16 a[246:247], v36 offset:21896
    v_mfma_f32_16x16x32_bf16 v[120:123], a[220:223], a[24:27], v[120:123]
    v_mfma_f32_16x16x32_bf16 v[124:127], a[220:223], a[28:31], v[124:127]
    s_waitcnt vmcnt(23)
    s_waitcnt lgkmcnt(10)
    v_mfma_f32_16x16x32_bf16 v[128:131], a[224:227], a[32:35], v[128:131]
    ds_read_b64_tr_b16 a[248:249], v36 offset:17600
    v_mfma_f32_16x16x32_bf16 v[132:135], a[224:227], a[36:39], v[132:135]
    ds_read_b64_tr_b16 a[250:251], v36 offset:21952
    v_mfma_f32_16x16x32_bf16 v[136:139], a[224:227], a[40:43], v[136:139]
    buffer_load_dwordx4 v61, s[40:43], s52 offen offset:1088 lds
    v_mfma_f32_16x16x32_bf16 v[140:143], a[224:227], a[44:47], v[140:143]
    s_waitcnt lgkmcnt(10)
    v_mfma_f32_16x16x32_bf16 v[144:147], a[228:231], a[32:35], v[144:147]
    ds_read_b64_tr_b16 a[252:253], v36 offset:17608
    v_mfma_f32_16x16x32_bf16 v[148:151], a[228:231], a[36:39], v[148:151]
    ds_read_b64_tr_b16 a[254:255], v36 offset:21960
    v_mfma_f32_16x16x32_bf16 v[152:155], a[228:231], a[40:43], v[152:155]
    buffer_load_dwordx4 v62, s[40:43], s52 offen offset:2176 lds
    v_mfma_f32_16x16x32_bf16 v[156:159], a[228:231], a[44:47], v[156:159]
    s_waitcnt lgkmcnt(10)
    v_mfma_f32_16x16x32_bf16 v[160:163], a[232:235], a[32:35], v[160:163]
    ds_read_b64_tr_b16 a[192:193], v56 offset:8704
    v_mfma_f32_16x16x32_bf16 v[164:167], a[232:235], a[36:39], v[164:167]
    ds_read_b64_tr_b16 a[194:195], v56 offset:10752
    v_mfma_f32_16x16x32_bf16 v[168:171], a[232:235], a[40:43], v[168:171]
    v_mfma_f32_16x16x32_bf16 v[172:175], a[232:235], a[44:47], v[172:175]
    s_waitcnt lgkmcnt(10)
    v_mfma_f32_16x16x32_bf16 v[176:179], a[236:239], a[32:35], v[176:179]
    ds_read_b64_tr_b16 a[196:197], v57 offset:8704
    v_mfma_f32_16x16x32_bf16 v[180:183], a[236:239], a[36:39], v[180:183]
    ds_read_b64_tr_b16 a[198:199], v57 offset:10752
    v_mfma_f32_16x16x32_bf16 v[184:187], a[236:239], a[40:43], v[184:187]
    buffer_load_dwordx4 v63, s[40:43], s52 offen offset:3264 lds
    v_mfma_f32_16x16x32_bf16 v[188:191], a[236:239], a[44:47], v[188:191]
    s_waitcnt lgkmcnt(10)
    v_mfma_f32_16x16x32_bf16 v[192:195], a[240:243], a[32:35], v[192:195]
    ds_read_b64_tr_b16 a[200:201], v58 offset:8704
    v_mfma_f32_16x16x32_bf16 v[196:199], a[240:243], a[36:39], v[196:199]
    ds_read_b64_tr_b16 a[202:203], v58 offset:10752
    v_mfma_f32_16x16x32_bf16 v[200:203], a[240:243], a[40:43], v[200:203]
    s_add_u32 m0, s55, 26112
    v_mfma_f32_16x16x32_bf16 v[204:207], a[240:243], a[44:47], v[204:207]
    buffer_load_dwordx4 v38, s[44:47], s53 offen offset:0 lds
    s_waitcnt lgkmcnt(10)
    v_mfma_f32_16x16x32_bf16 v[208:211], a[244:247], a[32:35], v[208:211]
    ds_read_b64_tr_b16 a[204:205], v59 offset:8704
    v_mfma_f32_16x16x32_bf16 v[212:215], a[244:247], a[36:39], v[212:215]
    ds_read_b64_tr_b16 a[206:207], v59 offset:10752
    v_mfma_f32_16x16x32_bf16 v[216:219], a[244:247], a[40:43], v[216:219]
    v_mfma_f32_16x16x32_bf16 v[220:223], a[244:247], a[44:47], v[220:223]
    s_waitcnt lgkmcnt(10)
    v_mfma_f32_16x16x32_bf16 v[224:227], a[248:251], a[32:35], v[224:227]
    ds_read_b64_tr_b16 a[208:209], v36 offset:26112
    v_mfma_f32_16x16x32_bf16 v[228:231], a[248:251], a[36:39], v[228:231]
    ds_read_b64_tr_b16 a[210:211], v36 offset:30464
    v_mfma_f32_16x16x32_bf16 v[232:235], a[248:251], a[40:43], v[232:235]
    buffer_load_dwordx4 v39, s[44:47], s53 offen offset:1024 lds
    v_mfma_f32_16x16x32_bf16 v[236:239], a[248:251], a[44:47], v[236:239]
    s_add_u32 s52, s52, 524288
    s_waitcnt lgkmcnt(10)
    v_mfma_f32_16x16x32_bf16 v[240:243], a[252:255], a[32:35], v[240:243]
    ds_read_b64_tr_b16 a[212:213], v36 offset:26120
    v_mfma_f32_16x16x32_bf16 v[244:247], a[252:255], a[36:39], v[244:247]
    ds_read_b64_tr_b16 a[214:215], v36 offset:30472
    v_mfma_f32_16x16x32_bf16 v[248:251], a[252:255], a[40:43], v[248:251]
    s_add_u32 s53, s53, 229376
    v_mfma_f32_16x16x32_bf16 v[252:255], a[252:255], a[44:47], v[252:255]
    s_add_u32 m0, s22, 0
    s_waitcnt lgkmcnt(10)
    v_mfma_f32_16x16x32_bf16 v[64:67], a[192:195], a[32:35], v[64:67]
    ds_read_b64_tr_b16 a[216:217], v36 offset:26176
    v_mfma_f32_16x16x32_bf16 v[68:71], a[192:195], a[36:39], v[68:71]
    ds_read_b64_tr_b16 a[218:219], v36 offset:30528
    v_mfma_f32_16x16x32_bf16 v[72:75], a[192:195], a[40:43], v[72:75]
    v_mfma_f32_16x16x32_bf16 v[76:79], a[192:195], a[44:47], v[76:79]
    s_waitcnt lgkmcnt(10)
    v_mfma_f32_16x16x32_bf16 v[80:83], a[196:199], a[32:35], v[80:83]
    ds_read_b64_tr_b16 a[220:221], v36 offset:26184
    v_mfma_f32_16x16x32_bf16 v[84:87], a[196:199], a[36:39], v[84:87]
    ds_read_b64_tr_b16 a[222:223], v36 offset:30536
    v_mfma_f32_16x16x32_bf16 v[88:91], a[196:199], a[40:43], v[88:91]
    buffer_load_dwordx4 v8, s[4:7], s20 offen offset:0 lds
    v_mfma_f32_16x16x32_bf16 v[92:95], a[196:199], a[44:47], v[92:95]
    s_waitcnt lgkmcnt(10)
    v_mfma_f32_16x16x32_bf16 v[96:99], a[200:203], a[32:35], v[96:99]
    ds_read_b64_tr_b16 a[224:225], v36 offset:26240
    v_mfma_f32_16x16x32_bf16 v[100:103], a[200:203], a[36:39], v[100:103]
    ds_read_b64_tr_b16 a[226:227], v36 offset:30592
    v_mfma_f32_16x16x32_bf16 v[104:107], a[200:203], a[40:43], v[104:107]
    buffer_load_dwordx4 v9, s[4:7], s20 offen offset:1088 lds
    v_mfma_f32_16x16x32_bf16 v[108:111], a[200:203], a[44:47], v[108:111]
    s_waitcnt lgkmcnt(10)
    v_mfma_f32_16x16x32_bf16 v[112:115], a[204:207], a[32:35], v[112:115]
    ds_read_b64_tr_b16 a[228:229], v36 offset:26248
    v_mfma_f32_16x16x32_bf16 v[116:119], a[204:207], a[36:39], v[116:119]
    ds_read_b64_tr_b16 a[230:231], v36 offset:30600
    v_mfma_f32_16x16x32_bf16 v[120:123], a[204:207], a[40:43], v[120:123]
    v_mfma_f32_16x16x32_bf16 v[124:127], a[204:207], a[44:47], v[124:127]
    s_waitcnt vmcnt(26)
    s_waitcnt lgkmcnt(10)
    v_mfma_f32_16x16x32_bf16 v[128:131], a[208:211], a[48:51], v[128:131]
    ds_read_b64_tr_b16 a[232:233], v36 offset:26304
    v_mfma_f32_16x16x32_bf16 v[132:135], a[208:211], a[52:55], v[132:135]
    ds_read_b64_tr_b16 a[234:235], v36 offset:30656
    v_mfma_f32_16x16x32_bf16 v[136:139], a[208:211], a[56:59], v[136:139]
    buffer_load_dwordx4 v10, s[4:7], s20 offen offset:2176 lds
    v_mfma_f32_16x16x32_bf16 v[140:143], a[208:211], a[60:63], v[140:143]
    s_waitcnt lgkmcnt(10)
    v_mfma_f32_16x16x32_bf16 v[144:147], a[212:215], a[48:51], v[144:147]
    ds_read_b64_tr_b16 a[236:237], v36 offset:26312
    v_mfma_f32_16x16x32_bf16 v[148:151], a[212:215], a[52:55], v[148:151]
    ds_read_b64_tr_b16 a[238:239], v36 offset:30664
    v_mfma_f32_16x16x32_bf16 v[152:155], a[212:215], a[56:59], v[152:155]
    buffer_load_dwordx4 v11, s[4:7], s20 offen offset:3264 lds
    v_mfma_f32_16x16x32_bf16 v[156:159], a[212:215], a[60:63], v[156:159]
    s_add_u32 s20, s20, 16384
    s_waitcnt lgkmcnt(10)
    v_mfma_f32_16x16x32_bf16 v[160:163], a[216:219], a[48:51], v[160:163]
    ds_read_b64_tr_b16 a[240:241], v56 offset:12800
    v_mfma_f32_16x16x32_bf16 v[164:167], a[216:219], a[52:55], v[164:167]
    ds_read_b64_tr_b16 a[242:243], v56 offset:14848
    v_mfma_f32_16x16x32_bf16 v[168:171], a[216:219], a[56:59], v[168:171]
    v_mfma_f32_16x16x32_bf16 v[172:175], a[216:219], a[60:63], v[172:175]
    s_waitcnt lgkmcnt(10)
    v_mfma_f32_16x16x32_bf16 v[176:179], a[220:223], a[48:51], v[176:179]
    ds_read_b64_tr_b16 a[244:245], v57 offset:12800
    v_mfma_f32_16x16x32_bf16 v[180:183], a[220:223], a[52:55], v[180:183]
    ds_read_b64_tr_b16 a[246:247], v57 offset:14848
    v_mfma_f32_16x16x32_bf16 v[184:187], a[220:223], a[56:59], v[184:187]
    s_add_u32 s27, s54, 15360
    v_mfma_f32_16x16x32_bf16 v[188:191], a[220:223], a[60:63], v[188:191]
    buffer_load_dwordx4 a[112:115], v26, s[12:15], s27 offen sc1
    s_waitcnt lgkmcnt(10)
    v_mfma_f32_16x16x32_bf16 v[192:195], a[224:227], a[48:51], v[192:195]
    ds_read_b64_tr_b16 a[248:249], v58 offset:12800
    v_mfma_f32_16x16x32_bf16 v[196:199], a[224:227], a[52:55], v[196:199]
    ds_read_b64_tr_b16 a[250:251], v58 offset:14848
    v_mfma_f32_16x16x32_bf16 v[200:203], a[224:227], a[56:59], v[200:203]
    s_add_u32 s27, s54, 31744
    v_mfma_f32_16x16x32_bf16 v[204:207], a[224:227], a[60:63], v[204:207]
    buffer_load_dwordx4 a[116:119], v26, s[12:15], s27 offen sc1
    s_waitcnt lgkmcnt(10)
    v_mfma_f32_16x16x32_bf16 v[208:211], a[228:231], a[48:51], v[208:211]
    ds_read_b64_tr_b16 a[252:253], v59 offset:12800
    v_mfma_f32_16x16x32_bf16 v[212:215], a[228:231], a[52:55], v[212:215]
    ds_read_b64_tr_b16 a[254:255], v59 offset:14848
    v_mfma_f32_16x16x32_bf16 v[216:219], a[228:231], a[56:59], v[216:219]
    v_mfma_f32_16x16x32_bf16 v[220:223], a[228:231], a[60:63], v[220:223]
    s_waitcnt lgkmcnt(10)
    s_waitcnt vmcnt(24)
    s_barrier
    v_mfma_f32_16x16x32_bf16 v[224:227], a[232:235], a[48:51], v[224:227]
    ds_read_b64_tr_b16 a[192:193], v36 offset:34816
    v_mfma_f32_16x16x32_bf16 v[228:231], a[232:235], a[52:55], v[228:231]
    ds_read_b64_tr_b16 a[194:195], v36 offset:39168
    v_mfma_f32_16x16x32_bf16 v[232:235], a[232:235], a[56:59], v[232:235]
    s_add_u32 s27, s54, 48128
    v_mfma_f32_16x16x32_bf16 v[236:239], a[232:235], a[60:63], v[236:239]
    buffer_load_dwordx4 a[120:123], v26, s[12:15], s27 offen sc1
    s_waitcnt lgkmcnt(10)
    v_mfma_f32_16x16x32_bf16 v[240:243], a[236:239], a[48:51], v[240:243]
    ds_read_b64_tr_b16 a[196:197], v36 offset:34824
    v_mfma_f32_16x16x32_bf16 v[244:247], a[236:239], a[52:55], v[244:247]
    ds_read_b64_tr_b16 a[198:199], v36 offset:39176
    v_mfma_f32_16x16x32_bf16 v[248:251], a[236:239], a[56:59], v[248:251]
    s_add_u32 s27, s54, 64512
    v_mfma_f32_16x16x32_bf16 v[252:255], a[236:239], a[60:63], v[252:255]
    buffer_load_dwordx4 a[124:127], v26, s[12:15], s27 offen sc1
    s_waitcnt lgkmcnt(10)
    v_mfma_f32_16x16x32_bf16 v[64:67], a[240:243], a[48:51], v[64:67]
    ds_read_b64_tr_b16 a[200:201], v36 offset:34880
    v_mfma_f32_16x16x32_bf16 v[68:71], a[240:243], a[52:55], v[68:71]
    ds_read_b64_tr_b16 a[202:203], v36 offset:39232
    v_mfma_f32_16x16x32_bf16 v[72:75], a[240:243], a[56:59], v[72:75]
    v_mfma_f32_16x16x32_bf16 v[76:79], a[240:243], a[60:63], v[76:79]
    s_waitcnt lgkmcnt(10)
    v_mfma_f32_16x16x32_bf16 v[80:83], a[244:247], a[48:51], v[80:83]
    ds_read_b64_tr_b16 a[204:205], v36 offset:34888
    v_mfma_f32_16x16x32_bf16 v[84:87], a[244:247], a[52:55], v[84:87]
    ds_read_b64_tr_b16 a[206:207], v36 offset:39240
    v_mfma_f32_16x16x32_bf16 v[88:91], a[244:247], a[56:59], v[88:91]
    s_add_u32 m0, s22, 17408
    v_mfma_f32_16x16x32_bf16 v[92:95], a[244:247], a[60:63], v[92:95]
    buffer_load_dwordx4 v8, s[4:7], s20 offen offset:0 lds
    s_waitcnt lgkmcnt(10)
    v_mfma_f32_16x16x32_bf16 v[96:99], a[248:251], a[48:51], v[96:99]
    ds_read_b64_tr_b16 a[208:209], v36 offset:34944
    v_mfma_f32_16x16x32_bf16 v[100:103], a[248:251], a[52:55], v[100:103]
    ds_read_b64_tr_b16 a[210:211], v36 offset:39296
    v_mfma_f32_16x16x32_bf16 v[104:107], a[248:251], a[56:59], v[104:107]
    buffer_load_dwordx4 v9, s[4:7], s20 offen offset:1088 lds
    v_mfma_f32_16x16x32_bf16 v[108:111], a[248:251], a[60:63], v[108:111]
    s_waitcnt lgkmcnt(10)
    v_mfma_f32_16x16x32_bf16 v[112:115], a[252:255], a[48:51], v[112:115]
    ds_read_b64_tr_b16 a[212:213], v36 offset:34952
    v_mfma_f32_16x16x32_bf16 v[116:119], a[252:255], a[52:55], v[116:119]
    ds_read_b64_tr_b16 a[214:215], v36 offset:39304
    v_mfma_f32_16x16x32_bf16 v[120:123], a[252:255], a[56:59], v[120:123]
    v_mfma_f32_16x16x32_bf16 v[124:127], a[252:255], a[60:63], v[124:127]
    s_waitcnt vmcnt(24)
    s_waitcnt lgkmcnt(10)
    v_mfma_f32_16x16x32_bf16 v[128:131], a[192:195], a[64:67], v[128:131]
    ds_read_b64_tr_b16 a[216:217], v36 offset:35008
    v_mfma_f32_16x16x32_bf16 v[132:135], a[192:195], a[68:71], v[132:135]
    ds_read_b64_tr_b16 a[218:219], v36 offset:39360
    v_mfma_f32_16x16x32_bf16 v[136:139], a[192:195], a[72:75], v[136:139]
    buffer_load_dwordx4 v10, s[4:7], s20 offen offset:2176 lds
    v_mfma_f32_16x16x32_bf16 v[140:143], a[192:195], a[76:79], v[140:143]
    s_waitcnt lgkmcnt(10)
    v_mfma_f32_16x16x32_bf16 v[144:147], a[196:199], a[64:67], v[144:147]
    ds_read_b64_tr_b16 a[220:221], v36 offset:35016
    v_mfma_f32_16x16x32_bf16 v[148:151], a[196:199], a[68:71], v[148:151]
    ds_read_b64_tr_b16 a[222:223], v36 offset:39368
    v_mfma_f32_16x16x32_bf16 v[152:155], a[196:199], a[72:75], v[152:155]
    buffer_load_dwordx4 v11, s[4:7], s20 offen offset:3264 lds
    v_mfma_f32_16x16x32_bf16 v[156:159], a[196:199], a[76:79], v[156:159]
    s_add_u32 s20, s20, 16384
    s_waitcnt lgkmcnt(10)
    v_mfma_f32_16x16x32_bf16 v[160:163], a[200:203], a[64:67], v[160:163]
    ds_read_b64_tr_b16 a[224:225], v56 offset:17408
    v_mfma_f32_16x16x32_bf16 v[164:167], a[200:203], a[68:71], v[164:167]
    ds_read_b64_tr_b16 a[226:227], v56 offset:19456
    v_mfma_f32_16x16x32_bf16 v[168:171], a[200:203], a[72:75], v[168:171]
    v_mfma_f32_16x16x32_bf16 v[172:175], a[200:203], a[76:79], v[172:175]
    s_waitcnt lgkmcnt(10)
    v_mfma_f32_16x16x32_bf16 v[176:179], a[204:207], a[64:67], v[176:179]
    ds_read_b64_tr_b16 a[228:229], v57 offset:17408
    v_mfma_f32_16x16x32_bf16 v[180:183], a[204:207], a[68:71], v[180:183]
    ds_read_b64_tr_b16 a[230:231], v57 offset:19456
    v_mfma_f32_16x16x32_bf16 v[184:187], a[204:207], a[72:75], v[184:187]
    s_add_u32 m0, s23, 0
    v_mfma_f32_16x16x32_bf16 v[188:191], a[204:207], a[76:79], v[188:191]
    buffer_load_dwordx4 v12, s[8:11], s21 offen offset:0 lds
    s_waitcnt lgkmcnt(10)
    v_mfma_f32_16x16x32_bf16 v[192:195], a[208:211], a[64:67], v[192:195]
    ds_read_b64_tr_b16 a[232:233], v58 offset:17408
    v_mfma_f32_16x16x32_bf16 v[196:199], a[208:211], a[68:71], v[196:199]
    ds_read_b64_tr_b16 a[234:235], v58 offset:19456
    v_mfma_f32_16x16x32_bf16 v[200:203], a[208:211], a[72:75], v[200:203]
    buffer_load_dwordx4 v13, s[8:11], s21 offen offset:1088 lds
    v_mfma_f32_16x16x32_bf16 v[204:207], a[208:211], a[76:79], v[204:207]
    s_waitcnt lgkmcnt(10)
    v_mfma_f32_16x16x32_bf16 v[208:211], a[212:215], a[64:67], v[208:211]
    ds_read_b64_tr_b16 a[236:237], v59 offset:17408
    v_mfma_f32_16x16x32_bf16 v[212:215], a[212:215], a[68:71], v[212:215]
    ds_read_b64_tr_b16 a[238:239], v59 offset:19456
    v_mfma_f32_16x16x32_bf16 v[216:219], a[212:215], a[72:75], v[216:219]
    v_mfma_f32_16x16x32_bf16 v[220:223], a[212:215], a[76:79], v[220:223]
    s_waitcnt lgkmcnt(10)
    v_mfma_f32_16x16x32_bf16 v[224:227], a[216:219], a[64:67], v[224:227]
    ds_read_b64_tr_b16 a[240:241], v36 offset:43520
    v_mfma_f32_16x16x32_bf16 v[228:231], a[216:219], a[68:71], v[228:231]
    ds_read_b64_tr_b16 a[242:243], v36 offset:47872
    v_mfma_f32_16x16x32_bf16 v[232:235], a[216:219], a[72:75], v[232:235]
    buffer_load_dwordx4 v14, s[8:11], s21 offen offset:2176 lds
    v_mfma_f32_16x16x32_bf16 v[236:239], a[216:219], a[76:79], v[236:239]
    s_waitcnt lgkmcnt(10)
    v_mfma_f32_16x16x32_bf16 v[240:243], a[220:223], a[64:67], v[240:243]
    ds_read_b64_tr_b16 a[244:245], v36 offset:43528
    v_mfma_f32_16x16x32_bf16 v[244:247], a[220:223], a[68:71], v[244:247]
    ds_read_b64_tr_b16 a[246:247], v36 offset:47880
    v_mfma_f32_16x16x32_bf16 v[248:251], a[220:223], a[72:75], v[248:251]
    buffer_load_dwordx4 v15, s[8:11], s21 offen offset:3264 lds
    v_mfma_f32_16x16x32_bf16 v[252:255], a[220:223], a[76:79], v[252:255]
    s_add_u32 s21, s21, 16384
    s_waitcnt lgkmcnt(10)
    v_mfma_f32_16x16x32_bf16 v[64:67], a[224:227], a[64:67], v[64:67]
    ds_read_b64_tr_b16 a[248:249], v36 offset:43584
    v_mfma_f32_16x16x32_bf16 v[68:71], a[224:227], a[68:71], v[68:71]
    ds_read_b64_tr_b16 a[250:251], v36 offset:47936
    v_mfma_f32_16x16x32_bf16 v[72:75], a[224:227], a[72:75], v[72:75]
    v_mfma_f32_16x16x32_bf16 v[76:79], a[224:227], a[76:79], v[76:79]
    s_waitcnt lgkmcnt(10)
    v_mfma_f32_16x16x32_bf16 v[80:83], a[228:231], a[64:67], v[80:83]
    ds_read_b64_tr_b16 a[252:253], v36 offset:43592
    v_mfma_f32_16x16x32_bf16 v[84:87], a[228:231], a[68:71], v[84:87]
    ds_read_b64_tr_b16 a[254:255], v36 offset:47944
    v_mfma_f32_16x16x32_bf16 v[88:91], a[228:231], a[72:75], v[88:91]
    v_mfma_f32_16x16x32_bf16 v[92:95], a[228:231], a[76:79], v[92:95]
    s_waitcnt lgkmcnt(10)
    v_mfma_f32_16x16x32_bf16 v[96:99], a[232:235], a[64:67], v[96:99]
    ds_read_b64_tr_b16 a[192:193], v36 offset:43648
    v_mfma_f32_16x16x32_bf16 v[100:103], a[232:235], a[68:71], v[100:103]
    ds_read_b64_tr_b16 a[194:195], v36 offset:48000
    v_mfma_f32_16x16x32_bf16 v[104:107], a[232:235], a[72:75], v[104:107]
    v_mfma_f32_16x16x32_bf16 v[108:111], a[232:235], a[76:79], v[108:111]
    s_waitcnt lgkmcnt(10)
    v_mfma_f32_16x16x32_bf16 v[112:115], a[236:239], a[64:67], v[112:115]
    ds_read_b64_tr_b16 a[196:197], v36 offset:43656
    v_mfma_f32_16x16x32_bf16 v[116:119], a[236:239], a[68:71], v[116:119]
    ds_read_b64_tr_b16 a[198:199], v36 offset:48008
    v_mfma_f32_16x16x32_bf16 v[120:123], a[236:239], a[72:75], v[120:123]
    v_mfma_f32_16x16x32_bf16 v[124:127], a[236:239], a[76:79], v[124:127]
    s_waitcnt vmcnt(26)
    s_waitcnt lgkmcnt(10)
    v_mfma_f32_16x16x32_bf16 v[128:131], a[240:243], a[80:83], v[128:131]
    ds_read_b64_tr_b16 a[200:201], v36 offset:43712
    v_mfma_f32_16x16x32_bf16 v[132:135], a[240:243], a[84:87], v[132:135]
    ds_read_b64_tr_b16 a[202:203], v36 offset:48064
    v_mfma_f32_16x16x32_bf16 v[136:139], a[240:243], a[88:91], v[136:139]
    v_mfma_f32_16x16x32_bf16 v[140:143], a[240:243], a[92:95], v[140:143]
    s_waitcnt lgkmcnt(10)
    v_mfma_f32_16x16x32_bf16 v[144:147], a[244:247], a[80:83], v[144:147]
    ds_read_b64_tr_b16 a[204:205], v36 offset:43720
    v_mfma_f32_16x16x32_bf16 v[148:151], a[244:247], a[84:87], v[148:151]
    ds_read_b64_tr_b16 a[206:207], v36 offset:48072
    v_mfma_f32_16x16x32_bf16 v[152:155], a[244:247], a[88:91], v[152:155]
    v_mfma_f32_16x16x32_bf16 v[156:159], a[244:247], a[92:95], v[156:159]
    s_waitcnt lgkmcnt(10)
    v_mfma_f32_16x16x32_bf16 v[160:163], a[248:251], a[80:83], v[160:163]
    ds_read_b64_tr_b16 a[208:209], v56 offset:21504
    v_mfma_f32_16x16x32_bf16 v[164:167], a[248:251], a[84:87], v[164:167]
    ds_read_b64_tr_b16 a[210:211], v56 offset:23552
    v_mfma_f32_16x16x32_bf16 v[168:171], a[248:251], a[88:91], v[168:171]
    v_mfma_f32_16x16x32_bf16 v[172:175], a[248:251], a[92:95], v[172:175]
    s_waitcnt lgkmcnt(10)
    v_mfma_f32_16x16x32_bf16 v[176:179], a[252:255], a[80:83], v[176:179]
    ds_read_b64_tr_b16 a[212:213], v57 offset:21504
    v_mfma_f32_16x16x32_bf16 v[180:183], a[252:255], a[84:87], v[180:183]
    ds_read_b64_tr_b16 a[214:215], v57 offset:23552
    v_mfma_f32_16x16x32_bf16 v[184:187], a[252:255], a[88:91], v[184:187]
    v_mfma_f32_16x16x32_bf16 v[188:191], a[252:255], a[92:95], v[188:191]
    s_waitcnt lgkmcnt(10)
    v_mfma_f32_16x16x32_bf16 v[192:195], a[192:195], a[80:83], v[192:195]
    ds_read_b64_tr_b16 a[216:217], v58 offset:21504
    v_mfma_f32_16x16x32_bf16 v[196:199], a[192:195], a[84:87], v[196:199]
    ds_read_b64_tr_b16 a[218:219], v58 offset:23552
    v_mfma_f32_16x16x32_bf16 v[200:203], a[192:195], a[88:91], v[200:203]
    v_mfma_f32_16x16x32_bf16 v[204:207], a[192:195], a[92:95], v[204:207]
    s_waitcnt lgkmcnt(10)
    v_mfma_f32_16x16x32_bf16 v[208:211], a[196:199], a[80:83], v[208:211]
    ds_read_b64_tr_b16 a[220:221], v59 offset:21504
    v_mfma_f32_16x16x32_bf16 v[212:215], a[196:199], a[84:87], v[212:215]
    ds_read_b64_tr_b16 a[222:223], v59 offset:23552
    v_mfma_f32_16x16x32_bf16 v[216:219], a[196:199], a[88:91], v[216:219]
    v_mfma_f32_16x16x32_bf16 v[220:223], a[196:199], a[92:95], v[220:223]
    s_waitcnt lgkmcnt(10)
    s_waitcnt vmcnt(16)
    s_barrier
    v_mfma_f32_16x16x32_bf16 v[224:227], a[200:203], a[80:83], v[224:227]
    ds_read_b64_tr_b16 a[224:225], v36 offset:52224
    v_mfma_f32_16x16x32_bf16 v[228:231], a[200:203], a[84:87], v[228:231]
    ds_read_b64_tr_b16 a[226:227], v36 offset:56576
    v_mfma_f32_16x16x32_bf16 v[232:235], a[200:203], a[88:91], v[232:235]
    s_add_u32 m0, s22, 34816
    v_mfma_f32_16x16x32_bf16 v[236:239], a[200:203], a[92:95], v[236:239]
    buffer_load_dwordx4 v8, s[4:7], s20 offen offset:0 lds
    s_waitcnt lgkmcnt(10)
    v_mfma_f32_16x16x32_bf16 v[240:243], a[204:207], a[80:83], v[240:243]
    ds_read_b64_tr_b16 a[228:229], v36 offset:52232
    v_mfma_f32_16x16x32_bf16 v[244:247], a[204:207], a[84:87], v[244:247]
    ds_read_b64_tr_b16 a[230:231], v36 offset:56584
    v_mfma_f32_16x16x32_bf16 v[248:251], a[204:207], a[88:91], v[248:251]
    buffer_load_dwordx4 v9, s[4:7], s20 offen offset:1088 lds
    v_mfma_f32_16x16x32_bf16 v[252:255], a[204:207], a[92:95], v[252:255]
    s_waitcnt lgkmcnt(10)
    v_mfma_f32_16x16x32_bf16 v[64:67], a[208:211], a[80:83], v[64:67]
    ds_read_b64_tr_b16 a[232:233], v36 offset:52288
    v_mfma_f32_16x16x32_bf16 v[68:71], a[208:211], a[84:87], v[68:71]
    ds_read_b64_tr_b16 a[234:235], v36 offset:56640
    v_mfma_f32_16x16x32_bf16 v[72:75], a[208:211], a[88:91], v[72:75]
    v_mfma_f32_16x16x32_bf16 v[76:79], a[208:211], a[92:95], v[76:79]
    s_waitcnt lgkmcnt(10)
    v_mfma_f32_16x16x32_bf16 v[80:83], a[212:215], a[80:83], v[80:83]
    ds_read_b64_tr_b16 a[236:237], v36 offset:52296
    v_mfma_f32_16x16x32_bf16 v[84:87], a[212:215], a[84:87], v[84:87]
    ds_read_b64_tr_b16 a[238:239], v36 offset:56648
    v_mfma_f32_16x16x32_bf16 v[88:91], a[212:215], a[88:91], v[88:91]
    buffer_load_dwordx4 v10, s[4:7], s20 offen offset:2176 lds
    v_mfma_f32_16x16x32_bf16 v[92:95], a[212:215], a[92:95], v[92:95]
    s_waitcnt lgkmcnt(10)
    v_mfma_f32_16x16x32_bf16 v[96:99], a[216:219], a[80:83], v[96:99]
    ds_read_b64_tr_b16 a[240:241], v36 offset:52352
    v_mfma_f32_16x16x32_bf16 v[100:103], a[216:219], a[84:87], v[100:103]
    ds_read_b64_tr_b16 a[242:243], v36 offset:56704
    v_mfma_f32_16x16x32_bf16 v[104:107], a[216:219], a[88:91], v[104:107]
    buffer_load_dwordx4 v11, s[4:7], s20 offen offset:3264 lds
    v_mfma_f32_16x16x32_bf16 v[108:111], a[216:219], a[92:95], v[108:111]
    s_add_u32 s20, s20, 16384
    s_waitcnt lgkmcnt(10)
    v_mfma_f32_16x16x32_bf16 v[112:115], a[220:223], a[80:83], v[112:115]
    ds_read_b64_tr_b16 a[244:245], v36 offset:52360
    v_mfma_f32_16x16x32_bf16 v[116:119], a[220:223], a[84:87], v[116:119]
    ds_read_b64_tr_b16 a[246:247], v36 offset:56712
    v_mfma_f32_16x16x32_bf16 v[120:123], a[220:223], a[88:91], v[120:123]
    v_mfma_f32_16x16x32_bf16 v[124:127], a[220:223], a[92:95], v[124:127]
    s_waitcnt vmcnt(26)
    s_waitcnt lgkmcnt(10)
    v_mfma_f32_16x16x32_bf16 v[128:131], a[224:227], a[96:99], v[128:131]
    ds_read_b64_tr_b16 a[248:249], v36 offset:52416
    v_mfma_f32_16x16x32_bf16 v[132:135], a[224:227], a[100:103], v[132:135]
    ds_read_b64_tr_b16 a[250:251], v36 offset:56768
    v_mfma_f32_16x16x32_bf16 v[136:139], a[224:227], a[104:107], v[136:139]
    s_add_u32 m0, s23, 17408
    v_mfma_f32_16x16x32_bf16 v[140:143], a[224:227], a[108:111], v[140:143]
    buffer_load_dwordx4 v12, s[8:11], s21 offen offset:0 lds
    s_waitcnt lgkmcnt(10)
    v_mfma_f32_16x16x32_bf16 v[144:147], a[228:231], a[96:99], v[144:147]
    ds_read_b64_tr_b16 a[252:253], v36 offset:52424
    v_mfma_f32_16x16x32_bf16 v[148:151], a[228:231], a[100:103], v[148:151]
    ds_read_b64_tr_b16 a[254:255], v36 offset:56776
    v_mfma_f32_16x16x32_bf16 v[152:155], a[228:231], a[104:107], v[152:155]
    buffer_load_dwordx4 v13, s[8:11], s21 offen offset:1088 lds
    v_mfma_f32_16x16x32_bf16 v[156:159], a[228:231], a[108:111], v[156:159]
    s_waitcnt lgkmcnt(10)
    v_mfma_f32_16x16x32_bf16 v[160:163], a[232:235], a[96:99], v[160:163]
    ds_read_b64_tr_b16 a[192:193], v56 offset:26112
    v_mfma_f32_16x16x32_bf16 v[164:167], a[232:235], a[100:103], v[164:167]
    ds_read_b64_tr_b16 a[194:195], v56 offset:28160
    v_mfma_f32_16x16x32_bf16 v[168:171], a[232:235], a[104:107], v[168:171]
    v_mfma_f32_16x16x32_bf16 v[172:175], a[232:235], a[108:111], v[172:175]
    s_waitcnt lgkmcnt(10)
    v_mfma_f32_16x16x32_bf16 v[176:179], a[236:239], a[96:99], v[176:179]
    ds_read_b64_tr_b16 a[196:197], v57 offset:26112
    v_mfma_f32_16x16x32_bf16 v[180:183], a[236:239], a[100:103], v[180:183]
    ds_read_b64_tr_b16 a[198:199], v57 offset:28160
    v_mfma_f32_16x16x32_bf16 v[184:187], a[236:239], a[104:107], v[184:187]
    buffer_load_dwordx4 v14, s[8:11], s21 offen offset:2176 lds
    v_mfma_f32_16x16x32_bf16 v[188:191], a[236:239], a[108:111], v[188:191]
    s_waitcnt lgkmcnt(10)
    v_mfma_f32_16x16x32_bf16 v[192:195], a[240:243], a[96:99], v[192:195]
    ds_read_b64_tr_b16 a[200:201], v58 offset:26112
    v_mfma_f32_16x16x32_bf16 v[196:199], a[240:243], a[100:103], v[196:199]
    ds_read_b64_tr_b16 a[202:203], v58 offset:28160
    v_mfma_f32_16x16x32_bf16 v[200:203], a[240:243], a[104:107], v[200:203]
    buffer_load_dwordx4 v15, s[8:11], s21 offen offset:3264 lds
    v_mfma_f32_16x16x32_bf16 v[204:207], a[240:243], a[108:111], v[204:207]
    s_add_u32 s21, s21, 16384
    s_waitcnt lgkmcnt(10)
    v_mfma_f32_16x16x32_bf16 v[208:211], a[244:247], a[96:99], v[208:211]
    ds_read_b64_tr_b16 a[204:205], v59 offset:26112
    v_mfma_f32_16x16x32_bf16 v[212:215], a[244:247], a[100:103], v[212:215]
    ds_read_b64_tr_b16 a[206:207], v59 offset:28160
    v_mfma_f32_16x16x32_bf16 v[216:219], a[244:247], a[104:107], v[216:219]
    v_mfma_f32_16x16x32_bf16 v[220:223], a[244:247], a[108:111], v[220:223]
    s_waitcnt lgkmcnt(10)
    v_mfma_f32_16x16x32_bf16 v[224:227], a[248:251], a[96:99], v[224:227]
    ds_read_b64_tr_b16 a[208:209], v36 offset:60928
    v_mfma_f32_16x16x32_bf16 v[228:231], a[248:251], a[100:103], v[228:231]
    ds_read_b64_tr_b16 a[210:211], v36 offset:65280
    v_mfma_f32_16x16x32_bf16 v[232:235], a[248:251], a[104:107], v[232:235]
    v_mfma_f32_16x16x32_bf16 v[236:239], a[248:251], a[108:111], v[236:239]
    s_waitcnt lgkmcnt(10)
    v_mfma_f32_16x16x32_bf16 v[240:243], a[252:255], a[96:99], v[240:243]
    ds_read_b64_tr_b16 a[212:213], v36 offset:60936
    v_mfma_f32_16x16x32_bf16 v[244:247], a[252:255], a[100:103], v[244:247]
    ds_read_b64_tr_b16 a[214:215], v36 offset:65288
    v_mfma_f32_16x16x32_bf16 v[248:251], a[252:255], a[104:107], v[248:251]
    v_mfma_f32_16x16x32_bf16 v[252:255], a[252:255], a[108:111], v[252:255]
    s_waitcnt lgkmcnt(10)
    v_mfma_f32_16x16x32_bf16 v[64:67], a[192:195], a[96:99], v[64:67]
    ds_read_b64_tr_b16 a[216:217], v36 offset:60992
    v_mfma_f32_16x16x32_bf16 v[68:71], a[192:195], a[100:103], v[68:71]
    ds_read_b64_tr_b16 a[218:219], v36 offset:65344
    v_mfma_f32_16x16x32_bf16 v[72:75], a[192:195], a[104:107], v[72:75]
    v_mfma_f32_16x16x32_bf16 v[76:79], a[192:195], a[108:111], v[76:79]
    s_waitcnt lgkmcnt(10)
    v_mfma_f32_16x16x32_bf16 v[80:83], a[196:199], a[96:99], v[80:83]
    ds_read_b64_tr_b16 a[220:221], v36 offset:61000
    v_mfma_f32_16x16x32_bf16 v[84:87], a[196:199], a[100:103], v[84:87]
    ds_read_b64_tr_b16 a[222:223], v36 offset:65352
    v_mfma_f32_16x16x32_bf16 v[88:91], a[196:199], a[104:107], v[88:91]
    v_mfma_f32_16x16x32_bf16 v[92:95], a[196:199], a[108:111], v[92:95]
    s_waitcnt lgkmcnt(10)
    v_mfma_f32_16x16x32_bf16 v[96:99], a[200:203], a[96:99], v[96:99]
    ds_read_b64_tr_b16 a[224:225], v36 offset:61056
    v_mfma_f32_16x16x32_bf16 v[100:103], a[200:203], a[100:103], v[100:103]
    ds_read_b64_tr_b16 a[226:227], v36 offset:65408
    v_mfma_f32_16x16x32_bf16 v[104:107], a[200:203], a[104:107], v[104:107]
    v_mfma_f32_16x16x32_bf16 v[108:111], a[200:203], a[108:111], v[108:111]
    s_waitcnt lgkmcnt(10)
    v_mfma_f32_16x16x32_bf16 v[112:115], a[204:207], a[96:99], v[112:115]
    ds_read_b64_tr_b16 a[228:229], v36 offset:61064
    v_mfma_f32_16x16x32_bf16 v[116:119], a[204:207], a[100:103], v[116:119]
    ds_read_b64_tr_b16 a[230:231], v36 offset:65416
    v_mfma_f32_16x16x32_bf16 v[120:123], a[204:207], a[104:107], v[120:123]
    v_mfma_f32_16x16x32_bf16 v[124:127], a[204:207], a[108:111], v[124:127]
    s_waitcnt vmcnt(16)
    s_waitcnt lgkmcnt(10)
    v_mfma_f32_16x16x32_bf16 v[128:131], a[208:211], a[112:115], v[128:131]
    ds_read_b64_tr_b16 a[232:233], v36 offset:61120
    v_mfma_f32_16x16x32_bf16 v[132:135], a[208:211], a[116:119], v[132:135]
    ds_read_b64_tr_b16 a[234:235], v36 offset:65472
    v_mfma_f32_16x16x32_bf16 v[136:139], a[208:211], a[120:123], v[136:139]
    v_mfma_f32_16x16x32_bf16 v[140:143], a[208:211], a[124:127], v[140:143]
    s_waitcnt lgkmcnt(10)
    v_mfma_f32_16x16x32_bf16 v[144:147], a[212:215], a[112:115], v[144:147]
    ds_read_b64_tr_b16 a[236:237], v36 offset:61128
    v_mfma_f32_16x16x32_bf16 v[148:151], a[212:215], a[116:119], v[148:151]
    ds_read_b64_tr_b16 a[238:239], v36 offset:65480
    v_mfma_f32_16x16x32_bf16 v[152:155], a[212:215], a[120:123], v[152:155]
    v_mfma_f32_16x16x32_bf16 v[156:159], a[212:215], a[124:127], v[156:159]
    s_waitcnt lgkmcnt(10)
    v_mfma_f32_16x16x32_bf16 v[160:163], a[216:219], a[112:115], v[160:163]
    ds_read_b64_tr_b16 a[240:241], v56 offset:30208
    v_mfma_f32_16x16x32_bf16 v[164:167], a[216:219], a[116:119], v[164:167]
    ds_read_b64_tr_b16 a[242:243], v56 offset:32256
    v_mfma_f32_16x16x32_bf16 v[168:171], a[216:219], a[120:123], v[168:171]
    v_mfma_f32_16x16x32_bf16 v[172:175], a[216:219], a[124:127], v[172:175]
    s_waitcnt lgkmcnt(10)
    v_mfma_f32_16x16x32_bf16 v[176:179], a[220:223], a[112:115], v[176:179]
    ds_read_b64_tr_b16 a[244:245], v57 offset:30208
    v_mfma_f32_16x16x32_bf16 v[180:183], a[220:223], a[116:119], v[180:183]
    ds_read_b64_tr_b16 a[246:247], v57 offset:32256
    v_mfma_f32_16x16x32_bf16 v[184:187], a[220:223], a[120:123], v[184:187]
    v_mfma_f32_16x16x32_bf16 v[188:191], a[220:223], a[124:127], v[188:191]
    s_waitcnt lgkmcnt(10)
    v_mfma_f32_16x16x32_bf16 v[192:195], a[224:227], a[112:115], v[192:195]
    ds_read_b64_tr_b16 a[248:249], v58 offset:30208
    v_mfma_f32_16x16x32_bf16 v[196:199], a[224:227], a[116:119], v[196:199]
    ds_read_b64_tr_b16 a[250:251], v58 offset:32256
    v_mfma_f32_16x16x32_bf16 v[200:203], a[224:227], a[120:123], v[200:203]
    v_mfma_f32_16x16x32_bf16 v[204:207], a[224:227], a[124:127], v[204:207]
    s_waitcnt lgkmcnt(10)
    v_mfma_f32_16x16x32_bf16 v[208:211], a[228:231], a[112:115], v[208:211]
    ds_read_b64_tr_b16 a[252:253], v59 offset:30208
    v_mfma_f32_16x16x32_bf16 v[212:215], a[228:231], a[116:119], v[212:215]
    ds_read_b64_tr_b16 a[254:255], v59 offset:32256
    v_mfma_f32_16x16x32_bf16 v[216:219], a[228:231], a[120:123], v[216:219]
    v_mfma_f32_16x16x32_bf16 v[220:223], a[228:231], a[124:127], v[220:223]
    s_waitcnt lgkmcnt(10)
    v_mfma_f32_16x16x32_bf16 v[224:227], a[232:235], a[112:115], v[224:227]
    v_mfma_f32_16x16x32_bf16 v[228:231], a[232:235], a[116:119], v[228:231]
    v_mfma_f32_16x16x32_bf16 v[232:235], a[232:235], a[120:123], v[232:235]
    v_mfma_f32_16x16x32_bf16 v[236:239], a[232:235], a[124:127], v[236:239]
    s_waitcnt lgkmcnt(8)
    v_mfma_f32_16x16x32_bf16 v[240:243], a[236:239], a[112:115], v[240:243]
    v_mfma_f32_16x16x32_bf16 v[244:247], a[236:239], a[116:119], v[244:247]
    v_mfma_f32_16x16x32_bf16 v[248:251], a[236:239], a[120:123], v[248:251]
    v_mfma_f32_16x16x32_bf16 v[252:255], a[236:239], a[124:127], v[252:255]
    s_waitcnt lgkmcnt(6)
    v_mfma_f32_16x16x32_bf16 v[64:67], a[240:243], a[112:115], v[64:67]
    v_mfma_f32_16x16x32_bf16 v[68:71], a[240:243], a[116:119], v[68:71]
    v_mfma_f32_16x16x32_bf16 v[72:75], a[240:243], a[120:123], v[72:75]
    v_mfma_f32_16x16x32_bf16 v[76:79], a[240:243], a[124:127], v[76:79]
    s_waitcnt lgkmcnt(4)
    v_mfma_f32_16x16x32_bf16 v[80:83], a[244:247], a[112:115], v[80:83]
    v_mfma_f32_16x16x32_bf16 v[84:87], a[244:247], a[116:119], v[84:87]
    v_mfma_f32_16x16x32_bf16 v[88:91], a[244:247], a[120:123], v[88:91]
    v_mfma_f32_16x16x32_bf16 v[92:95], a[244:247], a[124:127], v[92:95]
    s_waitcnt lgkmcnt(2)
    v_mfma_f32_16x16x32_bf16 v[96:99], a[248:251], a[112:115], v[96:99]
    v_mfma_f32_16x16x32_bf16 v[100:103], a[248:251], a[116:119], v[100:103]
    v_mfma_f32_16x16x32_bf16 v[104:107], a[248:251], a[120:123], v[104:107]
    v_mfma_f32_16x16x32_bf16 v[108:111], a[248:251], a[124:127], v[108:111]
    s_waitcnt lgkmcnt(0)
    v_mfma_f32_16x16x32_bf16 v[112:115], a[252:255], a[112:115], v[112:115]
    v_mfma_f32_16x16x32_bf16 v[116:119], a[252:255], a[116:119], v[116:119]
    v_mfma_f32_16x16x32_bf16 v[120:123], a[252:255], a[120:123], v[120:123]
    v_mfma_f32_16x16x32_bf16 v[124:127], a[252:255], a[124:127], v[124:127]
    s_nop 7
    s_mov_b32 s26, 0x3e0293ee
    s_mov_b32 s27, 0x3e0293ee
    v_pk_mul_f32 v[128:129], v[128:129], s[26:27]
    v_pk_mul_f32 v[130:131], v[130:131], s[26:27]
    v_pk_mul_f32 v[144:145], v[144:145], s[26:27]
    v_pk_mul_f32 v[146:147], v[146:147], s[26:27]
    v_cvt_pk_bf16_f32 v128, v128, v129
    v_cvt_pk_bf16_f32 v129, v130, v131
    v_cvt_pk_bf16_f32 v130, v144, v145
    v_cvt_pk_bf16_f32 v131, v146, v147
    v_pk_mul_f32 v[132:133], v[132:133], s[26:27]
    v_pk_mul_f32 v[134:135], v[134:135], s[26:27]
    v_pk_mul_f32 v[148:149], v[148:149], s[26:27]
    v_pk_mul_f32 v[150:151], v[150:151], s[26:27]
    v_cvt_pk_bf16_f32 v132, v132, v133
    v_cvt_pk_bf16_f32 v133, v134, v135
    v_cvt_pk_bf16_f32 v134, v148, v149
    v_cvt_pk_bf16_f32 v135, v150, v151
    v_pk_mul_f32 v[136:137], v[136:137], s[26:27]
    v_pk_mul_f32 v[138:139], v[138:139], s[26:27]
    v_pk_mul_f32 v[152:153], v[152:153], s[26:27]
    v_pk_mul_f32 v[154:155], v[154:155], s[26:27]
    v_cvt_pk_bf16_f32 v136, v136, v137
    v_cvt_pk_bf16_f32 v137, v138, v139
    v_cvt_pk_bf16_f32 v138, v152, v153
    v_cvt_pk_bf16_f32 v139, v154, v155
    v_pk_mul_f32 v[140:141], v[140:141], s[26:27]
    v_pk_mul_f32 v[142:143], v[142:143], s[26:27]
    v_pk_mul_f32 v[156:157], v[156:157], s[26:27]
    v_pk_mul_f32 v[158:159], v[158:159], s[26:27]
    v_cvt_pk_bf16_f32 v140, v140, v141
    v_cvt_pk_bf16_f32 v141, v142, v143
    v_cvt_pk_bf16_f32 v142, v156, v157
    v_cvt_pk_bf16_f32 v143, v158, v159
    v_pk_mul_f32 v[160:161], v[160:161], s[26:27]
    v_pk_mul_f32 v[162:163], v[162:163], s[26:27]
    v_pk_mul_f32 v[176:177], v[176:177], s[26:27]
    v_pk_mul_f32 v[178:179], v[178:179], s[26:27]
    v_cvt_pk_bf16_f32 v144, v160, v161
    v_cvt_pk_bf16_f32 v145, v162, v163
    v_cvt_pk_bf16_f32 v146, v176, v177
    v_cvt_pk_bf16_f32 v147, v178, v179
    v_pk_mul_f32 v[164:165], v[164:165], s[26:27]
    v_pk_mul_f32 v[166:167], v[166:167], s[26:27]
    v_pk_mul_f32 v[180:181], v[180:181], s[26:27]
    v_pk_mul_f32 v[182:183], v[182:183], s[26:27]
    v_cvt_pk_bf16_f32 v148, v164, v165
    v_cvt_pk_bf16_f32 v149, v166, v167
    v_cvt_pk_bf16_f32 v150, v180, v181
    v_cvt_pk_bf16_f32 v151, v182, v183
    v_pk_mul_f32 v[168:169], v[168:169], s[26:27]
    v_pk_mul_f32 v[170:171], v[170:171], s[26:27]
    v_pk_mul_f32 v[184:185], v[184:185], s[26:27]
    v_pk_mul_f32 v[186:187], v[186:187], s[26:27]
    v_cvt_pk_bf16_f32 v152, v168, v169
    v_cvt_pk_bf16_f32 v153, v170, v171
    v_cvt_pk_bf16_f32 v154, v184, v185
    v_cvt_pk_bf16_f32 v155, v186, v187
    v_pk_mul_f32 v[172:173], v[172:173], s[26:27]
    v_pk_mul_f32 v[174:175], v[174:175], s[26:27]
    v_pk_mul_f32 v[188:189], v[188:189], s[26:27]
    v_pk_mul_f32 v[190:191], v[190:191], s[26:27]
    v_cvt_pk_bf16_f32 v156, v172, v173
    v_cvt_pk_bf16_f32 v157, v174, v175
    v_cvt_pk_bf16_f32 v158, v188, v189
    v_cvt_pk_bf16_f32 v159, v190, v191
    v_pk_mul_f32 v[192:193], v[192:193], s[26:27]
    v_pk_mul_f32 v[194:195], v[194:195], s[26:27]
    v_pk_mul_f32 v[208:209], v[208:209], s[26:27]
    v_pk_mul_f32 v[210:211], v[210:211], s[26:27]
    v_cvt_pk_bf16_f32 v160, v192, v193
    v_cvt_pk_bf16_f32 v161, v194, v195
    v_cvt_pk_bf16_f32 v162, v208, v209
    v_cvt_pk_bf16_f32 v163, v210, v211
    v_pk_mul_f32 v[196:197], v[196:197], s[26:27]
    v_pk_mul_f32 v[198:199], v[198:199], s[26:27]
    v_pk_mul_f32 v[212:213], v[212:213], s[26:27]
    v_pk_mul_f32 v[214:215], v[214:215], s[26:27]
    v_cvt_pk_bf16_f32 v164, v196, v197
    v_cvt_pk_bf16_f32 v165, v198, v199
    v_cvt_pk_bf16_f32 v166, v212, v213
    v_cvt_pk_bf16_f32 v167, v214, v215
    v_pk_mul_f32 v[200:201], v[200:201], s[26:27]
    v_pk_mul_f32 v[202:203], v[202:203], s[26:27]
    v_pk_mul_f32 v[216:217], v[216:217], s[26:27]
    v_pk_mul_f32 v[218:219], v[218:219], s[26:27]
    v_cvt_pk_bf16_f32 v168, v200, v201
    v_cvt_pk_bf16_f32 v169, v202, v203
    v_cvt_pk_bf16_f32 v170, v216, v217
    v_cvt_pk_bf16_f32 v171, v218, v219
    v_pk_mul_f32 v[204:205], v[204:205], s[26:27]
    v_pk_mul_f32 v[206:207], v[206:207], s[26:27]
    v_pk_mul_f32 v[220:221], v[220:221], s[26:27]
    v_pk_mul_f32 v[222:223], v[222:223], s[26:27]
    v_cvt_pk_bf16_f32 v172, v204, v205
    v_cvt_pk_bf16_f32 v173, v206, v207
    v_cvt_pk_bf16_f32 v174, v220, v221
    v_cvt_pk_bf16_f32 v175, v222, v223
    v_pk_mul_f32 v[224:225], v[224:225], s[26:27]
    v_pk_mul_f32 v[226:227], v[226:227], s[26:27]
    v_pk_mul_f32 v[240:241], v[240:241], s[26:27]
    v_pk_mul_f32 v[242:243], v[242:243], s[26:27]
    v_cvt_pk_bf16_f32 v176, v224, v225
    v_cvt_pk_bf16_f32 v177, v226, v227
    v_cvt_pk_bf16_f32 v178, v240, v241
    v_cvt_pk_bf16_f32 v179, v242, v243
    v_pk_mul_f32 v[228:229], v[228:229], s[26:27]
    v_pk_mul_f32 v[230:231], v[230:231], s[26:27]
    v_pk_mul_f32 v[244:245], v[244:245], s[26:27]
    v_pk_mul_f32 v[246:247], v[246:247], s[26:27]
    v_cvt_pk_bf16_f32 v180, v228, v229
    v_cvt_pk_bf16_f32 v181, v230, v231
    v_cvt_pk_bf16_f32 v182, v244, v245
    v_cvt_pk_bf16_f32 v183, v246, v247
    v_pk_mul_f32 v[232:233], v[232:233], s[26:27]
    v_pk_mul_f32 v[234:235], v[234:235], s[26:27]
    v_pk_mul_f32 v[248:249], v[248:249], s[26:27]
    v_pk_mul_f32 v[250:251], v[250:251], s[26:27]
    v_cvt_pk_bf16_f32 v184, v232, v233
    v_cvt_pk_bf16_f32 v185, v234, v235
    v_cvt_pk_bf16_f32 v186, v248, v249
    v_cvt_pk_bf16_f32 v187, v250, v251
    v_pk_mul_f32 v[236:237], v[236:237], s[26:27]
    v_pk_mul_f32 v[238:239], v[238:239], s[26:27]
    v_pk_mul_f32 v[252:253], v[252:253], s[26:27]
    v_pk_mul_f32 v[254:255], v[254:255], s[26:27]
    v_cvt_pk_bf16_f32 v188, v236, v237
    v_cvt_pk_bf16_f32 v189, v238, v239
    v_cvt_pk_bf16_f32 v190, v252, v253
    v_cvt_pk_bf16_f32 v191, v254, v255
    v_cvt_pk_bf16_f32 v224, v64, v65
    v_cvt_pk_bf16_f32 v225, v66, v67
    v_cvt_pk_bf16_f32 v226, v80, v81
    v_cvt_pk_bf16_f32 v227, v82, v83
    v_pk_max_i16 v224, v224, 0
    v_pk_max_i16 v225, v225, 0
    v_pk_max_i16 v226, v226, 0
    v_pk_max_i16 v227, v227, 0
    v_cvt_pk_bf16_f32 v228, v96, v97
    v_cvt_pk_bf16_f32 v229, v98, v99
    v_cvt_pk_bf16_f32 v230, v112, v113
    v_cvt_pk_bf16_f32 v231, v114, v115
    v_pk_max_i16 v228, v228, 0
    v_pk_max_i16 v229, v229, 0
    v_pk_max_i16 v230, v230, 0
    v_pk_max_i16 v231, v231, 0
    v_cvt_pk_bf16_f32 v232, v68, v69
    v_cvt_pk_bf16_f32 v233, v70, v71
    v_cvt_pk_bf16_f32 v234, v84, v85
    v_cvt_pk_bf16_f32 v235, v86, v87
    v_pk_max_i16 v232, v232, 0
    v_pk_max_i16 v233, v233, 0
    v_pk_max_i16 v234, v234, 0
    v_pk_max_i16 v235, v235, 0
    v_cvt_pk_bf16_f32 v236, v100, v101
    v_cvt_pk_bf16_f32 v237, v102, v103
    v_cvt_pk_bf16_f32 v238, v116, v117
    v_cvt_pk_bf16_f32 v239, v118, v119
    v_pk_max_i16 v236, v236, 0
    v_pk_max_i16 v237, v237, 0
    v_pk_max_i16 v238, v238, 0
    v_pk_max_i16 v239, v239, 0
    v_cvt_pk_bf16_f32 v240, v72, v73
    v_cvt_pk_bf16_f32 v241, v74, v75
    v_cvt_pk_bf16_f32 v242, v88, v89
    v_cvt_pk_bf16_f32 v243, v90, v91
    v_pk_max_i16 v240, v240, 0
    v_pk_max_i16 v241, v241, 0
    v_pk_max_i16 v242, v242, 0
    v_pk_max_i16 v243, v243, 0
    v_cvt_pk_bf16_f32 v244, v104, v105
    v_cvt_pk_bf16_f32 v245, v106, v107
    v_cvt_pk_bf16_f32 v246, v120, v121
    v_cvt_pk_bf16_f32 v247, v122, v123
    v_pk_max_i16 v244, v244, 0
    v_pk_max_i16 v245, v245, 0
    v_pk_max_i16 v246, v246, 0
    v_pk_max_i16 v247, v247, 0
    v_cvt_pk_bf16_f32 v248, v76, v77
    v_cvt_pk_bf16_f32 v249, v78, v79
    v_cvt_pk_bf16_f32 v250, v92, v93
    v_cvt_pk_bf16_f32 v251, v94, v95
    v_pk_max_i16 v248, v248, 0
    v_pk_max_i16 v249, v249, 0
    v_pk_max_i16 v250, v250, 0
    v_pk_max_i16 v251, v251, 0
    v_cvt_pk_bf16_f32 v252, v108, v109
    v_cvt_pk_bf16_f32 v253, v110, v111
    v_cvt_pk_bf16_f32 v254, v124, v125
    v_cvt_pk_bf16_f32 v255, v126, v127
    v_pk_max_i16 v252, v252, 0
    v_pk_max_i16 v253, v253, 0
    v_pk_max_i16 v254, v254, 0
    v_pk_max_i16 v255, v255, 0
    s_mul_i32 s26, s35, 56
    s_lshl_b32 s27, s33, 1
    s_add_u32 s26, s26, s27
    s_lshl_b32 s56, s26, 10
    s_add_u32 s57, s56, 57344
    s_add_u32 s58, s56, 114688
    s_add_u32 s59, s56, 172032
    s_cmp_ge_u32 s33, 28
    s_cselect_b32 s50, 0, 7340032
    v_mov_b32 v16, 0
    v_mov_b32 v17, 0
    v_mov_b32 v18, 0
    v_mov_b32 v19, 0
    s_waitcnt vmcnt(20) lgkmcnt(0)
    s_barrier
    s_add_u32 m0, s22, 52224
    s_nop 0
    buffer_load_dwordx4 v8, s[4:7], s20 offen offset:0 lds
    buffer_load_dwordx4 v9, s[4:7], s20 offen offset:1088 lds
    buffer_load_dwordx4 v10, s[4:7], s20 offen offset:2176 lds
    buffer_load_dwordx4 v11, s[4:7], s20 offen offset:3264 lds
    s_add_u32 s20, s20, 16384
    ds_read_b128 a[192:195], v2 offset:0
    ds_read_b128 a[196:199], v2 offset:64
    ds_read_b128 a[200:203], v2 offset:128
    ds_read_b128 a[204:207], v2 offset:192
    ds_read_b128 a[208:211], v2 offset:4352
    ds_read_b128 a[212:215], v2 offset:4416
    ds_read_b128 a[216:219], v2 offset:4480
    ds_read_b128 a[220:223], v2 offset:4544
    s_waitcnt lgkmcnt(0)
    v_mfma_f32_16x16x32_bf16 v[64:67], a[192:195], v[128:131], 0
    v_mfma_f32_16x16x32_bf16 v[72:75], a[192:195], v[132:135], 0
    v_mfma_f32_16x16x32_bf16 v[80:83], a[192:195], v[136:139], 0
    v_mfma_f32_16x16x32_bf16 v[88:91], a[192:195], v[140:143], 0
    v_mfma_f32_16x16x32_bf16 v[64:67], a[196:199], v[144:147], v[64:67]
    v_mfma_f32_16x16x32_bf16 v[72:75], a[196:199], v[148:151], v[72:75]
    v_mfma_f32_16x16x32_bf16 v[80:83], a[196:199], v[152:155], v[80:83]
    v_mfma_f32_16x16x32_bf16 v[88:91], a[196:199], v[156:159], v[88:91]
    v_mfma_f32_16x16x32_bf16 v[64:67], a[200:203], v[160:163], v[64:67]
    v_mfma_f32_16x16x32_bf16 v[72:75], a[200:203], v[164:167], v[72:75]
    v_mfma_f32_16x16x32_bf16 v[80:83], a[200:203], v[168:171], v[80:83]
    v_mfma_f32_16x16x32_bf16 v[88:91], a[200:203], v[172:175], v[88:91]
    v_mfma_f32_16x16x32_bf16 v[64:67], a[204:207], v[176:179], v[64:67]
    v_mfma_f32_16x16x32_bf16 v[72:75], a[204:207], v[180:183], v[72:75]
    v_mfma_f32_16x16x32_bf16 v[80:83], a[204:207], v[184:187], v[80:83]
    v_mfma_f32_16x16x32_bf16 v[88:91], a[204:207], v[188:191], v[88:91]
    v_mfma_f32_16x16x32_bf16 v[68:71], a[208:211], v[128:131], 0
    v_mfma_f32_16x16x32_bf16 v[76:79], a[208:211], v[132:135], 0
    v_mfma_f32_16x16x32_bf16 v[84:87], a[208:211], v[136:139], 0
    v_mfma_f32_16x16x32_bf16 v[92:95], a[208:211], v[140:143], 0
    v_mfma_f32_16x16x32_bf16 v[68:71], a[212:215], v[144:147], v[68:71]
    v_mfma_f32_16x16x32_bf16 v[76:79], a[212:215], v[148:151], v[76:79]
    v_mfma_f32_16x16x32_bf16 v[84:87], a[212:215], v[152:155], v[84:87]
    v_mfma_f32_16x16x32_bf16 v[92:95], a[212:215], v[156:159], v[92:95]
    v_mfma_f32_16x16x32_bf16 v[68:71], a[216:219], v[160:163], v[68:71]
    v_mfma_f32_16x16x32_bf16 v[76:79], a[216:219], v[164:167], v[76:79]
    v_mfma_f32_16x16x32_bf16 v[84:87], a[216:219], v[168:171], v[84:87]
    v_mfma_f32_16x16x32_bf16 v[92:95], a[216:219], v[172:175], v[92:95]
    v_mfma_f32_16x16x32_bf16 v[68:71], a[220:223], v[176:179], v[68:71]
    v_mfma_f32_16x16x32_bf16 v[76:79], a[220:223], v[180:183], v[76:79]
    v_mfma_f32_16x16x32_bf16 v[84:87], a[220:223], v[184:187], v[84:87]
    v_mfma_f32_16x16x32_bf16 v[92:95], a[220:223], v[188:191], v[92:95]
    ds_read_b128 a[192:195], v2 offset:8704
    ds_read_b128 a[196:199], v2 offset:8768
    ds_read_b128 a[200:203], v2 offset:8832
    ds_read_b128 a[204:207], v2 offset:8896
    ds_read_b128 a[208:211], v2 offset:13056
    ds_read_b128 a[212:215], v2 offset:13120
    ds_read_b128 a[216:219], v2 offset:13184
    ds_read_b128 a[220:223], v2 offset:13248
    s_nop 3
    v_max3_f32 v28, v64, v65, v66
    v_max3_f32 v30, v72, v73, v74
    v_max3_f32 v32, v80, v81, v82
    v_max3_f32 v34, v88, v89, v90
    v_max3_f32 v28, v28, v67, v68
    v_max3_f32 v30, v30, v75, v76
    v_max3_f32 v32, v32, v83, v84
    v_max3_f32 v34, v34, v91, v92
    v_max3_f32 v28, v28, v69, v70
    v_max3_f32 v30, v30, v77, v78
    v_max3_f32 v32, v32, v85, v86
    v_max3_f32 v34, v34, v93, v94
    v_max_f32 v28, v28, v71
    v_max_f32 v30, v30, v79
    v_max_f32 v32, v32, v87
    v_max_f32 v34, v34, v95
    v_mov_b32 v29, v28
    v_mov_b32 v31, v30
    v_mov_b32 v33, v32
    v_mov_b32 v35, v34
    v_permlane16_swap_b32 v28, v29
    v_permlane16_swap_b32 v30, v31
    v_permlane16_swap_b32 v32, v33
    v_permlane16_swap_b32 v34, v35
    v_max_f32 v28, v28, v29
    v_max_f32 v30, v30, v31
    v_max_f32 v32, v32, v33
    v_max_f32 v34, v34, v35
    v_mov_b32 v29, v28
    v_mov_b32 v31, v30
    v_mov_b32 v33, v32
    v_mov_b32 v35, v34
    v_permlane32_swap_b32 v28, v29
    v_permlane32_swap_b32 v30, v31
    v_permlane32_swap_b32 v32, v33
    v_permlane32_swap_b32 v34, v35
    v_max_f32 v28, v28, v29
    v_max_f32 v30, v30, v31
    v_max_f32 v32, v32, v33
    v_max_f32 v34, v34, v35
    v_sub_f32 v40, 0, v28
    v_sub_f32 v41, 0, v28
    v_sub_f32 v42, 0, v28
    v_sub_f32 v43, 0, v28
    v_sub_f32 v64, v64, v28
    v_sub_f32 v65, v65, v28
    v_sub_f32 v66, v66, v28
    v_sub_f32 v67, v67, v28
    v_sub_f32 v68, v68, v28
    v_sub_f32 v69, v69, v28
    v_sub_f32 v70, v70, v28
    v_sub_f32 v71, v71, v28
    v_sub_f32 v44, 0, v30
    v_sub_f32 v45, 0, v30
    v_sub_f32 v46, 0, v30
    v_sub_f32 v47, 0, v30
    v_sub_f32 v72, v72, v30
    v_sub_f32 v73, v73, v30
    v_sub_f32 v74, v74, v30
    v_sub_f32 v75, v75, v30
    v_sub_f32 v76, v76, v30
    v_sub_f32 v77, v77, v30
    v_sub_f32 v78, v78, v30
    v_sub_f32 v79, v79, v30
    v_sub_f32 v48, 0, v32
    v_sub_f32 v49, 0, v32
    v_sub_f32 v50, 0, v32
    v_sub_f32 v51, 0, v32
    v_sub_f32 v80, v80, v32
    v_sub_f32 v81, v81, v32
    v_sub_f32 v82, v82, v32
    v_sub_f32 v83, v83, v32
    v_sub_f32 v84, v84, v32
    v_sub_f32 v85, v85, v32
    v_sub_f32 v86, v86, v32
    v_sub_f32 v87, v87, v32
    v_sub_f32 v52, 0, v34
    v_sub_f32 v53, 0, v34
    v_sub_f32 v54, 0, v34
    v_sub_f32 v55, 0, v34
    v_sub_f32 v88, v88, v34
    v_sub_f32 v89, v89, v34
    v_sub_f32 v90, v90, v34
    v_sub_f32 v91, v91, v34
    v_sub_f32 v92, v92, v34
    v_sub_f32 v93, v93, v34
    v_sub_f32 v94, v94, v34
    v_sub_f32 v95, v95, v34
    s_waitcnt lgkmcnt(0)
    s_nop 1
    v_mfma_f32_16x16x32_bf16 v[96:99], a[192:195], v[128:131], v[40:43]
    v_exp_f32 v28, v64
    v_mfma_f32_16x16x32_bf16 v[104:107], a[192:195], v[132:135], v[44:47]
    v_mfma_f32_16x16x32_bf16 v[112:115], a[192:195], v[136:139], v[48:51]
    v_exp_f32 v29, v65
    v_mfma_f32_16x16x32_bf16 v[120:123], a[192:195], v[140:143], v[52:55]
    buffer_store_dwordx4 v[224:227], v26, s[48:51], s56 offen offset:0 sc1
    v_add_f32 v20, v28, v29
    v_cvt_pk_bf16_f32 v192, v28, v29
    v_mfma_f32_16x16x32_bf16 v[96:99], a[196:199], v[144:147], v[96:99]
    v_exp_f32 v30, v66
    v_mfma_f32_16x16x32_bf16 v[104:107], a[196:199], v[148:151], v[104:107]
    v_add_f32 v20, v20, v30
    v_mfma_f32_16x16x32_bf16 v[112:115], a[196:199], v[152:155], v[112:115]
    buffer_store_dwordx4 v[228:231], v26, s[48:51], s56 offen offset:1024 sc1
    v_exp_f32 v31, v67
    v_mfma_f32_16x16x32_bf16 v[120:123], a[196:199], v[156:159], v[120:123]
    v_add_f32 v20, v20, v31
    v_cvt_pk_bf16_f32 v193, v30, v31
    v_mfma_f32_16x16x32_bf16 v[96:99], a[200:203], v[160:163], v[96:99]
    v_exp_f32 v32, v68
    v_mfma_f32_16x16x32_bf16 v[104:107], a[200:203], v[164:167], v[104:107]
    buffer_store_dwordx4 v[232:235], v26, s[48:51], s57 offen offset:0 sc1
    v_add_f32 v20, v20, v32
    v_mfma_f32_16x16x32_bf16 v[112:115], a[200:203], v[168:171], v[112:115]
    v_exp_f32 v33, v69
    v_mfma_f32_16x16x32_bf16 v[120:123], a[200:203], v[172:175], v[120:123]
    v_add_f32 v20, v20, v33
    v_cvt_pk_bf16_f32 v194, v32, v33
    v_mfma_f32_16x16x32_bf16 v[96:99], a[204:207], v[176:179], v[96:99]
    buffer_store_dwordx4 v[236:239], v26, s[48:51], s57 offen offset:1024 sc1
    v_exp_f32 v34, v70
    v_mfma_f32_16x16x32_bf16 v[104:107], a[204:207], v[180:183], v[104:107]
    v_add_f32 v20, v20, v34
    v_mfma_f32_16x16x32_bf16 v[112:115], a[204:207], v[184:187], v[112:115]
    v_exp_f32 v35, v71
    v_mfma_f32_16x16x32_bf16 v[120:123], a[204:207], v[188:191], v[120:123]
    buffer_store_dwordx4 v[240:243], v26, s[48:51], s58 offen offset:0 sc1
    v_add_f32 v20, v20, v35
    v_cvt_pk_bf16_f32 v195, v34, v35
    v_mfma_f32_16x16x32_bf16 v[100:103], a[208:211], v[128:131], v[40:43]
    v_exp_f32 v28, v72
    v_mfma_f32_16x16x32_bf16 v[108:111], a[208:211], v[132:135], v[44:47]
    v_mfma_f32_16x16x32_bf16 v[116:119], a[208:211], v[136:139], v[48:51]
    buffer_store_dwordx4 v[244:247], v26, s[48:51], s58 offen offset:1024 sc1
    v_exp_f32 v29, v73
    v_mfma_f32_16x16x32_bf16 v[124:127], a[208:211], v[140:143], v[52:55]
    v_add_f32 v21, v28, v29
    v_cvt_pk_bf16_f32 v196, v28, v29
    v_mfma_f32_16x16x32_bf16 v[100:103], a[212:215], v[144:147], v[100:103]
    v_exp_f32 v30, v74
    v_mfma_f32_16x16x32_bf16 v[108:111], a[212:215], v[148:151], v[108:111]
    buffer_store_dwordx4 v[248:251], v26, s[48:51], s59 offen offset:0 sc1
    v_add_f32 v21, v21, v30
    v_mfma_f32_16x16x32_bf16 v[116:119], a[212:215], v[152:155], v[116:119]
    v_exp_f32 v31, v75
    v_mfma_f32_16x16x32_bf16 v[124:127], a[212:215], v[156:159], v[124:127]
    v_add_f32 v21, v21, v31
    v_cvt_pk_bf16_f32 v197, v30, v31
    v_mfma_f32_16x16x32_bf16 v[100:103], a[216:219], v[160:163], v[100:103]
    buffer_store_dwordx4 v[252:255], v26, s[48:51], s59 offen offset:1024 sc1
    v_exp_f32 v32, v76
    v_mfma_f32_16x16x32_bf16 v[108:111], a[216:219], v[164:167], v[108:111]
    v_add_f32 v21, v21, v32
    v_mfma_f32_16x16x32_bf16 v[116:119], a[216:219], v[168:171], v[116:119]
    v_exp_f32 v33, v77
    v_mfma_f32_16x16x32_bf16 v[124:127], a[216:219], v[172:175], v[124:127]
    v_add_f32 v21, v21, v33
    v_cvt_pk_bf16_f32 v198, v32, v33
    v_mfma_f32_16x16x32_bf16 v[100:103], a[220:223], v[176:179], v[100:103]
    v_exp_f32 v34, v78
    v_mfma_f32_16x16x32_bf16 v[108:111], a[220:223], v[180:183], v[108:111]
    v_add_f32 v21, v21, v34
    v_mfma_f32_16x16x32_bf16 v[116:119], a[220:223], v[184:187], v[116:119]
    v_exp_f32 v35, v79
    v_mfma_f32_16x16x32_bf16 v[124:127], a[220:223], v[188:191], v[124:127]
    v_add_f32 v21, v21, v35
    v_cvt_pk_bf16_f32 v199, v34, v35
    s_waitcnt vmcnt(20)
    s_barrier
    s_nop 0
    v_exp_f32 v28, v80
    s_nop 0
    ds_read_b128 a[192:195], v2 offset:17408
    ds_read_b128 a[196:199], v2 offset:17472
    s_nop 0
    v_exp_f32 v29, v81
    s_nop 0
    v_add_f32 v22, v28, v29
    v_cvt_pk_bf16_f32 v200, v28, v29
    s_nop 0
    v_exp_f32 v30, v82
    s_nop 0
    ds_read_b128 a[200:203], v2 offset:17536
    ds_read_b128 a[204:207], v2 offset:17600
    v_add_f32 v22, v22, v30
    s_nop 0
    v_exp_f32 v31, v83
    s_nop 0
    v_add_f32 v22, v22, v31
    v_cvt_pk_bf16_f32 v201, v30, v31
    s_nop 0
    v_exp_f32 v32, v84
    s_nop 0
    ds_read_b128 a[208:211], v2 offset:21760
    ds_read_b128 a[212:215], v2 offset:21824
    v_add_f32 v22, v22, v32
    s_nop 0
    v_exp_f32 v33, v85
    s_nop 0
    v_add_f32 v22, v22, v33
    v_cvt_pk_bf16_f32 v202, v32, v33
    s_nop 0
    v_exp_f32 v34, v86
    s_nop 0
    ds_read_b128 a[216:219], v2 offset:21888
    ds_read_b128 a[220:223], v2 offset:21952
    v_add_f32 v22, v22, v34
    s_nop 0
    v_exp_f32 v35, v87
    s_nop 0
    s_add_u32 m0, s23, 34816
    v_add_f32 v22, v22, v35
    v_cvt_pk_bf16_f32 v203, v34, v35
    s_nop 0
    v_exp_f32 v28, v88
    s_nop 0
    buffer_load_dwordx4 v12, s[8:11], s21 offen offset:0 lds
    v_max3_f32 v24, v20, v21, v22
    s_nop 0
    v_exp_f32 v29, v89
    s_nop 0
    v_add_f32 v23, v28, v29
    v_cvt_pk_bf16_f32 v204, v28, v29
    s_nop 0
    v_exp_f32 v30, v90
    s_nop 0
    buffer_load_dwordx4 v13, s[8:11], s21 offen offset:1088 lds
    v_add_f32 v23, v23, v30
    s_nop 0
    v_exp_f32 v31, v91
    s_nop 0
    v_add_f32 v23, v23, v31
    v_cvt_pk_bf16_f32 v205, v30, v31
    s_nop 0
    v_exp_f32 v32, v92
    s_nop 0
    buffer_load_dwordx4 v14, s[8:11], s21 offen offset:2176 lds
    v_add_f32 v23, v23, v32
    s_nop 0
    v_exp_f32 v33, v93
    s_nop 0
    v_add_f32 v23, v23, v33
    v_cvt_pk_bf16_f32 v206, v32, v33
    s_nop 0
    v_exp_f32 v34, v94
    s_nop 0
    buffer_load_dwordx4 v15, s[8:11], s21 offen offset:3264 lds
    v_add_f32 v23, v23, v34
    s_nop 0
    v_exp_f32 v35, v95
    s_nop 0
    s_add_u32 s21, s21, 16384
    v_add_f32 v23, v23, v35
    v_cvt_pk_bf16_f32 v207, v34, v35
    v_max_f32 v24, v24, v23
    v_cmp_lt_f32 vcc, s25, v24
    s_waitcnt lgkmcnt(0)
    s_cbranch_vccnz rare_stub_1
rare_back_2:
    s_lshl_b32 s26, s2, 2
    s_add_u32 s26, s26, s32
    s_lshl_b32 s64, s26, 12
    s_lshl_b32 s65, s26, 11
    v_mfma_f32_16x16x32_bf16 v[64:67], a[192:195], v[128:131], v[40:43]
    v_exp_f32 v28, v96
    v_mfma_f32_16x16x32_bf16 v[72:75], a[192:195], v[132:135], v[44:47]
    ds_read_b64_tr_b16 a[224:225], v4 offset:0
    ds_read_b64_tr_b16 a[226:227], v4 offset:4352
    v_add_f32 v16, v16, v20
    v_add_f32 v17, v17, v21
    v_mfma_f32_16x16x32_bf16 v[80:83], a[192:195], v[136:139], v[48:51]
    v_exp_f32 v29, v97
    v_mfma_f32_16x16x32_bf16 v[88:91], a[192:195], v[140:143], v[52:55]
    buffer_load_dwordx4 a[128:131], v26, s[68:71], s64 offen offset:0
    v_add_f32 v20, v28, v29
    v_cvt_pk_bf16_f32 v208, v28, v29
    v_mfma_f32_16x16x32_bf16 v[64:67], a[196:199], v[144:147], v[64:67]
    v_exp_f32 v30, v98
    v_mfma_f32_16x16x32_bf16 v[72:75], a[196:199], v[148:151], v[72:75]
    ds_read_b64_tr_b16 a[228:229], v5 offset:32
    ds_read_b64_tr_b16 a[230:231], v5 offset:4384
    v_add_f32 v20, v20, v30
    v_mfma_f32_16x16x32_bf16 v[80:83], a[196:199], v[152:155], v[80:83]
    v_exp_f32 v31, v99
    v_mfma_f32_16x16x32_bf16 v[88:91], a[196:199], v[156:159], v[88:91]
    buffer_load_dwordx4 a[132:135], v26, s[68:71], s64 offen offset:1024
    v_add_f32 v20, v20, v31
    v_cvt_pk_bf16_f32 v209, v30, v31
    v_mfma_f32_16x16x32_bf16 v[64:67], a[200:203], v[160:163], v[64:67]
    v_exp_f32 v32, v100
    v_mfma_f32_16x16x32_bf16 v[72:75], a[200:203], v[164:167], v[72:75]
    ds_read_b64_tr_b16 a[232:233], v4 offset:64
    ds_read_b64_tr_b16 a[234:235], v4 offset:4416
    v_add_f32 v20, v20, v32
    v_mfma_f32_16x16x32_bf16 v[80:83], a[200:203], v[168:171], v[80:83]
    v_exp_f32 v33, v101
    v_mfma_f32_16x16x32_bf16 v[88:91], a[200:203], v[172:175], v[88:91]
    buffer_load_dwordx4 a[136:139], v26, s[68:71], s64 offen offset:2048
    v_add_f32 v20, v20, v33
    v_cvt_pk_bf16_f32 v210, v32, v33
    v_mfma_f32_16x16x32_bf16 v[64:67], a[204:207], v[176:179], v[64:67]
    v_exp_f32 v34, v102
    v_mfma_f32_16x16x32_bf16 v[72:75], a[204:207], v[180:183], v[72:75]
    ds_read_b64_tr_b16 a[236:237], v5 offset:96
    ds_read_b64_tr_b16 a[238:239], v5 offset:4448
    v_add_f32 v20, v20, v34
    v_mfma_f32_16x16x32_bf16 v[80:83], a[204:207], v[184:187], v[80:83]
    v_exp_f32 v35, v103
    v_mfma_f32_16x16x32_bf16 v[88:91], a[204:207], v[188:191], v[88:91]
    buffer_load_dwordx4 a[140:143], v26, s[68:71], s64 offen offset:3072
    v_add_f32 v20, v20, v35
    v_cvt_pk_bf16_f32 v211, v34, v35
    v_mfma_f32_16x16x32_bf16 v[68:71], a[208:211], v[128:131], v[40:43]
    v_exp_f32 v28, v104
    v_mfma_f32_16x16x32_bf16 v[76:79], a[208:211], v[132:135], v[44:47]
    ds_read_b64_tr_b16 a[240:241], v4 offset:128
    ds_read_b64_tr_b16 a[242:243], v4 offset:4480
    v_add_f32 v18, v18, v22
    v_add_f32 v19, v19, v23
    v_mfma_f32_16x16x32_bf16 v[84:87], a[208:211], v[136:139], v[48:51]
    v_exp_f32 v29, v105
    v_mfma_f32_16x16x32_bf16 v[92:95], a[208:211], v[140:143], v[52:55]
    buffer_load_dwordx4 a[144:147], v26, s[72:75], s65 offen offset:0
    v_add_f32 v21, v28, v29
    v_cvt_pk_bf16_f32 v212, v28, v29
    v_mfma_f32_16x16x32_bf16 v[68:71], a[212:215], v[144:147], v[68:71]
    v_exp_f32 v30, v106
    v_mfma_f32_16x16x32_bf16 v[76:79], a[212:215], v[148:151], v[76:79]
    ds_read_b64_tr_b16 a[244:245], v5 offset:160
    ds_read_b64_tr_b16 a[246:247], v5 offset:4512
    v_add_f32 v21, v21, v30
    v_mfma_f32_16x16x32_bf16 v[84:87], a[212:215], v[152:155], v[84:87]
    v_exp_f32 v31, v107
    v_mfma_f32_16x16x32_bf16 v[92:95], a[212:215], v[156:159], v[92:95]
    buffer_load_dwordx4 a[148:151], v26, s[72:75], s65 offen offset:1024
    v_add_f32 v21, v21, v31
    v_cvt_pk_bf16_f32 v213, v30, v31
    v_mfma_f32_16x16x32_bf16 v[68:71], a[216:219], v[160:163], v[68:71]
    v_exp_f32 v32, v108
    v_mfma_f32_16x16x32_bf16 v[76:79], a[216:219], v[164:167], v[76:79]
    ds_read_b64_tr_b16 a[248:249], v4 offset:192
    ds_read_b64_tr_b16 a[250:251], v4 offset:4544
    v_add_f32 v21, v21, v32
    v_mfma_f32_16x16x32_bf16 v[84:87], a[216:219], v[168:171], v[84:87]
    v_exp_f32 v33, v109
    v_mfma_f32_16x16x32_bf16 v[92:95], a[216:219], v[172:175], v[92:95]
    v_add_f32 v21, v21, v33
    v_cvt_pk_bf16_f32 v214, v32, v33
    v_mfma_f32_16x16x32_bf16 v[68:71], a[220:223], v[176:179], v[68:71]
    v_exp_f32 v34, v110
    v_mfma_f32_16x16x32_bf16 v[76:79], a[220:223], v[180:183], v[76:79]
    ds_read_b64_tr_b16 a[252:253], v5 offset:224
    ds_read_b64_tr_b16 a[254:255], v5 offset:4576
    v_add_f32 v21, v21, v34
    v_mfma_f32_16x16x32_bf16 v[84:87], a[220:223], v[184:187], v[84:87]
    v_exp_f32 v35, v111
    v_mfma_f32_16x16x32_bf16 v[92:95], a[220:223], v[188:191], v[92:95]
    v_add_f32 v21, v21, v35
    v_cvt_pk_bf16_f32 v215, v34, v35
    s_waitcnt lgkmcnt(0)
    v_mfma_f32_16x16x32_bf16 a[0:3], a[224:227], v[192:195], 0
    v_exp_f32 v28, v112
    v_mfma_f32_16x16x32_bf16 a[4:7], a[224:227], v[196:199], 0
    ds_read_b128 a[192:195], v2 offset:26112
    ds_read_b128 a[196:199], v2 offset:26176
    v_mfma_f32_16x16x32_bf16 a[8:11], a[224:227], v[200:203], 0
    v_exp_f32 v29, v113
    v_mfma_f32_16x16x32_bf16 a[12:15], a[224:227], v[204:207], 0
    v_add_f32 v22, v28, v29
    v_cvt_pk_bf16_f32 v216, v28, v29
    v_mfma_f32_16x16x32_bf16 a[16:19], a[228:231], v[192:195], 0
    v_exp_f32 v30, v114
    v_mfma_f32_16x16x32_bf16 a[20:23], a[228:231], v[196:199], 0
    ds_read_b128 a[200:203], v2 offset:26240
    ds_read_b128 a[204:207], v2 offset:26304
    v_add_f32 v22, v22, v30
    v_mfma_f32_16x16x32_bf16 a[24:27], a[228:231], v[200:203], 0
    v_exp_f32 v31, v115
    v_mfma_f32_16x16x32_bf16 a[28:31], a[228:231], v[204:207], 0
    v_add_f32 v22, v22, v31
    v_cvt_pk_bf16_f32 v217, v30, v31
    v_mfma_f32_16x16x32_bf16 a[32:35], a[232:235], v[192:195], 0
    v_exp_f32 v32, v116
    v_mfma_f32_16x16x32_bf16 a[36:39], a[232:235], v[196:199], 0
    ds_read_b128 a[208:211], v2 offset:30464
    ds_read_b128 a[212:215], v2 offset:30528
    v_add_f32 v22, v22, v32
    v_mfma_f32_16x16x32_bf16 a[40:43], a[232:235], v[200:203], 0
    v_exp_f32 v33, v117
    v_mfma_f32_16x16x32_bf16 a[44:47], a[232:235], v[204:207], 0
    v_add_f32 v22, v22, v33
    v_cvt_pk_bf16_f32 v218, v32, v33
    v_mfma_f32_16x16x32_bf16 a[48:51], a[236:239], v[192:195], 0
    v_exp_f32 v34, v118
    v_mfma_f32_16x16x32_bf16 a[52:55], a[236:239], v[196:199], 0
    ds_read_b128 a[216:219], v2 offset:30592
    ds_read_b128 a[220:223], v2 offset:30656
    v_add_f32 v22, v22, v34
    v_mfma_f32_16x16x32_bf16 a[56:59], a[236:239], v[200:203], 0
    v_exp_f32 v35, v119
    v_mfma_f32_16x16x32_bf16 a[60:63], a[236:239], v[204:207], 0
    s_add_u32 m0, s22, 0
    v_add_f32 v22, v22, v35
    v_cvt_pk_bf16_f32 v219, v34, v35
    v_mfma_f32_16x16x32_bf16 a[64:67], a[240:243], v[192:195], 0
    v_exp_f32 v28, v120
    v_mfma_f32_16x16x32_bf16 a[68:71], a[240:243], v[196:199], 0
    buffer_load_dwordx4 v8, s[4:7], s20 offen offset:0 lds
    v_max3_f32 v24, v20, v21, v22
    v_mfma_f32_16x16x32_bf16 a[72:75], a[240:243], v[200:203], 0
    v_exp_f32 v29, v121
    v_mfma_f32_16x16x32_bf16 a[76:79], a[240:243], v[204:207], 0
    v_add_f32 v23, v28, v29
    v_cvt_pk_bf16_f32 v220, v28, v29
    v_mfma_f32_16x16x32_bf16 a[80:83], a[244:247], v[192:195], 0
    v_exp_f32 v30, v122
    v_mfma_f32_16x16x32_bf16 a[84:87], a[244:247], v[196:199], 0
    buffer_load_dwordx4 v9, s[4:7], s20 offen offset:1088 lds
    v_add_f32 v23, v23, v30
    v_mfma_f32_16x16x32_bf16 a[88:91], a[244:247], v[200:203], 0
    v_exp_f32 v31, v123
    v_mfma_f32_16x16x32_bf16 a[92:95], a[244:247], v[204:207], 0
    v_add_f32 v23, v23, v31
    v_cvt_pk_bf16_f32 v221, v30, v31
    v_mfma_f32_16x16x32_bf16 a[96:99], a[248:251], v[192:195], 0
    v_exp_f32 v32, v124
    v_mfma_f32_16x16x32_bf16 a[100:103], a[248:251], v[196:199], 0
    buffer_load_dwordx4 v10, s[4:7], s20 offen offset:2176 lds
    v_add_f32 v23, v23, v32
    v_mfma_f32_16x16x32_bf16 a[104:107], a[248:251], v[200:203], 0
    v_exp_f32 v33, v125
    v_mfma_f32_16x16x32_bf16 a[108:111], a[248:251], v[204:207], 0
    v_add_f32 v23, v23, v33
    v_cvt_pk_bf16_f32 v222, v32, v33
    v_mfma_f32_16x16x32_bf16 a[112:115], a[252:255], v[192:195], 0
    v_exp_f32 v34, v126
    v_mfma_f32_16x16x32_bf16 a[116:119], a[252:255], v[196:199], 0
    buffer_load_dwordx4 v11, s[4:7], s20 offen offset:3264 lds
    v_add_f32 v23, v23, v34
    v_mfma_f32_16x16x32_bf16 a[120:123], a[252:255], v[200:203], 0
    v_exp_f32 v35, v127
    v_mfma_f32_16x16x32_bf16 a[124:127], a[252:255], v[204:207], 0
    s_add_u32 s20, s20, 16384
    v_add_f32 v23, v23, v35
    v_cvt_pk_bf16_f32 v223, v34, v35
    v_max_f32 v24, v24, v23
    v_cmp_lt_f32 vcc, s25, v24
    s_waitcnt lgkmcnt(0)
    s_cbranch_vccnz rare_stub_3
rare_back_4:
    s_mov_b32 s24, 0
    .p2align 6
attn_loop:
    s_lshl_b32 s26, s32, 4
    s_or_b32 s26, s26, s24
    s_cmp_lg_u32 s26, 1
    s_cbranch_scc1 hf_no_signal
    s_mov_b64 exec, 1
    s_lshl_b32 s61, s33, 2
    v_mov_b32 v248, s61
    v_mov_b32 v249, s63
    global_store_dword v248, v249, s[38:39] offset:512 sc1
    s_mov_b64 exec, -1
hf_no_signal:
    v_mfma_f32_16x16x32_bf16 v[96:99], a[192:195], v[128:131], v[40:43]
    v_exp_f32 v28, v64
    v_mfma_f32_16x16x32_bf16 v[104:107], a[192:195], v[132:135], v[44:47]
    ds_read_b64_tr_b16 a[224:225], v4 offset:8704
    ds_read_b64_tr_b16 a[226:227], v4 offset:13056
    v_add_f32 v16, v16, v20
    v_add_f32 v17, v17, v21
    v_mfma_f32_16x16x32_bf16 v[112:115], a[192:195], v[136:139], v[48:51]
    v_exp_f32 v29, v65
    v_mfma_f32_16x16x32_bf16 v[120:123], a[192:195], v[140:143], v[52:55]
    v_add_f32 v20, v28, v29
    v_cvt_pk_bf16_f32 v192, v28, v29
    v_mfma_f32_16x16x32_bf16 v[96:99], a[196:199], v[144:147], v[96:99]
    v_exp_f32 v30, v66
    v_mfma_f32_16x16x32_bf16 v[104:107], a[196:199], v[148:151], v[104:107]
    ds_read_b64_tr_b16 a[228:229], v5 offset:8736
    ds_read_b64_tr_b16 a[230:231], v5 offset:13088
    v_add_f32 v20, v20, v30
    v_mfma_f32_16x16x32_bf16 v[112:115], a[196:199], v[152:155], v[112:115]
    v_exp_f32 v31, v67
    v_mfma_f32_16x16x32_bf16 v[120:123], a[196:199], v[156:159], v[120:123]
    v_add_f32 v20, v20, v31
    v_cvt_pk_bf16_f32 v193, v30, v31
    v_mfma_f32_16x16x32_bf16 v[96:99], a[200:203], v[160:163], v[96:99]
    v_exp_f32 v32, v68
    v_mfma_f32_16x16x32_bf16 v[104:107], a[200:203], v[164:167], v[104:107]
    ds_read_b64_tr_b16 a[232:233], v4 offset:8768
    ds_read_b64_tr_b16 a[234:235], v4 offset:13120
    v_add_f32 v20, v20, v32
    v_mfma_f32_16x16x32_bf16 v[112:115], a[200:203], v[168:171], v[112:115]
    v_exp_f32 v33, v69
    v_mfma_f32_16x16x32_bf16 v[120:123], a[200:203], v[172:175], v[120:123]
    v_add_f32 v20, v20, v33
    v_cvt_pk_bf16_f32 v194, v32, v33
    v_mfma_f32_16x16x32_bf16 v[96:99], a[204:207], v[176:179], v[96:99]
    v_exp_f32 v34, v70
    v_mfma_f32_16x16x32_bf16 v[104:107], a[204:207], v[180:183], v[104:107]
    ds_read_b64_tr_b16 a[236:237], v5 offset:8800
    ds_read_b64_tr_b16 a[238:239], v5 offset:13152
    v_add_f32 v20, v20, v34
    v_mfma_f32_16x16x32_bf16 v[112:115], a[204:207], v[184:187], v[112:115]
    v_exp_f32 v35, v71
    v_mfma_f32_16x16x32_bf16 v[120:123], a[204:207], v[188:191], v[120:123]
    v_add_f32 v20, v20, v35
    v_cvt_pk_bf16_f32 v195, v34, v35
    v_mfma_f32_16x16x32_bf16 v[100:103], a[208:211], v[128:131], v[40:43]
    v_exp_f32 v28, v72
    v_mfma_f32_16x16x32_bf16 v[108:111], a[208:211], v[132:135], v[44:47]
    ds_read_b64_tr_b16 a[240:241], v4 offset:8832
    ds_read_b64_tr_b16 a[242:243], v4 offset:13184
    v_add_f32 v18, v18, v22
    v_add_f32 v19, v19, v23
    v_mfma_f32_16x16x32_bf16 v[116:119], a[208:211], v[136:139], v[48:51]
    v_exp_f32 v29, v73
    v_mfma_f32_16x16x32_bf16 v[124:127], a[208:211], v[140:143], v[52:55]
    v_add_f32 v21, v28, v29
    v_cvt_pk_bf16_f32 v196, v28, v29
    v_mfma_f32_16x16x32_bf16 v[100:103], a[212:215], v[144:147], v[100:103]
    v_exp_f32 v30, v74
    v_mfma_f32_16x16x32_bf16 v[108:111], a[212:215], v[148:151], v[108:111]
    ds_read_b64_tr_b16 a[244:245], v5 offset:8864
    ds_read_b64_tr_b16 a[246:247], v5 offset:13216
    v_add_f32 v21, v21, v30
    v_mfma_f32_16x16x32_bf16 v[116:119], a[212:215], v[152:155], v[116:119]
    v_exp_f32 v31, v75
    v_mfma_f32_16x16x32_bf16 v[124:127], a[212:215], v[156:159], v[124:127]
    v_add_f32 v21, v21, v31
    v_cvt_pk_bf16_f32 v197, v30, v31
    v_mfma_f32_16x16x32_bf16 v[100:103], a[216:219], v[160:163], v[100:103]
    v_exp_f32 v32, v76
    v_mfma_f32_16x16x32_bf16 v[108:111], a[216:219], v[164:167], v[108:111]
    ds_read_b64_tr_b16 a[248:249], v4 offset:8896
    ds_read_b64_tr_b16 a[250:251], v4 offset:13248
    v_add_f32 v21, v21, v32
    v_mfma_f32_16x16x32_bf16 v[116:119], a[216:219], v[168:171], v[116:119]
    v_exp_f32 v33, v77
    v_mfma_f32_16x16x32_bf16 v[124:127], a[216:219], v[172:175], v[124:127]
    v_add_f32 v21, v21, v33
    v_cvt_pk_bf16_f32 v198, v32, v33
    v_mfma_f32_16x16x32_bf16 v[100:103], a[220:223], v[176:179], v[100:103]
    v_exp_f32 v34, v78
    v_mfma_f32_16x16x32_bf16 v[108:111], a[220:223], v[180:183], v[108:111]
    ds_read_b64_tr_b16 a[252:253], v5 offset:8928
    ds_read_b64_tr_b16 a[254:255], v5 offset:13280
    v_add_f32 v21, v21, v34
    v_mfma_f32_16x16x32_bf16 v[116:119], a[220:223], v[184:187], v[116:119]
    v_exp_f32 v35, v79
    v_mfma_f32_16x16x32_bf16 v[124:127], a[220:223], v[188:191], v[124:127]
    v_add_f32 v21, v21, v35
    v_cvt_pk_bf16_f32 v199, v34, v35
    s_waitcnt vmcnt(12) lgkmcnt(0)
    s_barrier
    v_mfma_f32_16x16x32_bf16 a[0:3], a[224:227], v[208:211], a[0:3]
    v_exp_f32 v28, v80
    v_mfma_f32_16x16x32_bf16 a[4:7], a[224:227], v[212:215], a[4:7]
    ds_read_b128 a[192:195], v2 offset:34816
    ds_read_b128 a[196:199], v2 offset:34880
    v_mfma_f32_16x16x32_bf16 a[8:11], a[224:227], v[216:219], a[8:11]
    v_exp_f32 v29, v81
    v_mfma_f32_16x16x32_bf16 a[12:15], a[224:227], v[220:223], a[12:15]
    v_add_f32 v22, v28, v29
    v_cvt_pk_bf16_f32 v200, v28, v29
    v_mfma_f32_16x16x32_bf16 a[16:19], a[228:231], v[208:211], a[16:19]
    v_exp_f32 v30, v82
    v_mfma_f32_16x16x32_bf16 a[20:23], a[228:231], v[212:215], a[20:23]
    ds_read_b128 a[200:203], v2 offset:34944
    ds_read_b128 a[204:207], v2 offset:35008
    v_add_f32 v22, v22, v30
    v_mfma_f32_16x16x32_bf16 a[24:27], a[228:231], v[216:219], a[24:27]
    v_exp_f32 v31, v83
    v_mfma_f32_16x16x32_bf16 a[28:31], a[228:231], v[220:223], a[28:31]
    v_add_f32 v22, v22, v31
    v_cvt_pk_bf16_f32 v201, v30, v31
    v_mfma_f32_16x16x32_bf16 a[32:35], a[232:235], v[208:211], a[32:35]
    v_exp_f32 v32, v84
    v_mfma_f32_16x16x32_bf16 a[36:39], a[232:235], v[212:215], a[36:39]
    ds_read_b128 a[208:211], v2 offset:39168
    ds_read_b128 a[212:215], v2 offset:39232
    v_add_f32 v22, v22, v32
    v_mfma_f32_16x16x32_bf16 a[40:43], a[232:235], v[216:219], a[40:43]
    v_exp_f32 v33, v85
    v_mfma_f32_16x16x32_bf16 a[44:47], a[232:235], v[220:223], a[44:47]
    v_add_f32 v22, v22, v33
    v_cvt_pk_bf16_f32 v202, v32, v33
    v_mfma_f32_16x16x32_bf16 a[48:51], a[236:239], v[208:211], a[48:51]
    v_exp_f32 v34, v86
    v_mfma_f32_16x16x32_bf16 a[52:55], a[236:239], v[212:215], a[52:55]
    ds_read_b128 a[216:219], v2 offset:39296
    ds_read_b128 a[220:223], v2 offset:39360
    v_add_f32 v22, v22, v34
    v_mfma_f32_16x16x32_bf16 a[56:59], a[236:239], v[216:219], a[56:59]
    v_exp_f32 v35, v87
    v_mfma_f32_16x16x32_bf16 a[60:63], a[236:239], v[220:223], a[60:63]
    s_add_u32 m0, s23, 52224
    v_add_f32 v22, v22, v35
    v_cvt_pk_bf16_f32 v203, v34, v35
    v_mfma_f32_16x16x32_bf16 a[64:67], a[240:243], v[208:211], a[64:67]
    v_exp_f32 v28, v88
    v_mfma_f32_16x16x32_bf16 a[68:71], a[240:243], v[212:215], a[68:71]
    buffer_load_dwordx4 v12, s[8:11], s21 offen offset:0 lds
    v_max3_f32 v24, v20, v21, v22
    v_mfma_f32_16x16x32_bf16 a[72:75], a[240:243], v[216:219], a[72:75]
    v_exp_f32 v29, v89
    v_mfma_f32_16x16x32_bf16 a[76:79], a[240:243], v[220:223], a[76:79]
    v_add_f32 v23, v28, v29
    v_cvt_pk_bf16_f32 v204, v28, v29
    v_mfma_f32_16x16x32_bf16 a[80:83], a[244:247], v[208:211], a[80:83]
    v_exp_f32 v30, v90
    v_mfma_f32_16x16x32_bf16 a[84:87], a[244:247], v[212:215], a[84:87]
    buffer_load_dwordx4 v13, s[8:11], s21 offen offset:1088 lds
    v_add_f32 v23, v23, v30
    v_mfma_f32_16x16x32_bf16 a[88:91], a[244:247], v[216:219], a[88:91]
    v_exp_f32 v31, v91
    v_mfma_f32_16x16x32_bf16 a[92:95], a[244:247], v[220:223], a[92:95]
    v_add_f32 v23, v23, v31
    v_cvt_pk_bf16_f32 v205, v30, v31
    v_mfma_f32_16x16x32_bf16 a[96:99], a[248:251], v[208:211], a[96:99]
    v_exp_f32 v32, v92
    v_mfma_f32_16x16x32_bf16 a[100:103], a[248:251], v[212:215], a[100:103]
    buffer_load_dwordx4 v14, s[8:11], s21 offen offset:2176 lds
    v_add_f32 v23, v23, v32
    v_mfma_f32_16x16x32_bf16 a[104:107], a[248:251], v[216:219], a[104:107]
    v_exp_f32 v33, v93
    v_mfma_f32_16x16x32_bf16 a[108:111], a[248:251], v[220:223], a[108:111]
    v_add_f32 v23, v23, v33
    v_cvt_pk_bf16_f32 v206, v32, v33
    v_mfma_f32_16x16x32_bf16 a[112:115], a[252:255], v[208:211], a[112:115]
    v_exp_f32 v34, v94
    v_mfma_f32_16x16x32_bf16 a[116:119], a[252:255], v[212:215], a[116:119]
    buffer_load_dwordx4 v15, s[8:11], s21 offen offset:3264 lds
    v_add_f32 v23, v23, v34
    v_mfma_f32_16x16x32_bf16 a[120:123], a[252:255], v[216:219], a[120:123]
    v_exp_f32 v35, v95
    v_mfma_f32_16x16x32_bf16 a[124:127], a[252:255], v[220:223], a[124:127]
    s_add_u32 s21, s21, 16384
    v_add_f32 v23, v23, v35
    v_cvt_pk_bf16_f32 v207, v34, v35
    v_max_f32 v24, v24, v23
    v_cmp_lt_f32 vcc, s25, v24
    s_waitcnt lgkmcnt(0)
    s_cbranch_vccnz rare_stub_5
rare_back_6:
    v_mfma_f32_16x16x32_bf16 v[64:67], a[192:195], v[128:131], v[40:43]
    v_exp_f32 v28, v96
    v_mfma_f32_16x16x32_bf16 v[72:75], a[192:195], v[132:135], v[44:47]
    ds_read_b64_tr_b16 a[224:225], v4 offset:17408
    ds_read_b64_tr_b16 a[226:227], v4 offset:21760
    v_add_f32 v16, v16, v20
    v_add_f32 v17, v17, v21
    v_mfma_f32_16x16x32_bf16 v[80:83], a[192:195], v[136:139], v[48:51]
    v_exp_f32 v29, v97
    v_mfma_f32_16x16x32_bf16 v[88:91], a[192:195], v[140:143], v[52:55]
    v_add_f32 v20, v28, v29
    v_cvt_pk_bf16_f32 v208, v28, v29
    v_mfma_f32_16x16x32_bf16 v[64:67], a[196:199], v[144:147], v[64:67]
    v_exp_f32 v30, v98
    v_mfma_f32_16x16x32_bf16 v[72:75], a[196:199], v[148:151], v[72:75]
    ds_read_b64_tr_b16 a[228:229], v5 offset:17440
    ds_read_b64_tr_b16 a[230:231], v5 offset:21792
    v_add_f32 v20, v20, v30
    v_mfma_f32_16x16x32_bf16 v[80:83], a[196:199], v[152:155], v[80:83]
    v_exp_f32 v31, v99
    v_mfma_f32_16x16x32_bf16 v[88:91], a[196:199], v[156:159], v[88:91]
    v_add_f32 v20, v20, v31
    v_cvt_pk_bf16_f32 v209, v30, v31
    v_mfma_f32_16x16x32_bf16 v[64:67], a[200:203], v[160:163], v[64:67]
    v_exp_f32 v32, v100
    v_mfma_f32_16x16x32_bf16 v[72:75], a[200:203], v[164:167], v[72:75]
    ds_read_b64_tr_b16 a[232:233], v4 offset:17472
    ds_read_b64_tr_b16 a[234:235], v4 offset:21824
    v_add_f32 v20, v20, v32
    v_mfma_f32_16x16x32_bf16 v[80:83], a[200:203], v[168:171], v[80:83]
    v_exp_f32 v33, v101
    v_mfma_f32_16x16x32_bf16 v[88:91], a[200:203], v[172:175], v[88:91]
    v_add_f32 v20, v20, v33
    v_cvt_pk_bf16_f32 v210, v32, v33
    v_mfma_f32_16x16x32_bf16 v[64:67], a[204:207], v[176:179], v[64:67]
    v_exp_f32 v34, v102
    v_mfma_f32_16x16x32_bf16 v[72:75], a[204:207], v[180:183], v[72:75]
    ds_read_b64_tr_b16 a[236:237], v5 offset:17504
    ds_read_b64_tr_b16 a[238:239], v5 offset:21856
    v_add_f32 v20, v20, v34
    v_mfma_f32_16x16x32_bf16 v[80:83], a[204:207], v[184:187], v[80:83]
    v_exp_f32 v35, v103
    v_mfma_f32_16x16x32_bf16 v[88:91], a[204:207], v[188:191], v[88:91]
    v_add_f32 v20, v20, v35
    v_cvt_pk_bf16_f32 v211, v34, v35
    v_mfma_f32_16x16x32_bf16 v[68:71], a[208:211], v[128:131], v[40:43]
    v_exp_f32 v28, v104
    v_mfma_f32_16x16x32_bf16 v[76:79], a[208:211], v[132:135], v[44:47]
    ds_read_b64_tr_b16 a[240:241], v4 offset:17536
    ds_read_b64_tr_b16 a[242:243], v4 offset:21888
    v_add_f32 v18, v18, v22
    v_add_f32 v19, v19, v23
    v_mfma_f32_16x16x32_bf16 v[84:87], a[208:211], v[136:139], v[48:51]
    v_exp_f32 v29, v105
    v_mfma_f32_16x16x32_bf16 v[92:95], a[208:211], v[140:143], v[52:55]
    v_add_f32 v21, v28, v29
    v_cvt_pk_bf16_f32 v212, v28, v29
    v_mfma_f32_16x16x32_bf16 v[68:71], a[212:215], v[144:147], v[68:71]
    v_exp_f32 v30, v106
    v_mfma_f32_16x16x32_bf16 v[76:79], a[212:215], v[148:151], v[76:79]
    ds_read_b64_tr_b16 a[244:245], v5 offset:17568
    ds_read_b64_tr_b16 a[246:247], v5 offset:21920
    v_add_f32 v21, v21, v30
    v_mfma_f32_16x16x32_bf16 v[84:87], a[212:215], v[152:155], v[84:87]
    v_exp_f32 v31, v107
    v_mfma_f32_16x16x32_bf16 v[92:95], a[212:215], v[156:159], v[92:95]
    v_add_f32 v21, v21, v31
    v_cvt_pk_bf16_f32 v213, v30, v31
    v_mfma_f32_16x16x32_bf16 v[68:71], a[216:219], v[160:163], v[68:71]
    v_exp_f32 v32, v108
    v_mfma_f32_16x16x32_bf16 v[76:79], a[216:219], v[164:167], v[76:79]
    ds_read_b64_tr_b16 a[248:249], v4 offset:17600
    ds_read_b64_tr_b16 a[250:251], v4 offset:21952
    v_add_f32 v21, v21, v32
    v_mfma_f32_16x16x32_bf16 v[84:87], a[216:219], v[168:171], v[84:87]
    v_exp_f32 v33, v109
    v_mfma_f32_16x16x32_bf16 v[92:95], a[216:219], v[172:175], v[92:95]
    v_add_f32 v21, v21, v33
    v_cvt_pk_bf16_f32 v214, v32, v33
    v_mfma_f32_16x16x32_bf16 v[68:71], a[220:223], v[176:179], v[68:71]
    v_exp_f32 v34, v110
    v_mfma_f32_16x16x32_bf16 v[76:79], a[220:223], v[180:183], v[76:79]
    ds_read_b64_tr_b16 a[252:253], v5 offset:17632
    ds_read_b64_tr_b16 a[254:255], v5 offset:21984
    v_add_f32 v21, v21, v34
    v_mfma_f32_16x16x32_bf16 v[84:87], a[220:223], v[184:187], v[84:87]
    v_exp_f32 v35, v111
    v_mfma_f32_16x16x32_bf16 v[92:95], a[220:223], v[188:191], v[92:95]
    v_add_f32 v21, v21, v35
    v_cvt_pk_bf16_f32 v215, v34, v35
    s_waitcnt lgkmcnt(0)
    v_mfma_f32_16x16x32_bf16 a[0:3], a[224:227], v[192:195], a[0:3]
    v_exp_f32 v28, v112
    v_mfma_f32_16x16x32_bf16 a[4:7], a[224:227], v[196:199], a[4:7]
    ds_read_b128 a[192:195], v2 offset:43520
    ds_read_b128 a[196:199], v2 offset:43584
    v_mfma_f32_16x16x32_bf16 a[8:11], a[224:227], v[200:203], a[8:11]
    v_exp_f32 v29, v113
    v_mfma_f32_16x16x32_bf16 a[12:15], a[224:227], v[204:207], a[12:15]
    v_add_f32 v22, v28, v29
    v_cvt_pk_bf16_f32 v216, v28, v29
    v_mfma_f32_16x16x32_bf16 a[16:19], a[228:231], v[192:195], a[16:19]
    v_exp_f32 v30, v114
    v_mfma_f32_16x16x32_bf16 a[20:23], a[228:231], v[196:199], a[20:23]
    ds_read_b128 a[200:203], v2 offset:43648
    ds_read_b128 a[204:207], v2 offset:43712
    v_add_f32 v22, v22, v30
    v_mfma_f32_16x16x32_bf16 a[24:27], a[228:231], v[200:203], a[24:27]
    v_exp_f32 v31, v115
    v_mfma_f32_16x16x32_bf16 a[28:31], a[228:231], v[204:207], a[28:31]
    v_add_f32 v22, v22, v31
    v_cvt_pk_bf16_f32 v217, v30, v31
    v_mfma_f32_16x16x32_bf16 a[32:35], a[232:235], v[192:195], a[32:35]
    v_exp_f32 v32, v116
    v_mfma_f32_16x16x32_bf16 a[36:39], a[232:235], v[196:199], a[36:39]
    ds_read_b128 a[208:211], v2 offset:47872
    ds_read_b128 a[212:215], v2 offset:47936
    v_add_f32 v22, v22, v32
    v_mfma_f32_16x16x32_bf16 a[40:43], a[232:235], v[200:203], a[40:43]
    v_exp_f32 v33, v117
    v_mfma_f32_16x16x32_bf16 a[44:47], a[232:235], v[204:207], a[44:47]
    v_add_f32 v22, v22, v33
    v_cvt_pk_bf16_f32 v218, v32, v33
    v_mfma_f32_16x16x32_bf16 a[48:51], a[236:239], v[192:195], a[48:51]
    v_exp_f32 v34, v118
    v_mfma_f32_16x16x32_bf16 a[52:55], a[236:239], v[196:199], a[52:55]
    ds_read_b128 a[216:219], v2 offset:48000
    ds_read_b128 a[220:223], v2 offset:48064
    v_add_f32 v22, v22, v34
    v_mfma_f32_16x16x32_bf16 a[56:59], a[236:239], v[200:203], a[56:59]
    v_exp_f32 v35, v119
    v_mfma_f32_16x16x32_bf16 a[60:63], a[236:239], v[204:207], a[60:63]
    s_add_u32 m0, s22, 17408
    v_add_f32 v22, v22, v35
    v_cvt_pk_bf16_f32 v219, v34, v35
    v_mfma_f32_16x16x32_bf16 a[64:67], a[240:243], v[192:195], a[64:67]
    v_exp_f32 v28, v120
    v_mfma_f32_16x16x32_bf16 a[68:71], a[240:243], v[196:199], a[68:71]
    buffer_load_dwordx4 v8, s[4:7], s20 offen offset:0 lds
    v_max3_f32 v24, v20, v21, v22
    v_mfma_f32_16x16x32_bf16 a[72:75], a[240:243], v[200:203], a[72:75]
    v_exp_f32 v29, v121
    v_mfma_f32_16x16x32_bf16 a[76:79], a[240:243], v[204:207], a[76:79]
    v_add_f32 v23, v28, v29
    v_cvt_pk_bf16_f32 v220, v28, v29
    v_mfma_f32_16x16x32_bf16 a[80:83], a[244:247], v[192:195], a[80:83]
    v_exp_f32 v30, v122
    v_mfma_f32_16x16x32_bf16 a[84:87], a[244:247], v[196:199], a[84:87]
    buffer_load_dwordx4 v9, s[4:7], s20 offen offset:1088 lds
    v_add_f32 v23, v23, v30
    v_mfma_f32_16x16x32_bf16 a[88:91], a[244:247], v[200:203], a[88:91]
    v_exp_f32 v31, v123
    v_mfma_f32_16x16x32_bf16 a[92:95], a[244:247], v[204:207], a[92:95]
    v_add_f32 v23, v23, v31
    v_cvt_pk_bf16_f32 v221, v30, v31
    v_mfma_f32_16x16x32_bf16 a[96:99], a[248:251], v[192:195], a[96:99]
    v_exp_f32 v32, v124
    v_mfma_f32_16x16x32_bf16 a[100:103], a[248:251], v[196:199], a[100:103]
    buffer_load_dwordx4 v10, s[4:7], s20 offen offset:2176 lds
    v_add_f32 v23, v23, v32
    v_mfma_f32_16x16x32_bf16 a[104:107], a[248:251], v[200:203], a[104:107]
    v_exp_f32 v33, v125
    v_mfma_f32_16x16x32_bf16 a[108:111], a[248:251], v[204:207], a[108:111]
    v_add_f32 v23, v23, v33
    v_cvt_pk_bf16_f32 v222, v32, v33
    v_mfma_f32_16x16x32_bf16 a[112:115], a[252:255], v[192:195], a[112:115]
    v_exp_f32 v34, v126
    v_mfma_f32_16x16x32_bf16 a[116:119], a[252:255], v[196:199], a[116:119]
    buffer_load_dwordx4 v11, s[4:7], s20 offen offset:3264 lds
    v_add_f32 v23, v23, v34
    v_mfma_f32_16x16x32_bf16 a[120:123], a[252:255], v[200:203], a[120:123]
    v_exp_f32 v35, v127
    v_mfma_f32_16x16x32_bf16 a[124:127], a[252:255], v[204:207], a[124:127]
    s_add_u32 s20, s20, 16384
    v_add_f32 v23, v23, v35
    v_cvt_pk_bf16_f32 v223, v34, v35
    v_max_f32 v24, v24, v23
    v_cmp_lt_f32 vcc, s25, v24
    s_waitcnt lgkmcnt(0)
    s_cbranch_vccnz rare_stub_7
rare_back_8:
    v_mfma_f32_16x16x32_bf16 v[96:99], a[192:195], v[128:131], v[40:43]
    v_exp_f32 v28, v64
    v_mfma_f32_16x16x32_bf16 v[104:107], a[192:195], v[132:135], v[44:47]
    ds_read_b64_tr_b16 a[224:225], v4 offset:26112
    ds_read_b64_tr_b16 a[226:227], v4 offset:30464
    v_add_f32 v16, v16, v20
    v_add_f32 v17, v17, v21
    v_mfma_f32_16x16x32_bf16 v[112:115], a[192:195], v[136:139], v[48:51]
    v_exp_f32 v29, v65
    v_mfma_f32_16x16x32_bf16 v[120:123], a[192:195], v[140:143], v[52:55]
    v_add_f32 v20, v28, v29
    v_cvt_pk_bf16_f32 v192, v28, v29
    v_mfma_f32_16x16x32_bf16 v[96:99], a[196:199], v[144:147], v[96:99]
    v_exp_f32 v30, v66
    v_mfma_f32_16x16x32_bf16 v[104:107], a[196:199], v[148:151], v[104:107]
    ds_read_b64_tr_b16 a[228:229], v5 offset:26144
    ds_read_b64_tr_b16 a[230:231], v5 offset:30496
    v_add_f32 v20, v20, v30
    v_mfma_f32_16x16x32_bf16 v[112:115], a[196:199], v[152:155], v[112:115]
    v_exp_f32 v31, v67
    v_mfma_f32_16x16x32_bf16 v[120:123], a[196:199], v[156:159], v[120:123]
    v_add_f32 v20, v20, v31
    v_cvt_pk_bf16_f32 v193, v30, v31
    v_mfma_f32_16x16x32_bf16 v[96:99], a[200:203], v[160:163], v[96:99]
    v_exp_f32 v32, v68
    v_mfma_f32_16x16x32_bf16 v[104:107], a[200:203], v[164:167], v[104:107]
    ds_read_b64_tr_b16 a[232:233], v4 offset:26176
    ds_read_b64_tr_b16 a[234:235], v4 offset:30528
    v_add_f32 v20, v20, v32
    v_mfma_f32_16x16x32_bf16 v[112:115], a[200:203], v[168:171], v[112:115]
    v_exp_f32 v33, v69
    v_mfma_f32_16x16x32_bf16 v[120:123], a[200:203], v[172:175], v[120:123]
    v_add_f32 v20, v20, v33
    v_cvt_pk_bf16_f32 v194, v32, v33
    v_mfma_f32_16x16x32_bf16 v[96:99], a[204:207], v[176:179], v[96:99]
    v_exp_f32 v34, v70
    v_mfma_f32_16x16x32_bf16 v[104:107], a[204:207], v[180:183], v[104:107]
    ds_read_b64_tr_b16 a[236:237], v5 offset:26208
    ds_read_b64_tr_b16 a[238:239], v5 offset:30560
    v_add_f32 v20, v20, v34
    v_mfma_f32_16x16x32_bf16 v[112:115], a[204:207], v[184:187], v[112:115]
    v_exp_f32 v35, v71
    v_mfma_f32_16x16x32_bf16 v[120:123], a[204:207], v[188:191], v[120:123]
    v_add_f32 v20, v20, v35
    v_cvt_pk_bf16_f32 v195, v34, v35
    v_mfma_f32_16x16x32_bf16 v[100:103], a[208:211], v[128:131], v[40:43]
    v_exp_f32 v28, v72
    v_mfma_f32_16x16x32_bf16 v[108:111], a[208:211], v[132:135], v[44:47]
    ds_read_b64_tr_b16 a[240:241], v4 offset:26240
    ds_read_b64_tr_b16 a[242:243], v4 offset:30592
    v_add_f32 v18, v18, v22
    v_add_f32 v19, v19, v23
    v_mfma_f32_16x16x32_bf16 v[116:119], a[208:211], v[136:139], v[48:51]
    v_exp_f32 v29, v73
    v_mfma_f32_16x16x32_bf16 v[124:127], a[208:211], v[140:143], v[52:55]
    v_add_f32 v21, v28, v29
    v_cvt_pk_bf16_f32 v196, v28, v29
    v_mfma_f32_16x16x32_bf16 v[100:103], a[212:215], v[144:147], v[100:103]
    v_exp_f32 v30, v74
    v_mfma_f32_16x16x32_bf16 v[108:111], a[212:215], v[148:151], v[108:111]
    ds_read_b64_tr_b16 a[244:245], v5 offset:26272
    ds_read_b64_tr_b16 a[246:247], v5 offset:30624
    v_add_f32 v21, v21, v30
    v_mfma_f32_16x16x32_bf16 v[116:119], a[212:215], v[152:155], v[116:119]
    v_exp_f32 v31, v75
    v_mfma_f32_16x16x32_bf16 v[124:127], a[212:215], v[156:159], v[124:127]
    v_add_f32 v21, v21, v31
    v_cvt_pk_bf16_f32 v197, v30, v31
    v_mfma_f32_16x16x32_bf16 v[100:103], a[216:219], v[160:163], v[100:103]
    v_exp_f32 v32, v76
    v_mfma_f32_16x16x32_bf16 v[108:111], a[216:219], v[164:167], v[108:111]
    ds_read_b64_tr_b16 a[248:249], v4 offset:26304
    ds_read_b64_tr_b16 a[250:251], v4 offset:30656
    v_add_f32 v21, v21, v32
    v_mfma_f32_16x16x32_bf16 v[116:119], a[216:219], v[168:171], v[116:119]
    v_exp_f32 v33, v77
    v_mfma_f32_16x16x32_bf16 v[124:127], a[216:219], v[172:175], v[124:127]
    v_add_f32 v21, v21, v33
    v_cvt_pk_bf16_f32 v198, v32, v33
    v_mfma_f32_16x16x32_bf16 v[100:103], a[220:223], v[176:179], v[100:103]
    v_exp_f32 v34, v78
    v_mfma_f32_16x16x32_bf16 v[108:111], a[220:223], v[180:183], v[108:111]
    ds_read_b64_tr_b16 a[252:253], v5 offset:26336
    ds_read_b64_tr_b16 a[254:255], v5 offset:30688
    v_add_f32 v21, v21, v34
    v_mfma_f32_16x16x32_bf16 v[116:119], a[220:223], v[184:187], v[116:119]
    v_exp_f32 v35, v79
    v_mfma_f32_16x16x32_bf16 v[124:127], a[220:223], v[188:191], v[124:127]
    v_add_f32 v21, v21, v35
    v_cvt_pk_bf16_f32 v199, v34, v35
    s_waitcnt vmcnt(12) lgkmcnt(0)
    s_barrier
    v_mfma_f32_16x16x32_bf16 a[0:3], a[224:227], v[208:211], a[0:3]
    v_exp_f32 v28, v80
    v_mfma_f32_16x16x32_bf16 a[4:7], a[224:227], v[212:215], a[4:7]
    ds_read_b128 a[192:195], v2 offset:52224
    ds_read_b128 a[196:199], v2 offset:52288
    v_mfma_f32_16x16x32_bf16 a[8:11], a[224:227], v[216:219], a[8:11]
    v_exp_f32 v29, v81
    v_mfma_f32_16x16x32_bf16 a[12:15], a[224:227], v[220:223], a[12:15]
    v_add_f32 v22, v28, v29
    v_cvt_pk_bf16_f32 v200, v28, v29
    v_mfma_f32_16x16x32_bf16 a[16:19], a[228:231], v[208:211], a[16:19]
    v_exp_f32 v30, v82
    v_mfma_f32_16x16x32_bf16 a[20:23], a[228:231], v[212:215], a[20:23]
    ds_read_b128 a[200:203], v2 offset:52352
    ds_read_b128 a[204:207], v2 offset:52416
    v_add_f32 v22, v22, v30
    v_mfma_f32_16x16x32_bf16 a[24:27], a[228:231], v[216:219], a[24:27]
    v_exp_f32 v31, v83
    v_mfma_f32_16x16x32_bf16 a[28:31], a[228:231], v[220:223], a[28:31]
    v_add_f32 v22, v22, v31
    v_cvt_pk_bf16_f32 v201, v30, v31
    v_mfma_f32_16x16x32_bf16 a[32:35], a[232:235], v[208:211], a[32:35]
    v_exp_f32 v32, v84
    v_mfma_f32_16x16x32_bf16 a[36:39], a[232:235], v[212:215], a[36:39]
    ds_read_b128 a[208:211], v2 offset:56576
    ds_read_b128 a[212:215], v2 offset:56640
    v_add_f32 v22, v22, v32
    v_mfma_f32_16x16x32_bf16 a[40:43], a[232:235], v[216:219], a[40:43]
    v_exp_f32 v33, v85
    v_mfma_f32_16x16x32_bf16 a[44:47], a[232:235], v[220:223], a[44:47]
    v_add_f32 v22, v22, v33
    v_cvt_pk_bf16_f32 v202, v32, v33
    v_mfma_f32_16x16x32_bf16 a[48:51], a[236:239], v[208:211], a[48:51]
    v_exp_f32 v34, v86
    v_mfma_f32_16x16x32_bf16 a[52:55], a[236:239], v[212:215], a[52:55]
    ds_read_b128 a[216:219], v2 offset:56704
    ds_read_b128 a[220:223], v2 offset:56768
    v_add_f32 v22, v22, v34
    v_mfma_f32_16x16x32_bf16 a[56:59], a[236:239], v[216:219], a[56:59]
    v_exp_f32 v35, v87
    v_mfma_f32_16x16x32_bf16 a[60:63], a[236:239], v[220:223], a[60:63]
    s_add_u32 m0, s23, 0
    v_add_f32 v22, v22, v35
    v_cvt_pk_bf16_f32 v203, v34, v35
    v_mfma_f32_16x16x32_bf16 a[64:67], a[240:243], v[208:211], a[64:67]
    v_exp_f32 v28, v88
    v_mfma_f32_16x16x32_bf16 a[68:71], a[240:243], v[212:215], a[68:71]
    buffer_load_dwordx4 v12, s[8:11], s21 offen offset:0 lds
    v_max3_f32 v24, v20, v21, v22
    v_mfma_f32_16x16x32_bf16 a[72:75], a[240:243], v[216:219], a[72:75]
    v_exp_f32 v29, v89
    v_mfma_f32_16x16x32_bf16 a[76:79], a[240:243], v[220:223], a[76:79]
    v_add_f32 v23, v28, v29
    v_cvt_pk_bf16_f32 v204, v28, v29
    v_mfma_f32_16x16x32_bf16 a[80:83], a[244:247], v[208:211], a[80:83]
    v_exp_f32 v30, v90
    v_mfma_f32_16x16x32_bf16 a[84:87], a[244:247], v[212:215], a[84:87]
    buffer_load_dwordx4 v13, s[8:11], s21 offen offset:1088 lds
    v_add_f32 v23, v23, v30
    v_mfma_f32_16x16x32_bf16 a[88:91], a[244:247], v[216:219], a[88:91]
    v_exp_f32 v31, v91
    v_mfma_f32_16x16x32_bf16 a[92:95], a[244:247], v[220:223], a[92:95]
    v_add_f32 v23, v23, v31
    v_cvt_pk_bf16_f32 v205, v30, v31
    v_mfma_f32_16x16x32_bf16 a[96:99], a[248:251], v[208:211], a[96:99]
    v_exp_f32 v32, v92
    v_mfma_f32_16x16x32_bf16 a[100:103], a[248:251], v[212:215], a[100:103]
    buffer_load_dwordx4 v14, s[8:11], s21 offen offset:2176 lds
    v_add_f32 v23, v23, v32
    v_mfma_f32_16x16x32_bf16 a[104:107], a[248:251], v[216:219], a[104:107]
    v_exp_f32 v33, v93
    v_mfma_f32_16x16x32_bf16 a[108:111], a[248:251], v[220:223], a[108:111]
    v_add_f32 v23, v23, v33
    v_cvt_pk_bf16_f32 v206, v32, v33
    v_mfma_f32_16x16x32_bf16 a[112:115], a[252:255], v[208:211], a[112:115]
    v_exp_f32 v34, v94
    v_mfma_f32_16x16x32_bf16 a[116:119], a[252:255], v[212:215], a[116:119]
    buffer_load_dwordx4 v15, s[8:11], s21 offen offset:3264 lds
    v_add_f32 v23, v23, v34
    v_mfma_f32_16x16x32_bf16 a[120:123], a[252:255], v[216:219], a[120:123]
    v_exp_f32 v35, v95
    v_mfma_f32_16x16x32_bf16 a[124:127], a[252:255], v[220:223], a[124:127]
    s_add_u32 s21, s21, 16384
    v_add_f32 v23, v23, v35
    v_cvt_pk_bf16_f32 v207, v34, v35
    v_max_f32 v24, v24, v23
    v_cmp_lt_f32 vcc, s25, v24
    s_waitcnt lgkmcnt(0)
    s_cbranch_vccnz rare_stub_9
rare_back_10:
    v_mfma_f32_16x16x32_bf16 v[64:67], a[192:195], v[128:131], v[40:43]
    v_exp_f32 v28, v96
    v_mfma_f32_16x16x32_bf16 v[72:75], a[192:195], v[132:135], v[44:47]
    ds_read_b64_tr_b16 a[224:225], v6 offset:0
    ds_read_b64_tr_b16 a[226:227], v6 offset:4352
    v_add_f32 v16, v16, v20
    v_add_f32 v17, v17, v21
    v_mfma_f32_16x16x32_bf16 v[80:83], a[192:195], v[136:139], v[48:51]
    v_exp_f32 v29, v97
    v_mfma_f32_16x16x32_bf16 v[88:91], a[192:195], v[140:143], v[52:55]
    v_add_f32 v20, v28, v29
    v_cvt_pk_bf16_f32 v208, v28, v29
    v_mfma_f32_16x16x32_bf16 v[64:67], a[196:199], v[144:147], v[64:67]
    v_exp_f32 v30, v98
    v_mfma_f32_16x16x32_bf16 v[72:75], a[196:199], v[148:151], v[72:75]
    ds_read_b64_tr_b16 a[228:229], v7 offset:32
    ds_read_b64_tr_b16 a[230:231], v7 offset:4384
    v_add_f32 v20, v20, v30
    v_mfma_f32_16x16x32_bf16 v[80:83], a[196:199], v[152:155], v[80:83]
    v_exp_f32 v31, v99
    v_mfma_f32_16x16x32_bf16 v[88:91], a[196:199], v[156:159], v[88:91]
    v_add_f32 v20, v20, v31
    v_cvt_pk_bf16_f32 v209, v30, v31
    v_mfma_f32_16x16x32_bf16 v[64:67], a[200:203], v[160:163], v[64:67]
    v_exp_f32 v32, v100
    v_mfma_f32_16x16x32_bf16 v[72:75], a[200:203], v[164:167], v[72:75]
    ds_read_b64_tr_b16 a[232:233], v6 offset:64
    ds_read_b64_tr_b16 a[234:235], v6 offset:4416
    v_add_f32 v20, v20, v32
    v_mfma_f32_16x16x32_bf16 v[80:83], a[200:203], v[168:171], v[80:83]
    v_exp_f32 v33, v101
    v_mfma_f32_16x16x32_bf16 v[88:91], a[200:203], v[172:175], v[88:91]
    v_add_f32 v20, v20, v33
    v_cvt_pk_bf16_f32 v210, v32, v33
    v_mfma_f32_16x16x32_bf16 v[64:67], a[204:207], v[176:179], v[64:67]
    v_exp_f32 v34, v102
    v_mfma_f32_16x16x32_bf16 v[72:75], a[204:207], v[180:183], v[72:75]
    ds_read_b64_tr_b16 a[236:237], v7 offset:96
    ds_read_b64_tr_b16 a[238:239], v7 offset:4448
    v_add_f32 v20, v20, v34
    v_mfma_f32_16x16x32_bf16 v[80:83], a[204:207], v[184:187], v[80:83]
    v_exp_f32 v35, v103
    v_mfma_f32_16x16x32_bf16 v[88:91], a[204:207], v[188:191], v[88:91]
    v_add_f32 v20, v20, v35
    v_cvt_pk_bf16_f32 v211, v34, v35
    v_mfma_f32_16x16x32_bf16 v[68:71], a[208:211], v[128:131], v[40:43]
    v_exp_f32 v28, v104
    v_mfma_f32_16x16x32_bf16 v[76:79], a[208:211], v[132:135], v[44:47]
    ds_read_b64_tr_b16 a[240:241], v6 offset:128
    ds_read_b64_tr_b16 a[242:243], v6 offset:4480
    v_add_f32 v18, v18, v22
    v_add_f32 v19, v19, v23
    v_mfma_f32_16x16x32_bf16 v[84:87], a[208:211], v[136:139], v[48:51]
    v_exp_f32 v29, v105
    v_mfma_f32_16x16x32_bf16 v[92:95], a[208:211], v[140:143], v[52:55]
    v_add_f32 v21, v28, v29
    v_cvt_pk_bf16_f32 v212, v28, v29
    v_mfma_f32_16x16x32_bf16 v[68:71], a[212:215], v[144:147], v[68:71]
    v_exp_f32 v30, v106
    v_mfma_f32_16x16x32_bf16 v[76:79], a[212:215], v[148:151], v[76:79]
    ds_read_b64_tr_b16 a[244:245], v7 offset:160
    ds_read_b64_tr_b16 a[246:247], v7 offset:4512
    v_add_f32 v21, v21, v30
    v_mfma_f32_16x16x32_bf16 v[84:87], a[212:215], v[152:155], v[84:87]
    v_exp_f32 v31, v107
    v_mfma_f32_16x16x32_bf16 v[92:95], a[212:215], v[156:159], v[92:95]
    v_add_f32 v21, v21, v31
    v_cvt_pk_bf16_f32 v213, v30, v31
    v_mfma_f32_16x16x32_bf16 v[68:71], a[216:219], v[160:163], v[68:71]
    v_exp_f32 v32, v108
    v_mfma_f32_16x16x32_bf16 v[76:79], a[216:219], v[164:167], v[76:79]
    ds_read_b64_tr_b16 a[248:249], v6 offset:192
    ds_read_b64_tr_b16 a[250:251], v6 offset:4544
    v_add_f32 v21, v21, v32
    v_mfma_f32_16x16x32_bf16 v[84:87], a[216:219], v[168:171], v[84:87]
    v_exp_f32 v33, v109
    v_mfma_f32_16x16x32_bf16 v[92:95], a[216:219], v[172:175], v[92:95]
    v_add_f32 v21, v21, v33
    v_cvt_pk_bf16_f32 v214, v32, v33
    v_mfma_f32_16x16x32_bf16 v[68:71], a[220:223], v[176:179], v[68:71]
    v_exp_f32 v34, v110
    v_mfma_f32_16x16x32_bf16 v[76:79], a[220:223], v[180:183], v[76:79]
    ds_read_b64_tr_b16 a[252:253], v7 offset:224
    ds_read_b64_tr_b16 a[254:255], v7 offset:4576
    v_add_f32 v21, v21, v34
    v_mfma_f32_16x16x32_bf16 v[84:87], a[220:223], v[184:187], v[84:87]
    v_exp_f32 v35, v111
    v_mfma_f32_16x16x32_bf16 v[92:95], a[220:223], v[188:191], v[92:95]
    v_add_f32 v21, v21, v35
    v_cvt_pk_bf16_f32 v215, v34, v35
    s_waitcnt lgkmcnt(0)
    v_mfma_f32_16x16x32_bf16 a[0:3], a[224:227], v[192:195], a[0:3]
    v_exp_f32 v28, v112
    v_mfma_f32_16x16x32_bf16 a[4:7], a[224:227], v[196:199], a[4:7]
    ds_read_b128 a[192:195], v2 offset:60928
    ds_read_b128 a[196:199], v2 offset:60992
    v_mfma_f32_16x16x32_bf16 a[8:11], a[224:227], v[200:203], a[8:11]
    v_exp_f32 v29, v113
    v_mfma_f32_16x16x32_bf16 a[12:15], a[224:227], v[204:207], a[12:15]
    v_add_f32 v22, v28, v29
    v_cvt_pk_bf16_f32 v216, v28, v29
    v_mfma_f32_16x16x32_bf16 a[16:19], a[228:231], v[192:195], a[16:19]
    v_exp_f32 v30, v114
    v_mfma_f32_16x16x32_bf16 a[20:23], a[228:231], v[196:199], a[20:23]
    ds_read_b128 a[200:203], v2 offset:61056
    ds_read_b128 a[204:207], v2 offset:61120
    v_add_f32 v22, v22, v30
    v_mfma_f32_16x16x32_bf16 a[24:27], a[228:231], v[200:203], a[24:27]
    v_exp_f32 v31, v115
    v_mfma_f32_16x16x32_bf16 a[28:31], a[228:231], v[204:207], a[28:31]
    v_add_f32 v22, v22, v31
    v_cvt_pk_bf16_f32 v217, v30, v31
    v_mfma_f32_16x16x32_bf16 a[32:35], a[232:235], v[192:195], a[32:35]
    v_exp_f32 v32, v116
    v_mfma_f32_16x16x32_bf16 a[36:39], a[232:235], v[196:199], a[36:39]
    ds_read_b128 a[208:211], v2 offset:65280
    ds_read_b128 a[212:215], v2 offset:65344
    v_add_f32 v22, v22, v32
    v_mfma_f32_16x16x32_bf16 a[40:43], a[232:235], v[200:203], a[40:43]
    v_exp_f32 v33, v117
    v_mfma_f32_16x16x32_bf16 a[44:47], a[232:235], v[204:207], a[44:47]
    v_add_f32 v22, v22, v33
    v_cvt_pk_bf16_f32 v218, v32, v33
    v_mfma_f32_16x16x32_bf16 a[48:51], a[236:239], v[192:195], a[48:51]
    v_exp_f32 v34, v118
    v_mfma_f32_16x16x32_bf16 a[52:55], a[236:239], v[196:199], a[52:55]
    ds_read_b128 a[216:219], v2 offset:65408
    ds_read_b128 a[220:223], v2 offset:65472
    v_add_f32 v22, v22, v34
    v_mfma_f32_16x16x32_bf16 a[56:59], a[236:239], v[200:203], a[56:59]
    v_exp_f32 v35, v119
    v_mfma_f32_16x16x32_bf16 a[60:63], a[236:239], v[204:207], a[60:63]
    s_add_u32 m0, s22, 34816
    v_add_f32 v22, v22, v35
    v_cvt_pk_bf16_f32 v219, v34, v35
    v_mfma_f32_16x16x32_bf16 a[64:67], a[240:243], v[192:195], a[64:67]
    v_exp_f32 v28, v120
    v_mfma_f32_16x16x32_bf16 a[68:71], a[240:243], v[196:199], a[68:71]
    buffer_load_dwordx4 v8, s[4:7], s20 offen offset:0 lds
    v_max3_f32 v24, v20, v21, v22
    v_mfma_f32_16x16x32_bf16 a[72:75], a[240:243], v[200:203], a[72:75]
    v_exp_f32 v29, v121
    v_mfma_f32_16x16x32_bf16 a[76:79], a[240:243], v[204:207], a[76:79]
    v_add_f32 v23, v28, v29
    v_cvt_pk_bf16_f32 v220, v28, v29
    v_mfma_f32_16x16x32_bf16 a[80:83], a[244:247], v[192:195], a[80:83]
    v_exp_f32 v30, v122
    v_mfma_f32_16x16x32_bf16 a[84:87], a[244:247], v[196:199], a[84:87]
    buffer_load_dwordx4 v9, s[4:7], s20 offen offset:1088 lds
    v_add_f32 v23, v23, v30
    v_mfma_f32_16x16x32_bf16 a[88:91], a[244:247], v[200:203], a[88:91]
    v_exp_f32 v31, v123
    v_mfma_f32_16x16x32_bf16 a[92:95], a[244:247], v[204:207], a[92:95]
    v_add_f32 v23, v23, v31
    v_cvt_pk_bf16_f32 v221, v30, v31
    v_mfma_f32_16x16x32_bf16 a[96:99], a[248:251], v[192:195], a[96:99]
    v_exp_f32 v32, v124
    v_mfma_f32_16x16x32_bf16 a[100:103], a[248:251], v[196:199], a[100:103]
    buffer_load_dwordx4 v10, s[4:7], s20 offen offset:2176 lds
    v_add_f32 v23, v23, v32
    v_mfma_f32_16x16x32_bf16 a[104:107], a[248:251], v[200:203], a[104:107]
    v_exp_f32 v33, v125
    v_mfma_f32_16x16x32_bf16 a[108:111], a[248:251], v[204:207], a[108:111]
    v_add_f32 v23, v23, v33
    v_cvt_pk_bf16_f32 v222, v32, v33
    v_mfma_f32_16x16x32_bf16 a[112:115], a[252:255], v[192:195], a[112:115]
    v_exp_f32 v34, v126
    v_mfma_f32_16x16x32_bf16 a[116:119], a[252:255], v[196:199], a[116:119]
    buffer_load_dwordx4 v11, s[4:7], s20 offen offset:3264 lds
    v_add_f32 v23, v23, v34
    v_mfma_f32_16x16x32_bf16 a[120:123], a[252:255], v[200:203], a[120:123]
    v_exp_f32 v35, v127
    v_mfma_f32_16x16x32_bf16 a[124:127], a[252:255], v[204:207], a[124:127]
    s_add_u32 s20, s20, 16384
    v_add_f32 v23, v23, v35
    v_cvt_pk_bf16_f32 v223, v34, v35
    v_max_f32 v24, v24, v23
    v_cmp_lt_f32 vcc, s25, v24
    s_waitcnt lgkmcnt(0)
    s_cbranch_vccnz rare_stub_11
rare_back_12:
    v_mfma_f32_16x16x32_bf16 v[96:99], a[192:195], v[128:131], v[40:43]
    v_exp_f32 v28, v64
    v_mfma_f32_16x16x32_bf16 v[104:107], a[192:195], v[132:135], v[44:47]
    ds_read_b64_tr_b16 a[224:225], v6 offset:8704
    ds_read_b64_tr_b16 a[226:227], v6 offset:13056
    v_add_f32 v16, v16, v20
    v_add_f32 v17, v17, v21
    v_mfma_f32_16x16x32_bf16 v[112:115], a[192:195], v[136:139], v[48:51]
    v_exp_f32 v29, v65
    v_mfma_f32_16x16x32_bf16 v[120:123], a[192:195], v[140:143], v[52:55]
    v_add_f32 v20, v28, v29
    v_cvt_pk_bf16_f32 v192, v28, v29
    v_mfma_f32_16x16x32_bf16 v[96:99], a[196:199], v[144:147], v[96:99]
    v_exp_f32 v30, v66
    v_mfma_f32_16x16x32_bf16 v[104:107], a[196:199], v[148:151], v[104:107]
    ds_read_b64_tr_b16 a[228:229], v7 offset:8736
    ds_read_b64_tr_b16 a[230:231], v7 offset:13088
    v_add_f32 v20, v20, v30
    v_mfma_f32_16x16x32_bf16 v[112:115], a[196:199], v[152:155], v[112:115]
    v_exp_f32 v31, v67
    v_mfma_f32_16x16x32_bf16 v[120:123], a[196:199], v[156:159], v[120:123]
    v_add_f32 v20, v20, v31
    v_cvt_pk_bf16_f32 v193, v30, v31
    v_mfma_f32_16x16x32_bf16 v[96:99], a[200:203], v[160:163], v[96:99]
    v_exp_f32 v32, v68
    v_mfma_f32_16x16x32_bf16 v[104:107], a[200:203], v[164:167], v[104:107]
    ds_read_b64_tr_b16 a[232:233], v6 offset:8768
    ds_read_b64_tr_b16 a[234:235], v6 offset:13120
    v_add_f32 v20, v20, v32
    v_mfma_f32_16x16x32_bf16 v[112:115], a[200:203], v[168:171], v[112:115]
    v_exp_f32 v33, v69
    v_mfma_f32_16x16x32_bf16 v[120:123], a[200:203], v[172:175], v[120:123]
    v_add_f32 v20, v20, v33
    v_cvt_pk_bf16_f32 v194, v32, v33
    v_mfma_f32_16x16x32_bf16 v[96:99], a[204:207], v[176:179], v[96:99]
    v_exp_f32 v34, v70
    v_mfma_f32_16x16x32_bf16 v[104:107], a[204:207], v[180:183], v[104:107]
    ds_read_b64_tr_b16 a[236:237], v7 offset:8800
    ds_read_b64_tr_b16 a[238:239], v7 offset:13152
    v_add_f32 v20, v20, v34
    v_mfma_f32_16x16x32_bf16 v[112:115], a[204:207], v[184:187], v[112:115]
    v_exp_f32 v35, v71
    v_mfma_f32_16x16x32_bf16 v[120:123], a[204:207], v[188:191], v[120:123]
    v_add_f32 v20, v20, v35
    v_cvt_pk_bf16_f32 v195, v34, v35
    v_mfma_f32_16x16x32_bf16 v[100:103], a[208:211], v[128:131], v[40:43]
    v_exp_f32 v28, v72
    v_mfma_f32_16x16x32_bf16 v[108:111], a[208:211], v[132:135], v[44:47]
    ds_read_b64_tr_b16 a[240:241], v6 offset:8832
    ds_read_b64_tr_b16 a[242:243], v6 offset:13184
    v_add_f32 v18, v18, v22
    v_add_f32 v19, v19, v23
    v_mfma_f32_16x16x32_bf16 v[116:119], a[208:211], v[136:139], v[48:51]
    v_exp_f32 v29, v73
    v_mfma_f32_16x16x32_bf16 v[124:127], a[208:211], v[140:143], v[52:55]
    v_add_f32 v21, v28, v29
    v_cvt_pk_bf16_f32 v196, v28, v29
    v_mfma_f32_16x16x32_bf16 v[100:103], a[212:215], v[144:147], v[100:103]
    v_exp_f32 v30, v74
    v_mfma_f32_16x16x32_bf16 v[108:111], a[212:215], v[148:151], v[108:111]
    ds_read_b64_tr_b16 a[244:245], v7 offset:8864
    ds_read_b64_tr_b16 a[246:247], v7 offset:13216
    v_add_f32 v21, v21, v30
    v_mfma_f32_16x16x32_bf16 v[116:119], a[212:215], v[152:155], v[116:119]
    v_exp_f32 v31, v75
    v_mfma_f32_16x16x32_bf16 v[124:127], a[212:215], v[156:159], v[124:127]
    v_add_f32 v21, v21, v31
    v_cvt_pk_bf16_f32 v197, v30, v31
    v_mfma_f32_16x16x32_bf16 v[100:103], a[216:219], v[160:163], v[100:103]
    v_exp_f32 v32, v76
    v_mfma_f32_16x16x32_bf16 v[108:111], a[216:219], v[164:167], v[108:111]
    ds_read_b64_tr_b16 a[248:249], v6 offset:8896
    ds_read_b64_tr_b16 a[250:251], v6 offset:13248
    v_add_f32 v21, v21, v32
    v_mfma_f32_16x16x32_bf16 v[116:119], a[216:219], v[168:171], v[116:119]
    v_exp_f32 v33, v77
    v_mfma_f32_16x16x32_bf16 v[124:127], a[216:219], v[172:175], v[124:127]
    v_add_f32 v21, v21, v33
    v_cvt_pk_bf16_f32 v198, v32, v33
    v_mfma_f32_16x16x32_bf16 v[100:103], a[220:223], v[176:179], v[100:103]
    v_exp_f32 v34, v78
    v_mfma_f32_16x16x32_bf16 v[108:111], a[220:223], v[180:183], v[108:111]
    ds_read_b64_tr_b16 a[252:253], v7 offset:8928
    ds_read_b64_tr_b16 a[254:255], v7 offset:13280
    v_add_f32 v21, v21, v34
    v_mfma_f32_16x16x32_bf16 v[116:119], a[220:223], v[184:187], v[116:119]
    v_exp_f32 v35, v79
    v_mfma_f32_16x16x32_bf16 v[124:127], a[220:223], v[188:191], v[124:127]
    v_add_f32 v21, v21, v35
    v_cvt_pk_bf16_f32 v199, v34, v35
    s_waitcnt vmcnt(12) lgkmcnt(0)
    s_barrier
    v_mfma_f32_16x16x32_bf16 a[0:3], a[224:227], v[208:211], a[0:3]
    v_exp_f32 v28, v80
    v_mfma_f32_16x16x32_bf16 a[4:7], a[224:227], v[212:215], a[4:7]
    ds_read_b128 a[192:195], v2 offset:0
    ds_read_b128 a[196:199], v2 offset:64
    v_mfma_f32_16x16x32_bf16 a[8:11], a[224:227], v[216:219], a[8:11]
    v_exp_f32 v29, v81
    v_mfma_f32_16x16x32_bf16 a[12:15], a[224:227], v[220:223], a[12:15]
    v_add_f32 v22, v28, v29
    v_cvt_pk_bf16_f32 v200, v28, v29
    v_mfma_f32_16x16x32_bf16 a[16:19], a[228:231], v[208:211], a[16:19]
    v_exp_f32 v30, v82
    v_mfma_f32_16x16x32_bf16 a[20:23], a[228:231], v[212:215], a[20:23]
    ds_read_b128 a[200:203], v2 offset:128
    ds_read_b128 a[204:207], v2 offset:192
    v_add_f32 v22, v22, v30
    v_mfma_f32_16x16x32_bf16 a[24:27], a[228:231], v[216:219], a[24:27]
    v_exp_f32 v31, v83
    v_mfma_f32_16x16x32_bf16 a[28:31], a[228:231], v[220:223], a[28:31]
    v_add_f32 v22, v22, v31
    v_cvt_pk_bf16_f32 v201, v30, v31
    v_mfma_f32_16x16x32_bf16 a[32:35], a[232:235], v[208:211], a[32:35]
    v_exp_f32 v32, v84
    v_mfma_f32_16x16x32_bf16 a[36:39], a[232:235], v[212:215], a[36:39]
    ds_read_b128 a[208:211], v2 offset:4352
    ds_read_b128 a[212:215], v2 offset:4416
    v_add_f32 v22, v22, v32
    v_mfma_f32_16x16x32_bf16 a[40:43], a[232:235], v[216:219], a[40:43]
    v_exp_f32 v33, v85
    v_mfma_f32_16x16x32_bf16 a[44:47], a[232:235], v[220:223], a[44:47]
    v_add_f32 v22, v22, v33
    v_cvt_pk_bf16_f32 v202, v32, v33
    v_mfma_f32_16x16x32_bf16 a[48:51], a[236:239], v[208:211], a[48:51]
    v_exp_f32 v34, v86
    v_mfma_f32_16x16x32_bf16 a[52:55], a[236:239], v[212:215], a[52:55]
    ds_read_b128 a[216:219], v2 offset:4480
    ds_read_b128 a[220:223], v2 offset:4544
    v_add_f32 v22, v22, v34
    v_mfma_f32_16x16x32_bf16 a[56:59], a[236:239], v[216:219], a[56:59]
    v_exp_f32 v35, v87
    v_mfma_f32_16x16x32_bf16 a[60:63], a[236:239], v[220:223], a[60:63]
    s_add_u32 m0, s23, 17408
    v_add_f32 v22, v22, v35
    v_cvt_pk_bf16_f32 v203, v34, v35
    v_mfma_f32_16x16x32_bf16 a[64:67], a[240:243], v[208:211], a[64:67]
    v_exp_f32 v28, v88
    v_mfma_f32_16x16x32_bf16 a[68:71], a[240:243], v[212:215], a[68:71]
    buffer_load_dwordx4 v12, s[8:11], s21 offen offset:0 lds
    v_max3_f32 v24, v20, v21, v22
    v_mfma_f32_16x16x32_bf16 a[72:75], a[240:243], v[216:219], a[72:75]
    v_exp_f32 v29, v89
    v_mfma_f32_16x16x32_bf16 a[76:79], a[240:243], v[220:223], a[76:79]
    v_add_f32 v23, v28, v29
    v_cvt_pk_bf16_f32 v204, v28, v29
    v_mfma_f32_16x16x32_bf16 a[80:83], a[244:247], v[208:211], a[80:83]
    v_exp_f32 v30, v90
    v_mfma_f32_16x16x32_bf16 a[84:87], a[244:247], v[212:215], a[84:87]
    buffer_load_dwordx4 v13, s[8:11], s21 offen offset:1088 lds
    v_add_f32 v23, v23, v30
    v_mfma_f32_16x16x32_bf16 a[88:91], a[244:247], v[216:219], a[88:91]
    v_exp_f32 v31, v91
    v_mfma_f32_16x16x32_bf16 a[92:95], a[244:247], v[220:223], a[92:95]
    v_add_f32 v23, v23, v31
    v_cvt_pk_bf16_f32 v205, v30, v31
    v_mfma_f32_16x16x32_bf16 a[96:99], a[248:251], v[208:211], a[96:99]
    v_exp_f32 v32, v92
    v_mfma_f32_16x16x32_bf16 a[100:103], a[248:251], v[212:215], a[100:103]
    buffer_load_dwordx4 v14, s[8:11], s21 offen offset:2176 lds
    v_add_f32 v23, v23, v32
    v_mfma_f32_16x16x32_bf16 a[104:107], a[248:251], v[216:219], a[104:107]
    v_exp_f32 v33, v93
    v_mfma_f32_16x16x32_bf16 a[108:111], a[248:251], v[220:223], a[108:111]
    v_add_f32 v23, v23, v33
    v_cvt_pk_bf16_f32 v206, v32, v33
    v_mfma_f32_16x16x32_bf16 a[112:115], a[252:255], v[208:211], a[112:115]
    v_exp_f32 v34, v94
    v_mfma_f32_16x16x32_bf16 a[116:119], a[252:255], v[212:215], a[116:119]
    buffer_load_dwordx4 v15, s[8:11], s21 offen offset:3264 lds
    v_add_f32 v23, v23, v34
    v_mfma_f32_16x16x32_bf16 a[120:123], a[252:255], v[216:219], a[120:123]
    v_exp_f32 v35, v95
    v_mfma_f32_16x16x32_bf16 a[124:127], a[252:255], v[220:223], a[124:127]
    s_add_u32 s21, s21, 16384
    v_add_f32 v23, v23, v35
    v_cvt_pk_bf16_f32 v207, v34, v35
    v_max_f32 v24, v24, v23
    v_cmp_lt_f32 vcc, s25, v24
    s_waitcnt lgkmcnt(0)
    s_cbranch_vccnz rare_stub_13
rare_back_14:
    v_mfma_f32_16x16x32_bf16 v[64:67], a[192:195], v[128:131], v[40:43]
    v_exp_f32 v28, v96
    v_mfma_f32_16x16x32_bf16 v[72:75], a[192:195], v[132:135], v[44:47]
    ds_read_b64_tr_b16 a[224:225], v6 offset:17408
    ds_read_b64_tr_b16 a[226:227], v6 offset:21760
    v_add_f32 v16, v16, v20
    v_add_f32 v17, v17, v21
    v_mfma_f32_16x16x32_bf16 v[80:83], a[192:195], v[136:139], v[48:51]
    v_exp_f32 v29, v97
    v_mfma_f32_16x16x32_bf16 v[88:91], a[192:195], v[140:143], v[52:55]
    v_add_f32 v20, v28, v29
    v_cvt_pk_bf16_f32 v208, v28, v29
    v_mfma_f32_16x16x32_bf16 v[64:67], a[196:199], v[144:147], v[64:67]
    v_exp_f32 v30, v98
    v_mfma_f32_16x16x32_bf16 v[72:75], a[196:199], v[148:151], v[72:75]
    ds_read_b64_tr_b16 a[228:229], v7 offset:17440
    ds_read_b64_tr_b16 a[230:231], v7 offset:21792
    v_add_f32 v20, v20, v30
    v_mfma_f32_16x16x32_bf16 v[80:83], a[196:199], v[152:155], v[80:83]
    v_exp_f32 v31, v99
    v_mfma_f32_16x16x32_bf16 v[88:91], a[196:199], v[156:159], v[88:91]
    v_add_f32 v20, v20, v31
    v_cvt_pk_bf16_f32 v209, v30, v31
    v_mfma_f32_16x16x32_bf16 v[64:67], a[200:203], v[160:163], v[64:67]
    v_exp_f32 v32, v100
    v_mfma_f32_16x16x32_bf16 v[72:75], a[200:203], v[164:167], v[72:75]
    ds_read_b64_tr_b16 a[232:233], v6 offset:17472
    ds_read_b64_tr_b16 a[234:235], v6 offset:21824
    v_add_f32 v20, v20, v32
    v_mfma_f32_16x16x32_bf16 v[80:83], a[200:203], v[168:171], v[80:83]
    v_exp_f32 v33, v101
    v_mfma_f32_16x16x32_bf16 v[88:91], a[200:203], v[172:175], v[88:91]
    v_add_f32 v20, v20, v33
    v_cvt_pk_bf16_f32 v210, v32, v33
    v_mfma_f32_16x16x32_bf16 v[64:67], a[204:207], v[176:179], v[64:67]
    v_exp_f32 v34, v102
    v_mfma_f32_16x16x32_bf16 v[72:75], a[204:207], v[180:183], v[72:75]
    ds_read_b64_tr_b16 a[236:237], v7 offset:17504
    ds_read_b64_tr_b16 a[238:239], v7 offset:21856
    v_add_f32 v20, v20, v34
    v_mfma_f32_16x16x32_bf16 v[80:83], a[204:207], v[184:187], v[80:83]
    v_exp_f32 v35, v103
    v_mfma_f32_16x16x32_bf16 v[88:91], a[204:207], v[188:191], v[88:91]
    v_add_f32 v20, v20, v35
    v_cvt_pk_bf16_f32 v211, v34, v35
    v_mfma_f32_16x16x32_bf16 v[68:71], a[208:211], v[128:131], v[40:43]
    v_exp_f32 v28, v104
    v_mfma_f32_16x16x32_bf16 v[76:79], a[208:211], v[132:135], v[44:47]
    ds_read_b64_tr_b16 a[240:241], v6 offset:17536
    ds_read_b64_tr_b16 a[242:243], v6 offset:21888
    v_add_f32 v18, v18, v22
    v_add_f32 v19, v19, v23
    v_mfma_f32_16x16x32_bf16 v[84:87], a[208:211], v[136:139], v[48:51]
    v_exp_f32 v29, v105
    v_mfma_f32_16x16x32_bf16 v[92:95], a[208:211], v[140:143], v[52:55]
    v_add_f32 v21, v28, v29
    v_cvt_pk_bf16_f32 v212, v28, v29
    v_mfma_f32_16x16x32_bf16 v[68:71], a[212:215], v[144:147], v[68:71]
    v_exp_f32 v30, v106
    v_mfma_f32_16x16x32_bf16 v[76:79], a[212:215], v[148:151], v[76:79]
    ds_read_b64_tr_b16 a[244:245], v7 offset:17568
    ds_read_b64_tr_b16 a[246:247], v7 offset:21920
    v_add_f32 v21, v21, v30
    v_mfma_f32_16x16x32_bf16 v[84:87], a[212:215], v[152:155], v[84:87]
    v_exp_f32 v31, v107
    v_mfma_f32_16x16x32_bf16 v[92:95], a[212:215], v[156:159], v[92:95]
    v_add_f32 v21, v21, v31
    v_cvt_pk_bf16_f32 v213, v30, v31
    v_mfma_f32_16x16x32_bf16 v[68:71], a[216:219], v[160:163], v[68:71]
    v_exp_f32 v32, v108
    v_mfma_f32_16x16x32_bf16 v[76:79], a[216:219], v[164:167], v[76:79]
    ds_read_b64_tr_b16 a[248:249], v6 offset:17600
    ds_read_b64_tr_b16 a[250:251], v6 offset:21952
    v_add_f32 v21, v21, v32
    v_mfma_f32_16x16x32_bf16 v[84:87], a[216:219], v[168:171], v[84:87]
    v_exp_f32 v33, v109
    v_mfma_f32_16x16x32_bf16 v[92:95], a[216:219], v[172:175], v[92:95]
    v_add_f32 v21, v21, v33
    v_cvt_pk_bf16_f32 v214, v32, v33
    v_mfma_f32_16x16x32_bf16 v[68:71], a[220:223], v[176:179], v[68:71]
    v_exp_f32 v34, v110
    v_mfma_f32_16x16x32_bf16 v[76:79], a[220:223], v[180:183], v[76:79]
    ds_read_b64_tr_b16 a[252:253], v7 offset:17632
    ds_read_b64_tr_b16 a[254:255], v7 offset:21984
    v_add_f32 v21, v21, v34
    v_mfma_f32_16x16x32_bf16 v[84:87], a[220:223], v[184:187], v[84:87]
    v_exp_f32 v35, v111
    v_mfma_f32_16x16x32_bf16 v[92:95], a[220:223], v[188:191], v[92:95]
    v_add_f32 v21, v21, v35
    v_cvt_pk_bf16_f32 v215, v34, v35
    s_waitcnt lgkmcnt(0)
    v_mfma_f32_16x16x32_bf16 a[0:3], a[224:227], v[192:195], a[0:3]
    v_exp_f32 v28, v112
    v_mfma_f32_16x16x32_bf16 a[4:7], a[224:227], v[196:199], a[4:7]
    ds_read_b128 a[192:195], v2 offset:8704
    ds_read_b128 a[196:199], v2 offset:8768
    v_mfma_f32_16x16x32_bf16 a[8:11], a[224:227], v[200:203], a[8:11]
    v_exp_f32 v29, v113
    v_mfma_f32_16x16x32_bf16 a[12:15], a[224:227], v[204:207], a[12:15]
    v_add_f32 v22, v28, v29
    v_cvt_pk_bf16_f32 v216, v28, v29
    v_mfma_f32_16x16x32_bf16 a[16:19], a[228:231], v[192:195], a[16:19]
    v_exp_f32 v30, v114
    v_mfma_f32_16x16x32_bf16 a[20:23], a[228:231], v[196:199], a[20:23]
    ds_read_b128 a[200:203], v2 offset:8832
    ds_read_b128 a[204:207], v2 offset:8896
    v_add_f32 v22, v22, v30
    v_mfma_f32_16x16x32_bf16 a[24:27], a[228:231], v[200:203], a[24:27]
    v_exp_f32 v31, v115
    v_mfma_f32_16x16x32_bf16 a[28:31], a[228:231], v[204:207], a[28:31]
    v_add_f32 v22, v22, v31
    v_cvt_pk_bf16_f32 v217, v30, v31
    v_mfma_f32_16x16x32_bf16 a[32:35], a[232:235], v[192:195], a[32:35]
    v_exp_f32 v32, v116
    v_mfma_f32_16x16x32_bf16 a[36:39], a[232:235], v[196:199], a[36:39]
    ds_read_b128 a[208:211], v2 offset:13056
    ds_read_b128 a[212:215], v2 offset:13120
    v_add_f32 v22, v22, v32
    v_mfma_f32_16x16x32_bf16 a[40:43], a[232:235], v[200:203], a[40:43]
    v_exp_f32 v33, v117
    v_mfma_f32_16x16x32_bf16 a[44:47], a[232:235], v[204:207], a[44:47]
    v_add_f32 v22, v22, v33
    v_cvt_pk_bf16_f32 v218, v32, v33
    v_mfma_f32_16x16x32_bf16 a[48:51], a[236:239], v[192:195], a[48:51]
    v_exp_f32 v34, v118
    v_mfma_f32_16x16x32_bf16 a[52:55], a[236:239], v[196:199], a[52:55]
    ds_read_b128 a[216:219], v2 offset:13184
    ds_read_b128 a[220:223], v2 offset:13248
    v_add_f32 v22, v22, v34
    v_mfma_f32_16x16x32_bf16 a[56:59], a[236:239], v[200:203], a[56:59]
    v_exp_f32 v35, v119
    v_mfma_f32_16x16x32_bf16 a[60:63], a[236:239], v[204:207], a[60:63]
    s_add_u32 m0, s22, 52224
    v_add_f32 v22, v22, v35
    v_cvt_pk_bf16_f32 v219, v34, v35
    v_mfma_f32_16x16x32_bf16 a[64:67], a[240:243], v[192:195], a[64:67]
    v_exp_f32 v28, v120
    v_mfma_f32_16x16x32_bf16 a[68:71], a[240:243], v[196:199], a[68:71]
    buffer_load_dwordx4 v8, s[4:7], s20 offen offset:0 lds
    v_max3_f32 v24, v20, v21, v22
    v_mfma_f32_16x16x32_bf16 a[72:75], a[240:243], v[200:203], a[72:75]
    v_exp_f32 v29, v121
    v_mfma_f32_16x16x32_bf16 a[76:79], a[240:243], v[204:207], a[76:79]
    v_add_f32 v23, v28, v29
    v_cvt_pk_bf16_f32 v220, v28, v29
    v_mfma_f32_16x16x32_bf16 a[80:83], a[244:247], v[192:195], a[80:83]
    v_exp_f32 v30, v122
    v_mfma_f32_16x16x32_bf16 a[84:87], a[244:247], v[196:199], a[84:87]
    buffer_load_dwordx4 v9, s[4:7], s20 offen offset:1088 lds
    v_add_f32 v23, v23, v30
    v_mfma_f32_16x16x32_bf16 a[88:91], a[244:247], v[200:203], a[88:91]
    v_exp_f32 v31, v123
    v_mfma_f32_16x16x32_bf16 a[92:95], a[244:247], v[204:207], a[92:95]
    v_add_f32 v23, v23, v31
    v_cvt_pk_bf16_f32 v221, v30, v31
    v_mfma_f32_16x16x32_bf16 a[96:99], a[248:251], v[192:195], a[96:99]
    v_exp_f32 v32, v124
    v_mfma_f32_16x16x32_bf16 a[100:103], a[248:251], v[196:199], a[100:103]
    buffer_load_dwordx4 v10, s[4:7], s20 offen offset:2176 lds
    v_add_f32 v23, v23, v32
    v_mfma_f32_16x16x32_bf16 a[104:107], a[248:251], v[200:203], a[104:107]
    v_exp_f32 v33, v125
    v_mfma_f32_16x16x32_bf16 a[108:111], a[248:251], v[204:207], a[108:111]
    v_add_f32 v23, v23, v33
    v_cvt_pk_bf16_f32 v222, v32, v33
    v_mfma_f32_16x16x32_bf16 a[112:115], a[252:255], v[192:195], a[112:115]
    v_exp_f32 v34, v126
    v_mfma_f32_16x16x32_bf16 a[116:119], a[252:255], v[196:199], a[116:119]
    buffer_load_dwordx4 v11, s[4:7], s20 offen offset:3264 lds
    v_add_f32 v23, v23, v34
    v_mfma_f32_16x16x32_bf16 a[120:123], a[252:255], v[200:203], a[120:123]
    v_exp_f32 v35, v127
    v_mfma_f32_16x16x32_bf16 a[124:127], a[252:255], v[204:207], a[124:127]
    s_add_u32 s20, s20, 16384
    v_add_f32 v23, v23, v35
    v_cvt_pk_bf16_f32 v223, v34, v35
    v_max_f32 v24, v24, v23
    v_cmp_lt_f32 vcc, s25, v24
    s_waitcnt lgkmcnt(0)
    s_cbranch_vccnz rare_stub_15
rare_back_16:
    v_mfma_f32_16x16x32_bf16 v[96:99], a[192:195], v[128:131], v[40:43]
    v_exp_f32 v28, v64
    v_mfma_f32_16x16x32_bf16 v[104:107], a[192:195], v[132:135], v[44:47]
    ds_read_b64_tr_b16 a[224:225], v6 offset:26112
    ds_read_b64_tr_b16 a[226:227], v6 offset:30464
    v_add_f32 v16, v16, v20
    v_add_f32 v17, v17, v21
    v_mfma_f32_16x16x32_bf16 v[112:115], a[192:195], v[136:139], v[48:51]
    v_exp_f32 v29, v65
    v_mfma_f32_16x16x32_bf16 v[120:123], a[192:195], v[140:143], v[52:55]
    v_add_f32 v20, v28, v29
    v_cvt_pk_bf16_f32 v192, v28, v29
    v_mfma_f32_16x16x32_bf16 v[96:99], a[196:199], v[144:147], v[96:99]
    v_exp_f32 v30, v66
    v_mfma_f32_16x16x32_bf16 v[104:107], a[196:199], v[148:151], v[104:107]
    ds_read_b64_tr_b16 a[228:229], v7 offset:26144
    ds_read_b64_tr_b16 a[230:231], v7 offset:30496
    v_add_f32 v20, v20, v30
    v_mfma_f32_16x16x32_bf16 v[112:115], a[196:199], v[152:155], v[112:115]
    v_exp_f32 v31, v67
    v_mfma_f32_16x16x32_bf16 v[120:123], a[196:199], v[156:159], v[120:123]
    v_add_f32 v20, v20, v31
    v_cvt_pk_bf16_f32 v193, v30, v31
    v_mfma_f32_16x16x32_bf16 v[96:99], a[200:203], v[160:163], v[96:99]
    v_exp_f32 v32, v68
    v_mfma_f32_16x16x32_bf16 v[104:107], a[200:203], v[164:167], v[104:107]
    ds_read_b64_tr_b16 a[232:233], v6 offset:26176
    ds_read_b64_tr_b16 a[234:235], v6 offset:30528
    v_add_f32 v20, v20, v32
    v_mfma_f32_16x16x32_bf16 v[112:115], a[200:203], v[168:171], v[112:115]
    v_exp_f32 v33, v69
    v_mfma_f32_16x16x32_bf16 v[120:123], a[200:203], v[172:175], v[120:123]
    v_add_f32 v20, v20, v33
    v_cvt_pk_bf16_f32 v194, v32, v33
    v_mfma_f32_16x16x32_bf16 v[96:99], a[204:207], v[176:179], v[96:99]
    v_exp_f32 v34, v70
    v_mfma_f32_16x16x32_bf16 v[104:107], a[204:207], v[180:183], v[104:107]
    ds_read_b64_tr_b16 a[236:237], v7 offset:26208
    ds_read_b64_tr_b16 a[238:239], v7 offset:30560
    v_add_f32 v20, v20, v34
    v_mfma_f32_16x16x32_bf16 v[112:115], a[204:207], v[184:187], v[112:115]
    v_exp_f32 v35, v71
    v_mfma_f32_16x16x32_bf16 v[120:123], a[204:207], v[188:191], v[120:123]
    v_add_f32 v20, v20, v35
    v_cvt_pk_bf16_f32 v195, v34, v35
    v_mfma_f32_16x16x32_bf16 v[100:103], a[208:211], v[128:131], v[40:43]
    v_exp_f32 v28, v72
    v_mfma_f32_16x16x32_bf16 v[108:111], a[208:211], v[132:135], v[44:47]
    ds_read_b64_tr_b16 a[240:241], v6 offset:26240
    ds_read_b64_tr_b16 a[242:243], v6 offset:30592
    v_add_f32 v18, v18, v22
    v_add_f32 v19, v19, v23
    v_mfma_f32_16x16x32_bf16 v[116:119], a[208:211], v[136:139], v[48:51]
    v_exp_f32 v29, v73
    v_mfma_f32_16x16x32_bf16 v[124:127], a[208:211], v[140:143], v[52:55]
    v_add_f32 v21, v28, v29
    v_cvt_pk_bf16_f32 v196, v28, v29
    v_mfma_f32_16x16x32_bf16 v[100:103], a[212:215], v[144:147], v[100:103]
    v_exp_f32 v30, v74
    v_mfma_f32_16x16x32_bf16 v[108:111], a[212:215], v[148:151], v[108:111]
    ds_read_b64_tr_b16 a[244:245], v7 offset:26272
    ds_read_b64_tr_b16 a[246:247], v7 offset:30624
    v_add_f32 v21, v21, v30
    v_mfma_f32_16x16x32_bf16 v[116:119], a[212:215], v[152:155], v[116:119]
    v_exp_f32 v31, v75
    v_mfma_f32_16x16x32_bf16 v[124:127], a[212:215], v[156:159], v[124:127]
    v_add_f32 v21, v21, v31
    v_cvt_pk_bf16_f32 v197, v30, v31
    v_mfma_f32_16x16x32_bf16 v[100:103], a[216:219], v[160:163], v[100:103]
    v_exp_f32 v32, v76
    v_mfma_f32_16x16x32_bf16 v[108:111], a[216:219], v[164:167], v[108:111]
    ds_read_b64_tr_b16 a[248:249], v6 offset:26304
    ds_read_b64_tr_b16 a[250:251], v6 offset:30656
    v_add_f32 v21, v21, v32
    v_mfma_f32_16x16x32_bf16 v[116:119], a[216:219], v[168:171], v[116:119]
    v_exp_f32 v33, v77
    v_mfma_f32_16x16x32_bf16 v[124:127], a[216:219], v[172:175], v[124:127]
    v_add_f32 v21, v21, v33
    v_cvt_pk_bf16_f32 v198, v32, v33
    v_mfma_f32_16x16x32_bf16 v[100:103], a[220:223], v[176:179], v[100:103]
    v_exp_f32 v34, v78
    v_mfma_f32_16x16x32_bf16 v[108:111], a[220:223], v[180:183], v[108:111]
    ds_read_b64_tr_b16 a[252:253], v7 offset:26336
    ds_read_b64_tr_b16 a[254:255], v7 offset:30688
    v_add_f32 v21, v21, v34
    v_mfma_f32_16x16x32_bf16 v[116:119], a[220:223], v[184:187], v[116:119]
    v_exp_f32 v35, v79
    v_mfma_f32_16x16x32_bf16 v[124:127], a[220:223], v[188:191], v[124:127]
    v_add_f32 v21, v21, v35
    v_cvt_pk_bf16_f32 v199, v34, v35
    s_waitcnt vmcnt(12) lgkmcnt(0)
    s_barrier
    v_mfma_f32_16x16x32_bf16 a[0:3], a[224:227], v[208:211], a[0:3]
    v_exp_f32 v28, v80
    v_mfma_f32_16x16x32_bf16 a[4:7], a[224:227], v[212:215], a[4:7]
    ds_read_b128 a[192:195], v2 offset:17408
    ds_read_b128 a[196:199], v2 offset:17472
    v_mfma_f32_16x16x32_bf16 a[8:11], a[224:227], v[216:219], a[8:11]
    v_exp_f32 v29, v81
    v_mfma_f32_16x16x32_bf16 a[12:15], a[224:227], v[220:223], a[12:15]
    v_add_f32 v22, v28, v29
    v_cvt_pk_bf16_f32 v200, v28, v29
    v_mfma_f32_16x16x32_bf16 a[16:19], a[228:231], v[208:211], a[16:19]
    v_exp_f32 v30, v82
    v_mfma_f32_16x16x32_bf16 a[20:23], a[228:231], v[212:215], a[20:23]
    ds_read_b128 a[200:203], v2 offset:17536
    ds_read_b128 a[204:207], v2 offset:17600
    v_add_f32 v22, v22, v30
    v_mfma_f32_16x16x32_bf16 a[24:27], a[228:231], v[216:219], a[24:27]
    v_exp_f32 v31, v83
    v_mfma_f32_16x16x32_bf16 a[28:31], a[228:231], v[220:223], a[28:31]
    v_add_f32 v22, v22, v31
    v_cvt_pk_bf16_f32 v201, v30, v31
    v_mfma_f32_16x16x32_bf16 a[32:35], a[232:235], v[208:211], a[32:35]
    v_exp_f32 v32, v84
    v_mfma_f32_16x16x32_bf16 a[36:39], a[232:235], v[212:215], a[36:39]
    ds_read_b128 a[208:211], v2 offset:21760
    ds_read_b128 a[212:215], v2 offset:21824
    v_add_f32 v22, v22, v32
    v_mfma_f32_16x16x32_bf16 a[40:43], a[232:235], v[216:219], a[40:43]
    v_exp_f32 v33, v85
    v_mfma_f32_16x16x32_bf16 a[44:47], a[232:235], v[220:223], a[44:47]
    v_add_f32 v22, v22, v33
    v_cvt_pk_bf16_f32 v202, v32, v33
    v_mfma_f32_16x16x32_bf16 a[48:51], a[236:239], v[208:211], a[48:51]
    v_exp_f32 v34, v86
    v_mfma_f32_16x16x32_bf16 a[52:55], a[236:239], v[212:215], a[52:55]
    ds_read_b128 a[216:219], v2 offset:21888
    ds_read_b128 a[220:223], v2 offset:21952
    v_add_f32 v22, v22, v34
    v_mfma_f32_16x16x32_bf16 a[56:59], a[236:239], v[216:219], a[56:59]
    v_exp_f32 v35, v87
    v_mfma_f32_16x16x32_bf16 a[60:63], a[236:239], v[220:223], a[60:63]
    s_add_u32 m0, s23, 34816
    v_add_f32 v22, v22, v35
    v_cvt_pk_bf16_f32 v203, v34, v35
    v_mfma_f32_16x16x32_bf16 a[64:67], a[240:243], v[208:211], a[64:67]
    v_exp_f32 v28, v88
    v_mfma_f32_16x16x32_bf16 a[68:71], a[240:243], v[212:215], a[68:71]
    buffer_load_dwordx4 v12, s[8:11], s21 offen offset:0 lds
    v_max3_f32 v24, v20, v21, v22
    v_mfma_f32_16x16x32_bf16 a[72:75], a[240:243], v[216:219], a[72:75]
    v_exp_f32 v29, v89
    v_mfma_f32_16x16x32_bf16 a[76:79], a[240:243], v[220:223], a[76:79]
    v_add_f32 v23, v28, v29
    v_cvt_pk_bf16_f32 v204, v28, v29
    v_mfma_f32_16x16x32_bf16 a[80:83], a[244:247], v[208:211], a[80:83]
    v_exp_f32 v30, v90
    v_mfma_f32_16x16x32_bf16 a[84:87], a[244:247], v[212:215], a[84:87]
    buffer_load_dwordx4 v13, s[8:11], s21 offen offset:1088 lds
    v_add_f32 v23, v23, v30
    v_mfma_f32_16x16x32_bf16 a[88:91], a[244:247], v[216:219], a[88:91]
    v_exp_f32 v31, v91
    v_mfma_f32_16x16x32_bf16 a[92:95], a[244:247], v[220:223], a[92:95]
    v_add_f32 v23, v23, v31
    v_cvt_pk_bf16_f32 v205, v30, v31
    v_mfma_f32_16x16x32_bf16 a[96:99], a[248:251], v[208:211], a[96:99]
    v_exp_f32 v32, v92
    v_mfma_f32_16x16x32_bf16 a[100:103], a[248:251], v[212:215], a[100:103]
    buffer_load_dwordx4 v14, s[8:11], s21 offen offset:2176 lds
    v_add_f32 v23, v23, v32
    v_mfma_f32_16x16x32_bf16 a[104:107], a[248:251], v[216:219], a[104:107]
    v_exp_f32 v33, v93
    v_mfma_f32_16x16x32_bf16 a[108:111], a[248:251], v[220:223], a[108:111]
    v_add_f32 v23, v23, v33
    v_cvt_pk_bf16_f32 v206, v32, v33
    v_mfma_f32_16x16x32_bf16 a[112:115], a[252:255], v[208:211], a[112:115]
    v_exp_f32 v34, v94
    v_mfma_f32_16x16x32_bf16 a[116:119], a[252:255], v[212:215], a[116:119]
    buffer_load_dwordx4 v15, s[8:11], s21 offen offset:3264 lds
    v_add_f32 v23, v23, v34
    v_mfma_f32_16x16x32_bf16 a[120:123], a[252:255], v[216:219], a[120:123]
    v_exp_f32 v35, v95
    v_mfma_f32_16x16x32_bf16 a[124:127], a[252:255], v[220:223], a[124:127]
    s_add_u32 s21, s21, 16384
    v_add_f32 v23, v23, v35
    v_cvt_pk_bf16_f32 v207, v34, v35
    v_max_f32 v24, v24, v23
    v_cmp_lt_f32 vcc, s25, v24
    s_waitcnt lgkmcnt(0)
    s_cbranch_vccnz rare_stub_17
rare_back_18:
    v_mfma_f32_16x16x32_bf16 v[64:67], a[192:195], v[128:131], v[40:43]
    v_exp_f32 v28, v96
    v_mfma_f32_16x16x32_bf16 v[72:75], a[192:195], v[132:135], v[44:47]
    ds_read_b64_tr_b16 a[224:225], v4 offset:0
    ds_read_b64_tr_b16 a[226:227], v4 offset:4352
    v_add_f32 v16, v16, v20
    v_add_f32 v17, v17, v21
    v_mfma_f32_16x16x32_bf16 v[80:83], a[192:195], v[136:139], v[48:51]
    v_exp_f32 v29, v97
    v_mfma_f32_16x16x32_bf16 v[88:91], a[192:195], v[140:143], v[52:55]
    v_add_f32 v20, v28, v29
    v_cvt_pk_bf16_f32 v208, v28, v29
    v_mfma_f32_16x16x32_bf16 v[64:67], a[196:199], v[144:147], v[64:67]
    v_exp_f32 v30, v98
    v_mfma_f32_16x16x32_bf16 v[72:75], a[196:199], v[148:151], v[72:75]
    ds_read_b64_tr_b16 a[228:229], v5 offset:32
    ds_read_b64_tr_b16 a[230:231], v5 offset:4384
    v_add_f32 v20, v20, v30
    v_mfma_f32_16x16x32_bf16 v[80:83], a[196:199], v[152:155], v[80:83]
    v_exp_f32 v31, v99
    v_mfma_f32_16x16x32_bf16 v[88:91], a[196:199], v[156:159], v[88:91]
    v_add_f32 v20, v20, v31
    v_cvt_pk_bf16_f32 v209, v30, v31
    v_mfma_f32_16x16x32_bf16 v[64:67], a[200:203], v[160:163], v[64:67]
    v_exp_f32 v32, v100
    v_mfma_f32_16x16x32_bf16 v[72:75], a[200:203], v[164:167], v[72:75]
    ds_read_b64_tr_b16 a[232:233], v4 offset:64
    ds_read_b64_tr_b16 a[234:235], v4 offset:4416
    v_add_f32 v20, v20, v32
    v_mfma_f32_16x16x32_bf16 v[80:83], a[200:203], v[168:171], v[80:83]
    v_exp_f32 v33, v101
    v_mfma_f32_16x16x32_bf16 v[88:91], a[200:203], v[172:175], v[88:91]
    v_add_f32 v20, v20, v33
    v_cvt_pk_bf16_f32 v210, v32, v33
    v_mfma_f32_16x16x32_bf16 v[64:67], a[204:207], v[176:179], v[64:67]
    v_exp_f32 v34, v102
    v_mfma_f32_16x16x32_bf16 v[72:75], a[204:207], v[180:183], v[72:75]
    ds_read_b64_tr_b16 a[236:237], v5 offset:96
    ds_read_b64_tr_b16 a[238:239], v5 offset:4448
    v_add_f32 v20, v20, v34
    v_mfma_f32_16x16x32_bf16 v[80:83], a[204:207], v[184:187], v[80:83]
    v_exp_f32 v35, v103
    v_mfma_f32_16x16x32_bf16 v[88:91], a[204:207], v[188:191], v[88:91]
    v_add_f32 v20, v20, v35
    v_cvt_pk_bf16_f32 v211, v34, v35
    v_mfma_f32_16x16x32_bf16 v[68:71], a[208:211], v[128:131], v[40:43]
    v_exp_f32 v28, v104
    v_mfma_f32_16x16x32_bf16 v[76:79], a[208:211], v[132:135], v[44:47]
    ds_read_b64_tr_b16 a[240:241], v4 offset:128
    ds_read_b64_tr_b16 a[242:243], v4 offset:4480
    v_add_f32 v18, v18, v22
    v_add_f32 v19, v19, v23
    v_mfma_f32_16x16x32_bf16 v[84:87], a[208:211], v[136:139], v[48:51]
    v_exp_f32 v29, v105
    v_mfma_f32_16x16x32_bf16 v[92:95], a[208:211], v[140:143], v[52:55]
    v_add_f32 v21, v28, v29
    v_cvt_pk_bf16_f32 v212, v28, v29
    v_mfma_f32_16x16x32_bf16 v[68:71], a[212:215], v[144:147], v[68:71]
    v_exp_f32 v30, v106
    v_mfma_f32_16x16x32_bf16 v[76:79], a[212:215], v[148:151], v[76:79]
    ds_read_b64_tr_b16 a[244:245], v5 offset:160
    ds_read_b64_tr_b16 a[246:247], v5 offset:4512
    v_add_f32 v21, v21, v30
    v_mfma_f32_16x16x32_bf16 v[84:87], a[212:215], v[152:155], v[84:87]
    v_exp_f32 v31, v107
    v_mfma_f32_16x16x32_bf16 v[92:95], a[212:215], v[156:159], v[92:95]
    v_add_f32 v21, v21, v31
    v_cvt_pk_bf16_f32 v213, v30, v31
    v_mfma_f32_16x16x32_bf16 v[68:71], a[216:219], v[160:163], v[68:71]
    v_exp_f32 v32, v108
    v_mfma_f32_16x16x32_bf16 v[76:79], a[216:219], v[164:167], v[76:79]
    ds_read_b64_tr_b16 a[248:249], v4 offset:192
    ds_read_b64_tr_b16 a[250:251], v4 offset:4544
    v_add_f32 v21, v21, v32
    v_mfma_f32_16x16x32_bf16 v[84:87], a[216:219], v[168:171], v[84:87]
    v_exp_f32 v33, v109
    v_mfma_f32_16x16x32_bf16 v[92:95], a[216:219], v[172:175], v[92:95]
    v_add_f32 v21, v21, v33
    v_cvt_pk_bf16_f32 v214, v32, v33
    v_mfma_f32_16x16x32_bf16 v[68:71], a[220:223], v[176:179], v[68:71]
    v_exp_f32 v34, v110
    v_mfma_f32_16x16x32_bf16 v[76:79], a[220:223], v[180:183], v[76:79]
    ds_read_b64_tr_b16 a[252:253], v5 offset:224
    ds_read_b64_tr_b16 a[254:255], v5 offset:4576
    v_add_f32 v21, v21, v34
    v_mfma_f32_16x16x32_bf16 v[84:87], a[220:223], v[184:187], v[84:87]
    v_exp_f32 v35, v111
    v_mfma_f32_16x16x32_bf16 v[92:95], a[220:223], v[188:191], v[92:95]
    v_add_f32 v21, v21, v35
    v_cvt_pk_bf16_f32 v215, v34, v35
    s_waitcnt lgkmcnt(0)
    v_mfma_f32_16x16x32_bf16 a[0:3], a[224:227], v[192:195], a[0:3]
    v_exp_f32 v28, v112
    v_mfma_f32_16x16x32_bf16 a[4:7], a[224:227], v[196:199], a[4:7]
    ds_read_b128 a[192:195], v2 offset:26112
    ds_read_b128 a[196:199], v2 offset:26176
    v_mfma_f32_16x16x32_bf16 a[8:11], a[224:227], v[200:203], a[8:11]
    v_exp_f32 v29, v113
    v_mfma_f32_16x16x32_bf16 a[12:15], a[224:227], v[204:207], a[12:15]
    v_add_f32 v22, v28, v29
    v_cvt_pk_bf16_f32 v216, v28, v29
    v_mfma_f32_16x16x32_bf16 a[16:19], a[228:231], v[192:195], a[16:19]
    v_exp_f32 v30, v114
    v_mfma_f32_16x16x32_bf16 a[20:23], a[228:231], v[196:199], a[20:23]
    ds_read_b128 a[200:203], v2 offset:26240
    ds_read_b128 a[204:207], v2 offset:26304
    v_add_f32 v22, v22, v30
    v_mfma_f32_16x16x32_bf16 a[24:27], a[228:231], v[200:203], a[24:27]
    v_exp_f32 v31, v115
    v_mfma_f32_16x16x32_bf16 a[28:31], a[228:231], v[204:207], a[28:31]
    v_add_f32 v22, v22, v31
    v_cvt_pk_bf16_f32 v217, v30, v31
    v_mfma_f32_16x16x32_bf16 a[32:35], a[232:235], v[192:195], a[32:35]
    v_exp_f32 v32, v116
    v_mfma_f32_16x16x32_bf16 a[36:39], a[232:235], v[196:199], a[36:39]
    ds_read_b128 a[208:211], v2 offset:30464
    ds_read_b128 a[212:215], v2 offset:30528
    v_add_f32 v22, v22, v32
    v_mfma_f32_16x16x32_bf16 a[40:43], a[232:235], v[200:203], a[40:43]
    v_exp_f32 v33, v117
    v_mfma_f32_16x16x32_bf16 a[44:47], a[232:235], v[204:207], a[44:47]
    v_add_f32 v22, v22, v33
    v_cvt_pk_bf16_f32 v218, v32, v33
    v_mfma_f32_16x16x32_bf16 a[48:51], a[236:239], v[192:195], a[48:51]
    v_exp_f32 v34, v118
    v_mfma_f32_16x16x32_bf16 a[52:55], a[236:239], v[196:199], a[52:55]
    ds_read_b128 a[216:219], v2 offset:30592
    ds_read_b128 a[220:223], v2 offset:30656
    v_add_f32 v22, v22, v34
    v_mfma_f32_16x16x32_bf16 a[56:59], a[236:239], v[200:203], a[56:59]
    v_exp_f32 v35, v119
    v_mfma_f32_16x16x32_bf16 a[60:63], a[236:239], v[204:207], a[60:63]
    s_add_u32 m0, s22, 0
    v_add_f32 v22, v22, v35
    v_cvt_pk_bf16_f32 v219, v34, v35
    v_mfma_f32_16x16x32_bf16 a[64:67], a[240:243], v[192:195], a[64:67]
    v_exp_f32 v28, v120
    v_mfma_f32_16x16x32_bf16 a[68:71], a[240:243], v[196:199], a[68:71]
    buffer_load_dwordx4 v8, s[4:7], s20 offen offset:0 lds
    v_max3_f32 v24, v20, v21, v22
    v_mfma_f32_16x16x32_bf16 a[72:75], a[240:243], v[200:203], a[72:75]
    v_exp_f32 v29, v121
    v_mfma_f32_16x16x32_bf16 a[76:79], a[240:243], v[204:207], a[76:79]
    v_add_f32 v23, v28, v29
    v_cvt_pk_bf16_f32 v220, v28, v29
    v_mfma_f32_16x16x32_bf16 a[80:83], a[244:247], v[192:195], a[80:83]
    v_exp_f32 v30, v122
    v_mfma_f32_16x16x32_bf16 a[84:87], a[244:247], v[196:199], a[84:87]
    buffer_load_dwordx4 v9, s[4:7], s20 offen offset:1088 lds
    v_add_f32 v23, v23, v30
    v_mfma_f32_16x16x32_bf16 a[88:91], a[244:247], v[200:203], a[88:91]
    v_exp_f32 v31, v123
    v_mfma_f32_16x16x32_bf16 a[92:95], a[244:247], v[204:207], a[92:95]
    v_add_f32 v23, v23, v31
    v_cvt_pk_bf16_f32 v221, v30, v31
    v_mfma_f32_16x16x32_bf16 a[96:99], a[248:251], v[192:195], a[96:99]
    v_exp_f32 v32, v124
    v_mfma_f32_16x16x32_bf16 a[100:103], a[248:251], v[196:199], a[100:103]
    buffer_load_dwordx4 v10, s[4:7], s20 offen offset:2176 lds
    v_add_f32 v23, v23, v32
    v_mfma_f32_16x16x32_bf16 a[104:107], a[248:251], v[200:203], a[104:107]
    v_exp_f32 v33, v125
    v_mfma_f32_16x16x32_bf16 a[108:111], a[248:251], v[204:207], a[108:111]
    v_add_f32 v23, v23, v33
    v_cvt_pk_bf16_f32 v222, v32, v33
    v_mfma_f32_16x16x32_bf16 a[112:115], a[252:255], v[192:195], a[112:115]
    v_exp_f32 v34, v126
    v_mfma_f32_16x16x32_bf16 a[116:119], a[252:255], v[196:199], a[116:119]
    buffer_load_dwordx4 v11, s[4:7], s20 offen offset:3264 lds
    v_add_f32 v23, v23, v34
    v_mfma_f32_16x16x32_bf16 a[120:123], a[252:255], v[200:203], a[120:123]
    v_exp_f32 v35, v127
    v_mfma_f32_16x16x32_bf16 a[124:127], a[252:255], v[204:207], a[124:127]
    s_add_u32 s20, s20, 16384
    v_add_f32 v23, v23, v35
    v_cvt_pk_bf16_f32 v223, v34, v35
    v_max_f32 v24, v24, v23
    v_cmp_lt_f32 vcc, s25, v24
    s_waitcnt lgkmcnt(0)
    s_cbranch_vccnz rare_stub_19
rare_back_20:
    s_add_u32 s24, s24, 1
    s_cmp_lt_u32 s24, 7
    s_cbranch_scc1 attn_loop
    s_mov_b32 s40, s72
    s_mov_b32 s41, s73
    s_mov_b32 s42, s74
    s_mov_b32 s43, s75
    s_lshr_b32 s68, s33, 3
    s_bfe_u32 s69, s33, 0x10002
    s_and_b32 s70, s33, 3
    s_lshr_b32 s71, s32, 1
    s_and_b32 s72, s32, 1
    s_lshl_b32 s73, s34, 4
    s_lshl_b32 s26, s69, 3
    s_add_u32 s73, s73, s26
    v_lshrrev_b32 v235, 4, v1
    v_lshrrev_b32 v236, 3, v1
    v_and_b32 v237, 7, v1
    v_lshlrev_b32 v238, 1, v235
    v_xor_b32 v237, v237, v238
    v_lshlrev_b32 v237, 4, v237
    v_lshl_add_u32 v230, v236, 10, v237
    v_add_u32 v245, 7168, v230
    v_lshlrev_b32 v239, 4, v1
    s_lshl_b32 s26, s32, 1
    s_mul_i32 s27, s26, 131072
    v_add_u32 v231, s27, v239
    v_add_u32 v232, 130048, v231
    s_mul_i32 s27, s26, 57344
    v_add_u32 v233, s27, v239
    v_add_u32 v234, 56320, v233
    s_add_u32 s48, s28, 2097152
    s_addc_u32 s49, s29, 0
    s_mov_b32 s50, 7340032
    s_mov_b32 s51, 0x20000
    s_mul_i32 s64, s68, 448
    s_lshl_b32 s27, s72, 4
    s_add_u32 s64, s64, s27
    s_lshl_b32 s64, s64, 10
    s_lshl_b32 s26, s70, 1
    s_add_u32 s26, s26, s71
    s_lshl_b32 s26, s26, 7
    s_add_u32 s64, s64, s26
    s_mul_i32 s65, s73, 56
    s_mul_i32 s27, s68, 14
    s_add_u32 s65, s65, s27
    s_lshl_b32 s65, s65, 10
    s_lshl_b32 s74, s32, 11
    s_add_u32 s75, s74, 8192
    v_and_b32 v240, 31, v1
    v_lshlrev_b32 v240, 2, v240
    global_load_dword v241, v240, s[38:39] offset:512 sc1
    v_mfma_f32_16x16x32_bf16 v[96:99], a[192:195], v[128:131], v[40:43]
    v_exp_f32 v28, v64
    v_mfma_f32_16x16x32_bf16 v[104:107], a[192:195], v[132:135], v[44:47]
    ds_read_b64_tr_b16 a[224:225], v4 offset:8704
    ds_read_b64_tr_b16 a[226:227], v4 offset:13056
    v_add_f32 v16, v16, v20
    v_add_f32 v17, v17, v21
    v_mfma_f32_16x16x32_bf16 v[112:115], a[192:195], v[136:139], v[48:51]
    v_exp_f32 v29, v65
    v_mfma_f32_16x16x32_bf16 v[120:123], a[192:195], v[140:143], v[52:55]
    v_add_f32 v20, v28, v29
    v_cvt_pk_bf16_f32 v192, v28, v29
    v_mfma_f32_16x16x32_bf16 v[96:99], a[196:199], v[144:147], v[96:99]
    v_exp_f32 v30, v66
    v_mfma_f32_16x16x32_bf16 v[104:107], a[196:199], v[148:151], v[104:107]
    ds_read_b64_tr_b16 a[228:229], v5 offset:8736
    ds_read_b64_tr_b16 a[230:231], v5 offset:13088
    v_add_f32 v20, v20, v30
    v_mfma_f32_16x16x32_bf16 v[112:115], a[196:199], v[152:155], v[112:115]
    v_exp_f32 v31, v67
    v_mfma_f32_16x16x32_bf16 v[120:123], a[196:199], v[156:159], v[120:123]
    v_add_f32 v20, v20, v31
    v_cvt_pk_bf16_f32 v193, v30, v31
    v_mfma_f32_16x16x32_bf16 v[96:99], a[200:203], v[160:163], v[96:99]
    v_exp_f32 v32, v68
    v_mfma_f32_16x16x32_bf16 v[104:107], a[200:203], v[164:167], v[104:107]
    ds_read_b64_tr_b16 a[232:233], v4 offset:8768
    ds_read_b64_tr_b16 a[234:235], v4 offset:13120
    v_add_f32 v20, v20, v32
    v_mfma_f32_16x16x32_bf16 v[112:115], a[200:203], v[168:171], v[112:115]
    v_exp_f32 v33, v69
    v_mfma_f32_16x16x32_bf16 v[120:123], a[200:203], v[172:175], v[120:123]
    v_add_f32 v20, v20, v33
    v_cvt_pk_bf16_f32 v194, v32, v33
    v_mfma_f32_16x16x32_bf16 v[96:99], a[204:207], v[176:179], v[96:99]
    v_exp_f32 v34, v70
    v_mfma_f32_16x16x32_bf16 v[104:107], a[204:207], v[180:183], v[104:107]
    ds_read_b64_tr_b16 a[236:237], v5 offset:8800
    ds_read_b64_tr_b16 a[238:239], v5 offset:13152
    v_add_f32 v20, v20, v34
    v_mfma_f32_16x16x32_bf16 v[112:115], a[204:207], v[184:187], v[112:115]
    v_exp_f32 v35, v71
    v_mfma_f32_16x16x32_bf16 v[120:123], a[204:207], v[188:191], v[120:123]
    v_add_f32 v20, v20, v35
    v_cvt_pk_bf16_f32 v195, v34, v35
    v_mfma_f32_16x16x32_bf16 v[100:103], a[208:211], v[128:131], v[40:43]
    v_exp_f32 v28, v72
    v_mfma_f32_16x16x32_bf16 v[108:111], a[208:211], v[132:135], v[44:47]
    ds_read_b64_tr_b16 a[240:241], v4 offset:8832
    ds_read_b64_tr_b16 a[242:243], v4 offset:13184
    v_add_f32 v18, v18, v22
    v_add_f32 v19, v19, v23
    v_mfma_f32_16x16x32_bf16 v[116:119], a[208:211], v[136:139], v[48:51]
    v_exp_f32 v29, v73
    v_mfma_f32_16x16x32_bf16 v[124:127], a[208:211], v[140:143], v[52:55]
    v_add_f32 v21, v28, v29
    v_cvt_pk_bf16_f32 v196, v28, v29
    v_mfma_f32_16x16x32_bf16 v[100:103], a[212:215], v[144:147], v[100:103]
    v_exp_f32 v30, v74
    v_mfma_f32_16x16x32_bf16 v[108:111], a[212:215], v[148:151], v[108:111]
    ds_read_b64_tr_b16 a[244:245], v5 offset:8864
    ds_read_b64_tr_b16 a[246:247], v5 offset:13216
    v_add_f32 v21, v21, v30
    v_mfma_f32_16x16x32_bf16 v[116:119], a[212:215], v[152:155], v[116:119]
    v_exp_f32 v31, v75
    v_mfma_f32_16x16x32_bf16 v[124:127], a[212:215], v[156:159], v[124:127]
    v_add_f32 v21, v21, v31
    v_cvt_pk_bf16_f32 v197, v30, v31
    v_mfma_f32_16x16x32_bf16 v[100:103], a[216:219], v[160:163], v[100:103]
    v_exp_f32 v32, v76
    v_mfma_f32_16x16x32_bf16 v[108:111], a[216:219], v[164:167], v[108:111]
    ds_read_b64_tr_b16 a[248:249], v4 offset:8896
    ds_read_b64_tr_b16 a[250:251], v4 offset:13248
    v_add_f32 v21, v21, v32
    v_mfma_f32_16x16x32_bf16 v[116:119], a[216:219], v[168:171], v[116:119]
    v_exp_f32 v33, v77
    v_mfma_f32_16x16x32_bf16 v[124:127], a[216:219], v[172:175], v[124:127]
    v_add_f32 v21, v21, v33
    v_cvt_pk_bf16_f32 v198, v32, v33
    v_mfma_f32_16x16x32_bf16 v[100:103], a[220:223], v[176:179], v[100:103]
    v_exp_f32 v34, v78
    v_mfma_f32_16x16x32_bf16 v[108:111], a[220:223], v[180:183], v[108:111]
    ds_read_b64_tr_b16 a[252:253], v5 offset:8928
    ds_read_b64_tr_b16 a[254:255], v5 offset:13280
    v_add_f32 v21, v21, v34
    v_mfma_f32_16x16x32_bf16 v[116:119], a[220:223], v[184:187], v[116:119]
    v_exp_f32 v35, v79
    v_mfma_f32_16x16x32_bf16 v[124:127], a[220:223], v[188:191], v[124:127]
    v_add_f32 v21, v21, v35
    v_cvt_pk_bf16_f32 v199, v34, v35
    s_waitcnt vmcnt(12) lgkmcnt(0)
    s_barrier
    v_mfma_f32_16x16x32_bf16 a[0:3], a[224:227], v[208:211], a[0:3]
    v_exp_f32 v28, v80
    v_mfma_f32_16x16x32_bf16 a[4:7], a[224:227], v[212:215], a[4:7]
    ds_read_b128 a[192:195], v2 offset:34816
    ds_read_b128 a[196:199], v2 offset:34880
    v_mfma_f32_16x16x32_bf16 a[8:11], a[224:227], v[216:219], a[8:11]
    v_exp_f32 v29, v81
    v_mfma_f32_16x16x32_bf16 a[12:15], a[224:227], v[220:223], a[12:15]
    v_add_f32 v22, v28, v29
    v_cvt_pk_bf16_f32 v200, v28, v29
    v_mfma_f32_16x16x32_bf16 a[16:19], a[228:231], v[208:211], a[16:19]
    v_exp_f32 v30, v82
    v_mfma_f32_16x16x32_bf16 a[20:23], a[228:231], v[212:215], a[20:23]
    ds_read_b128 a[200:203], v2 offset:34944
    ds_read_b128 a[204:207], v2 offset:35008
    v_add_f32 v22, v22, v30
    v_mfma_f32_16x16x32_bf16 a[24:27], a[228:231], v[216:219], a[24:27]
    v_exp_f32 v31, v83
    v_mfma_f32_16x16x32_bf16 a[28:31], a[228:231], v[220:223], a[28:31]
    v_add_f32 v22, v22, v31
    v_cvt_pk_bf16_f32 v201, v30, v31
    v_mfma_f32_16x16x32_bf16 a[32:35], a[232:235], v[208:211], a[32:35]
    v_exp_f32 v32, v84
    v_mfma_f32_16x16x32_bf16 a[36:39], a[232:235], v[212:215], a[36:39]
    ds_read_b128 a[208:211], v2 offset:39168
    ds_read_b128 a[212:215], v2 offset:39232
    v_add_f32 v22, v22, v32
    v_mfma_f32_16x16x32_bf16 a[40:43], a[232:235], v[216:219], a[40:43]
    v_exp_f32 v33, v85
    v_mfma_f32_16x16x32_bf16 a[44:47], a[232:235], v[220:223], a[44:47]
    v_add_f32 v22, v22, v33
    v_cvt_pk_bf16_f32 v202, v32, v33
    v_mfma_f32_16x16x32_bf16 a[48:51], a[236:239], v[208:211], a[48:51]
    v_exp_f32 v34, v86
    v_mfma_f32_16x16x32_bf16 a[52:55], a[236:239], v[212:215], a[52:55]
    ds_read_b128 a[216:219], v2 offset:39296
    ds_read_b128 a[220:223], v2 offset:39360
    v_add_f32 v22, v22, v34
    v_mfma_f32_16x16x32_bf16 a[56:59], a[236:239], v[216:219], a[56:59]
    v_exp_f32 v35, v87
    v_mfma_f32_16x16x32_bf16 a[60:63], a[236:239], v[220:223], a[60:63]
    s_add_u32 m0, s23, 52224
    v_add_f32 v22, v22, v35
    v_cvt_pk_bf16_f32 v203, v34, v35
    v_mfma_f32_16x16x32_bf16 a[64:67], a[240:243], v[208:211], a[64:67]
    v_exp_f32 v28, v88
    v_mfma_f32_16x16x32_bf16 a[68:71], a[240:243], v[212:215], a[68:71]
    buffer_load_dwordx4 v12, s[8:11], s21 offen offset:0 lds
    v_max3_f32 v24, v20, v21, v22
    v_mfma_f32_16x16x32_bf16 a[72:75], a[240:243], v[216:219], a[72:75]
    v_exp_f32 v29, v89
    v_mfma_f32_16x16x32_bf16 a[76:79], a[240:243], v[220:223], a[76:79]
    v_add_f32 v23, v28, v29
    v_cvt_pk_bf16_f32 v204, v28, v29
    v_mfma_f32_16x16x32_bf16 a[80:83], a[244:247], v[208:211], a[80:83]
    v_exp_f32 v30, v90
    v_mfma_f32_16x16x32_bf16 a[84:87], a[244:247], v[212:215], a[84:87]
    buffer_load_dwordx4 v13, s[8:11], s21 offen offset:1088 lds
    v_add_f32 v23, v23, v30
    v_mfma_f32_16x16x32_bf16 a[88:91], a[244:247], v[216:219], a[88:91]
    v_exp_f32 v31, v91
    v_mfma_f32_16x16x32_bf16 a[92:95], a[244:247], v[220:223], a[92:95]
    v_add_f32 v23, v23, v31
    v_cvt_pk_bf16_f32 v205, v30, v31
    v_mfma_f32_16x16x32_bf16 a[96:99], a[248:251], v[208:211], a[96:99]
    v_exp_f32 v32, v92
    v_mfma_f32_16x16x32_bf16 a[100:103], a[248:251], v[212:215], a[100:103]
    buffer_load_dwordx4 v14, s[8:11], s21 offen offset:2176 lds
    v_add_f32 v23, v23, v32
    v_mfma_f32_16x16x32_bf16 a[104:107], a[248:251], v[216:219], a[104:107]
    v_exp_f32 v33, v93
    v_mfma_f32_16x16x32_bf16 a[108:111], a[248:251], v[220:223], a[108:111]
    v_add_f32 v23, v23, v33
    v_cvt_pk_bf16_f32 v206, v32, v33
    v_mfma_f32_16x16x32_bf16 a[112:115], a[252:255], v[208:211], a[112:115]
    v_exp_f32 v34, v94
    v_mfma_f32_16x16x32_bf16 a[116:119], a[252:255], v[212:215], a[116:119]
    buffer_load_dwordx4 v15, s[8:11], s21 offen offset:3264 lds
    v_add_f32 v23, v23, v34
    v_mfma_f32_16x16x32_bf16 a[120:123], a[252:255], v[216:219], a[120:123]
    v_exp_f32 v35, v95
    v_mfma_f32_16x16x32_bf16 a[124:127], a[252:255], v[220:223], a[124:127]
    s_add_u32 s21, s21, 16384
    v_add_f32 v23, v23, v35
    v_cvt_pk_bf16_f32 v207, v34, v35
    v_max_f32 v24, v24, v23
    v_cmp_lt_f32 vcc, s25, v24
    s_waitcnt lgkmcnt(0)
    s_cbranch_vccnz rare_stub_21
rare_back_22:
    v_mfma_f32_16x16x32_bf16 v[64:67], a[192:195], v[128:131], v[40:43]
    v_exp_f32 v28, v96
    v_mfma_f32_16x16x32_bf16 v[72:75], a[192:195], v[132:135], v[44:47]
    ds_read_b64_tr_b16 a[224:225], v4 offset:17408
    ds_read_b64_tr_b16 a[226:227], v4 offset:21760
    v_add_f32 v16, v16, v20
    v_add_f32 v17, v17, v21
    v_mfma_f32_16x16x32_bf16 v[80:83], a[192:195], v[136:139], v[48:51]
    v_exp_f32 v29, v97
    v_mfma_f32_16x16x32_bf16 v[88:91], a[192:195], v[140:143], v[52:55]
    v_add_f32 v20, v28, v29
    v_cvt_pk_bf16_f32 v208, v28, v29
    v_mfma_f32_16x16x32_bf16 v[64:67], a[196:199], v[144:147], v[64:67]
    v_exp_f32 v30, v98
    v_mfma_f32_16x16x32_bf16 v[72:75], a[196:199], v[148:151], v[72:75]
    ds_read_b64_tr_b16 a[228:229], v5 offset:17440
    ds_read_b64_tr_b16 a[230:231], v5 offset:21792
    v_add_f32 v20, v20, v30
    v_mfma_f32_16x16x32_bf16 v[80:83], a[196:199], v[152:155], v[80:83]
    v_exp_f32 v31, v99
    v_mfma_f32_16x16x32_bf16 v[88:91], a[196:199], v[156:159], v[88:91]
    v_add_f32 v20, v20, v31
    v_cvt_pk_bf16_f32 v209, v30, v31
    v_mfma_f32_16x16x32_bf16 v[64:67], a[200:203], v[160:163], v[64:67]
    v_exp_f32 v32, v100
    v_mfma_f32_16x16x32_bf16 v[72:75], a[200:203], v[164:167], v[72:75]
    ds_read_b64_tr_b16 a[232:233], v4 offset:17472
    ds_read_b64_tr_b16 a[234:235], v4 offset:21824
    v_add_f32 v20, v20, v32
    v_mfma_f32_16x16x32_bf16 v[80:83], a[200:203], v[168:171], v[80:83]
    v_exp_f32 v33, v101
    v_mfma_f32_16x16x32_bf16 v[88:91], a[200:203], v[172:175], v[88:91]
    v_add_f32 v20, v20, v33
    v_cvt_pk_bf16_f32 v210, v32, v33
    v_mfma_f32_16x16x32_bf16 v[64:67], a[204:207], v[176:179], v[64:67]
    v_exp_f32 v34, v102
    v_mfma_f32_16x16x32_bf16 v[72:75], a[204:207], v[180:183], v[72:75]
    ds_read_b64_tr_b16 a[236:237], v5 offset:17504
    ds_read_b64_tr_b16 a[238:239], v5 offset:21856
    v_add_f32 v20, v20, v34
    v_mfma_f32_16x16x32_bf16 v[80:83], a[204:207], v[184:187], v[80:83]
    v_exp_f32 v35, v103
    v_mfma_f32_16x16x32_bf16 v[88:91], a[204:207], v[188:191], v[88:91]
    v_add_f32 v20, v20, v35
    v_cvt_pk_bf16_f32 v211, v34, v35
    v_mfma_f32_16x16x32_bf16 v[68:71], a[208:211], v[128:131], v[40:43]
    v_exp_f32 v28, v104
    v_mfma_f32_16x16x32_bf16 v[76:79], a[208:211], v[132:135], v[44:47]
    ds_read_b64_tr_b16 a[240:241], v4 offset:17536
    ds_read_b64_tr_b16 a[242:243], v4 offset:21888
    v_add_f32 v18, v18, v22
    v_add_f32 v19, v19, v23
    v_mfma_f32_16x16x32_bf16 v[84:87], a[208:211], v[136:139], v[48:51]
    v_exp_f32 v29, v105
    v_mfma_f32_16x16x32_bf16 v[92:95], a[208:211], v[140:143], v[52:55]
    v_add_f32 v21, v28, v29
    v_cvt_pk_bf16_f32 v212, v28, v29
    v_mfma_f32_16x16x32_bf16 v[68:71], a[212:215], v[144:147], v[68:71]
    v_exp_f32 v30, v106
    v_mfma_f32_16x16x32_bf16 v[76:79], a[212:215], v[148:151], v[76:79]
    ds_read_b64_tr_b16 a[244:245], v5 offset:17568
    ds_read_b64_tr_b16 a[246:247], v5 offset:21920
    v_add_f32 v21, v21, v30
    v_mfma_f32_16x16x32_bf16 v[84:87], a[212:215], v[152:155], v[84:87]
    v_exp_f32 v31, v107
    v_mfma_f32_16x16x32_bf16 v[92:95], a[212:215], v[156:159], v[92:95]
    v_add_f32 v21, v21, v31
    v_cvt_pk_bf16_f32 v213, v30, v31
    v_mfma_f32_16x16x32_bf16 v[68:71], a[216:219], v[160:163], v[68:71]
    v_exp_f32 v32, v108
    v_mfma_f32_16x16x32_bf16 v[76:79], a[216:219], v[164:167], v[76:79]
    ds_read_b64_tr_b16 a[248:249], v4 offset:17600
    ds_read_b64_tr_b16 a[250:251], v4 offset:21952
    v_add_f32 v21, v21, v32
    v_mfma_f32_16x16x32_bf16 v[84:87], a[216:219], v[168:171], v[84:87]
    v_exp_f32 v33, v109
    v_mfma_f32_16x16x32_bf16 v[92:95], a[216:219], v[172:175], v[92:95]
    v_add_f32 v21, v21, v33
    v_cvt_pk_bf16_f32 v214, v32, v33
    v_mfma_f32_16x16x32_bf16 v[68:71], a[220:223], v[176:179], v[68:71]
    v_exp_f32 v34, v110
    v_mfma_f32_16x16x32_bf16 v[76:79], a[220:223], v[180:183], v[76:79]
    ds_read_b64_tr_b16 a[252:253], v5 offset:17632
    ds_read_b64_tr_b16 a[254:255], v5 offset:21984
    v_add_f32 v21, v21, v34
    v_mfma_f32_16x16x32_bf16 v[84:87], a[220:223], v[184:187], v[84:87]
    v_exp_f32 v35, v111
    v_mfma_f32_16x16x32_bf16 v[92:95], a[220:223], v[188:191], v[92:95]
    v_add_f32 v21, v21, v35
    v_cvt_pk_bf16_f32 v215, v34, v35
    s_waitcnt lgkmcnt(0)
    v_mfma_f32_16x16x32_bf16 a[0:3], a[224:227], v[192:195], a[0:3]
    v_exp_f32 v28, v112
    v_mfma_f32_16x16x32_bf16 a[4:7], a[224:227], v[196:199], a[4:7]
    ds_read_b128 a[192:195], v2 offset:43520
    ds_read_b128 a[196:199], v2 offset:43584
    v_mfma_f32_16x16x32_bf16 a[8:11], a[224:227], v[200:203], a[8:11]
    v_exp_f32 v29, v113
    v_mfma_f32_16x16x32_bf16 a[12:15], a[224:227], v[204:207], a[12:15]
    v_add_f32 v22, v28, v29
    v_cvt_pk_bf16_f32 v216, v28, v29
    v_mfma_f32_16x16x32_bf16 a[16:19], a[228:231], v[192:195], a[16:19]
    v_exp_f32 v30, v114
    v_mfma_f32_16x16x32_bf16 a[20:23], a[228:231], v[196:199], a[20:23]
    ds_read_b128 a[200:203], v2 offset:43648
    ds_read_b128 a[204:207], v2 offset:43712
    v_add_f32 v22, v22, v30
    v_mfma_f32_16x16x32_bf16 a[24:27], a[228:231], v[200:203], a[24:27]
    v_exp_f32 v31, v115
    v_mfma_f32_16x16x32_bf16 a[28:31], a[228:231], v[204:207], a[28:31]
    v_add_f32 v22, v22, v31
    v_cvt_pk_bf16_f32 v217, v30, v31
    v_mfma_f32_16x16x32_bf16 a[32:35], a[232:235], v[192:195], a[32:35]
    v_exp_f32 v32, v116
    v_mfma_f32_16x16x32_bf16 a[36:39], a[232:235], v[196:199], a[36:39]
    ds_read_b128 a[208:211], v2 offset:47872
    ds_read_b128 a[212:215], v2 offset:47936
    v_add_f32 v22, v22, v32
    v_mfma_f32_16x16x32_bf16 a[40:43], a[232:235], v[200:203], a[40:43]
    v_exp_f32 v33, v117
    v_mfma_f32_16x16x32_bf16 a[44:47], a[232:235], v[204:207], a[44:47]
    v_add_f32 v22, v22, v33
    v_cvt_pk_bf16_f32 v218, v32, v33
    v_mfma_f32_16x16x32_bf16 a[48:51], a[236:239], v[192:195], a[48:51]
    v_exp_f32 v34, v118
    v_mfma_f32_16x16x32_bf16 a[52:55], a[236:239], v[196:199], a[52:55]
    ds_read_b128 a[216:219], v2 offset:48000
    ds_read_b128 a[220:223], v2 offset:48064
    v_add_f32 v22, v22, v34
    v_mfma_f32_16x16x32_bf16 a[56:59], a[236:239], v[200:203], a[56:59]
    v_exp_f32 v35, v119
    v_mfma_f32_16x16x32_bf16 a[60:63], a[236:239], v[204:207], a[60:63]
    v_add_f32 v22, v22, v35
    v_cvt_pk_bf16_f32 v219, v34, v35
    v_mfma_f32_16x16x32_bf16 a[64:67], a[240:243], v[192:195], a[64:67]
    v_exp_f32 v28, v120
    v_mfma_f32_16x16x32_bf16 a[68:71], a[240:243], v[196:199], a[68:71]
    v_max3_f32 v24, v20, v21, v22
    v_mfma_f32_16x16x32_bf16 a[72:75], a[240:243], v[200:203], a[72:75]
    v_exp_f32 v29, v121
    v_mfma_f32_16x16x32_bf16 a[76:79], a[240:243], v[204:207], a[76:79]
    v_add_f32 v23, v28, v29
    v_cvt_pk_bf16_f32 v220, v28, v29
    v_mfma_f32_16x16x32_bf16 a[80:83], a[244:247], v[192:195], a[80:83]
    v_exp_f32 v30, v122
    v_mfma_f32_16x16x32_bf16 a[84:87], a[244:247], v[196:199], a[84:87]
    v_add_f32 v23, v23, v30
    v_mfma_f32_16x16x32_bf16 a[88:91], a[244:247], v[200:203], a[88:91]
    v_exp_f32 v31, v123
    v_mfma_f32_16x16x32_bf16 a[92:95], a[244:247], v[204:207], a[92:95]
    v_add_f32 v23, v23, v31
    v_cvt_pk_bf16_f32 v221, v30, v31
    v_mfma_f32_16x16x32_bf16 a[96:99], a[248:251], v[192:195], a[96:99]
    v_exp_f32 v32, v124
    v_mfma_f32_16x16x32_bf16 a[100:103], a[248:251], v[196:199], a[100:103]
    v_add_f32 v23, v23, v32
    v_mfma_f32_16x16x32_bf16 a[104:107], a[248:251], v[200:203], a[104:107]
    v_exp_f32 v33, v125
    v_mfma_f32_16x16x32_bf16 a[108:111], a[248:251], v[204:207], a[108:111]
    v_add_f32 v23, v23, v33
    v_cvt_pk_bf16_f32 v222, v32, v33
    v_mfma_f32_16x16x32_bf16 a[112:115], a[252:255], v[192:195], a[112:115]
    v_exp_f32 v34, v126
    v_mfma_f32_16x16x32_bf16 a[116:119], a[252:255], v[196:199], a[116:119]
    v_add_f32 v23, v23, v34
    v_mfma_f32_16x16x32_bf16 a[120:123], a[252:255], v[200:203], a[120:123]
    v_exp_f32 v35, v127
    v_mfma_f32_16x16x32_bf16 a[124:127], a[252:255], v[204:207], a[124:127]
    v_add_f32 v23, v23, v35
    v_cvt_pk_bf16_f32 v223, v34, v35
    v_max_f32 v24, v24, v23
    v_cmp_lt_f32 vcc, s25, v24
    s_waitcnt lgkmcnt(0)
    s_cbranch_vccnz rare_stub_23
rare_back_24:
    v_mfma_f32_16x16x32_bf16 v[96:99], a[192:195], v[128:131], v[40:43]
    v_exp_f32 v28, v64
    v_mfma_f32_16x16x32_bf16 v[104:107], a[192:195], v[132:135], v[44:47]
    ds_read_b64_tr_b16 a[224:225], v4 offset:26112
    ds_read_b64_tr_b16 a[226:227], v4 offset:30464
    v_add_f32 v16, v16, v20
    v_add_f32 v17, v17, v21
    v_mfma_f32_16x16x32_bf16 v[112:115], a[192:195], v[136:139], v[48:51]
    v_exp_f32 v29, v65
    v_mfma_f32_16x16x32_bf16 v[120:123], a[192:195], v[140:143], v[52:55]
    v_add_f32 v20, v28, v29
    v_cvt_pk_bf16_f32 v192, v28, v29
    v_mfma_f32_16x16x32_bf16 v[96:99], a[196:199], v[144:147], v[96:99]
    v_exp_f32 v30, v66
    v_mfma_f32_16x16x32_bf16 v[104:107], a[196:199], v[148:151], v[104:107]
    ds_read_b64_tr_b16 a[228:229], v5 offset:26144
    ds_read_b64_tr_b16 a[230:231], v5 offset:30496
    v_add_f32 v20, v20, v30
    v_mfma_f32_16x16x32_bf16 v[112:115], a[196:199], v[152:155], v[112:115]
    v_exp_f32 v31, v67
    v_mfma_f32_16x16x32_bf16 v[120:123], a[196:199], v[156:159], v[120:123]
    v_add_f32 v20, v20, v31
    v_cvt_pk_bf16_f32 v193, v30, v31
    v_mfma_f32_16x16x32_bf16 v[96:99], a[200:203], v[160:163], v[96:99]
    v_exp_f32 v32, v68
    v_mfma_f32_16x16x32_bf16 v[104:107], a[200:203], v[164:167], v[104:107]
    ds_read_b64_tr_b16 a[232:233], v4 offset:26176
    ds_read_b64_tr_b16 a[234:235], v4 offset:30528
    v_add_f32 v20, v20, v32
    v_mfma_f32_16x16x32_bf16 v[112:115], a[200:203], v[168:171], v[112:115]
    v_exp_f32 v33, v69
    v_mfma_f32_16x16x32_bf16 v[120:123], a[200:203], v[172:175], v[120:123]
    v_add_f32 v20, v20, v33
    v_cvt_pk_bf16_f32 v194, v32, v33
    v_mfma_f32_16x16x32_bf16 v[96:99], a[204:207], v[176:179], v[96:99]
    v_exp_f32 v34, v70
    v_mfma_f32_16x16x32_bf16 v[104:107], a[204:207], v[180:183], v[104:107]
    ds_read_b64_tr_b16 a[236:237], v5 offset:26208
    ds_read_b64_tr_b16 a[238:239], v5 offset:30560
    v_add_f32 v20, v20, v34
    v_mfma_f32_16x16x32_bf16 v[112:115], a[204:207], v[184:187], v[112:115]
    v_exp_f32 v35, v71
    v_mfma_f32_16x16x32_bf16 v[120:123], a[204:207], v[188:191], v[120:123]
    v_add_f32 v20, v20, v35
    v_cvt_pk_bf16_f32 v195, v34, v35
    v_mfma_f32_16x16x32_bf16 v[100:103], a[208:211], v[128:131], v[40:43]
    v_exp_f32 v28, v72
    v_mfma_f32_16x16x32_bf16 v[108:111], a[208:211], v[132:135], v[44:47]
    ds_read_b64_tr_b16 a[240:241], v4 offset:26240
    ds_read_b64_tr_b16 a[242:243], v4 offset:30592
    v_add_f32 v18, v18, v22
    v_add_f32 v19, v19, v23
    v_mfma_f32_16x16x32_bf16 v[116:119], a[208:211], v[136:139], v[48:51]
    v_exp_f32 v29, v73
    v_mfma_f32_16x16x32_bf16 v[124:127], a[208:211], v[140:143], v[52:55]
    v_add_f32 v21, v28, v29
    v_cvt_pk_bf16_f32 v196, v28, v29
    v_mfma_f32_16x16x32_bf16 v[100:103], a[212:215], v[144:147], v[100:103]
    v_exp_f32 v30, v74
    v_mfma_f32_16x16x32_bf16 v[108:111], a[212:215], v[148:151], v[108:111]
    ds_read_b64_tr_b16 a[244:245], v5 offset:26272
    ds_read_b64_tr_b16 a[246:247], v5 offset:30624
    v_add_f32 v21, v21, v30
    v_mfma_f32_16x16x32_bf16 v[116:119], a[212:215], v[152:155], v[116:119]
    v_exp_f32 v31, v75
    v_mfma_f32_16x16x32_bf16 v[124:127], a[212:215], v[156:159], v[124:127]
    v_add_f32 v21, v21, v31
    v_cvt_pk_bf16_f32 v197, v30, v31
    v_mfma_f32_16x16x32_bf16 v[100:103], a[216:219], v[160:163], v[100:103]
    v_exp_f32 v32, v76
    v_mfma_f32_16x16x32_bf16 v[108:111], a[216:219], v[164:167], v[108:111]
    ds_read_b64_tr_b16 a[248:249], v4 offset:26304
    ds_read_b64_tr_b16 a[250:251], v4 offset:30656
    v_add_f32 v21, v21, v32
    v_mfma_f32_16x16x32_bf16 v[116:119], a[216:219], v[168:171], v[116:119]
    v_exp_f32 v33, v77
    v_mfma_f32_16x16x32_bf16 v[124:127], a[216:219], v[172:175], v[124:127]
    v_add_f32 v21, v21, v33
    v_cvt_pk_bf16_f32 v198, v32, v33
    v_mfma_f32_16x16x32_bf16 v[100:103], a[220:223], v[176:179], v[100:103]
    v_exp_f32 v34, v78
    v_mfma_f32_16x16x32_bf16 v[108:111], a[220:223], v[180:183], v[108:111]
    ds_read_b64_tr_b16 a[252:253], v5 offset:26336
    ds_read_b64_tr_b16 a[254:255], v5 offset:30688
    v_add_f32 v21, v21, v34
    v_mfma_f32_16x16x32_bf16 v[116:119], a[220:223], v[184:187], v[116:119]
    v_exp_f32 v35, v79
    v_mfma_f32_16x16x32_bf16 v[124:127], a[220:223], v[188:191], v[124:127]
    v_add_f32 v21, v21, v35
    v_cvt_pk_bf16_f32 v199, v34, v35
    s_waitcnt vmcnt(8) lgkmcnt(0)
    s_barrier
    v_mfma_f32_16x16x32_bf16 a[0:3], a[224:227], v[208:211], a[0:3]
    v_exp_f32 v28, v80
    v_mfma_f32_16x16x32_bf16 a[4:7], a[224:227], v[212:215], a[4:7]
    ds_read_b128 a[192:195], v2 offset:52224
    ds_read_b128 a[196:199], v2 offset:52288
    v_mfma_f32_16x16x32_bf16 a[8:11], a[224:227], v[216:219], a[8:11]
    v_exp_f32 v29, v81
    v_mfma_f32_16x16x32_bf16 a[12:15], a[224:227], v[220:223], a[12:15]
    v_add_f32 v22, v28, v29
    v_cvt_pk_bf16_f32 v200, v28, v29
    v_mfma_f32_16x16x32_bf16 a[16:19], a[228:231], v[208:211], a[16:19]
    v_exp_f32 v30, v82
    v_mfma_f32_16x16x32_bf16 a[20:23], a[228:231], v[212:215], a[20:23]
    ds_read_b128 a[200:203], v2 offset:52352
    ds_read_b128 a[204:207], v2 offset:52416
    v_add_f32 v22, v22, v30
    v_mfma_f32_16x16x32_bf16 a[24:27], a[228:231], v[216:219], a[24:27]
    v_exp_f32 v31, v83
    v_mfma_f32_16x16x32_bf16 a[28:31], a[228:231], v[220:223], a[28:31]
    v_add_f32 v22, v22, v31
    v_cvt_pk_bf16_f32 v201, v30, v31
    v_mfma_f32_16x16x32_bf16 a[32:35], a[232:235], v[208:211], a[32:35]
    v_exp_f32 v32, v84
    v_mfma_f32_16x16x32_bf16 a[36:39], a[232:235], v[212:215], a[36:39]
    ds_read_b128 a[208:211], v2 offset:56576
    ds_read_b128 a[212:215], v2 offset:56640
    v_add_f32 v22, v22, v32
    v_mfma_f32_16x16x32_bf16 a[40:43], a[232:235], v[216:219], a[40:43]
    v_exp_f32 v33, v85
    v_mfma_f32_16x16x32_bf16 a[44:47], a[232:235], v[220:223], a[44:47]
    v_add_f32 v22, v22, v33
    v_cvt_pk_bf16_f32 v202, v32, v33
    v_mfma_f32_16x16x32_bf16 a[48:51], a[236:239], v[208:211], a[48:51]
    v_exp_f32 v34, v86
    v_mfma_f32_16x16x32_bf16 a[52:55], a[236:239], v[212:215], a[52:55]
    ds_read_b128 a[216:219], v2 offset:56704
    ds_read_b128 a[220:223], v2 offset:56768
    v_add_f32 v22, v22, v34
    v_mfma_f32_16x16x32_bf16 a[56:59], a[236:239], v[216:219], a[56:59]
    v_exp_f32 v35, v87
    v_mfma_f32_16x16x32_bf16 a[60:63], a[236:239], v[220:223], a[60:63]
    v_add_f32 v22, v22, v35
    v_cvt_pk_bf16_f32 v203, v34, v35
    v_mfma_f32_16x16x32_bf16 a[64:67], a[240:243], v[208:211], a[64:67]
    v_exp_f32 v28, v88
    v_mfma_f32_16x16x32_bf16 a[68:71], a[240:243], v[212:215], a[68:71]
    v_max3_f32 v24, v20, v21, v22
    v_mfma_f32_16x16x32_bf16 a[72:75], a[240:243], v[216:219], a[72:75]
    v_exp_f32 v29, v89
    v_mfma_f32_16x16x32_bf16 a[76:79], a[240:243], v[220:223], a[76:79]
    v_add_f32 v23, v28, v29
    v_cvt_pk_bf16_f32 v204, v28, v29
    v_mfma_f32_16x16x32_bf16 a[80:83], a[244:247], v[208:211], a[80:83]
    v_exp_f32 v30, v90
    v_mfma_f32_16x16x32_bf16 a[84:87], a[244:247], v[212:215], a[84:87]
    v_add_f32 v23, v23, v30
    v_mfma_f32_16x16x32_bf16 a[88:91], a[244:247], v[216:219], a[88:91]
    v_exp_f32 v31, v91
    v_mfma_f32_16x16x32_bf16 a[92:95], a[244:247], v[220:223], a[92:95]
    v_add_f32 v23, v23, v31
    v_cvt_pk_bf16_f32 v205, v30, v31
    v_mfma_f32_16x16x32_bf16 a[96:99], a[248:251], v[208:211], a[96:99]
    v_exp_f32 v32, v92
    v_mfma_f32_16x16x32_bf16 a[100:103], a[248:251], v[212:215], a[100:103]
    v_add_f32 v23, v23, v32
    v_mfma_f32_16x16x32_bf16 a[104:107], a[248:251], v[216:219], a[104:107]
    v_exp_f32 v33, v93
    v_mfma_f32_16x16x32_bf16 a[108:111], a[248:251], v[220:223], a[108:111]
    v_add_f32 v23, v23, v33
    v_cvt_pk_bf16_f32 v206, v32, v33
    v_mfma_f32_16x16x32_bf16 a[112:115], a[252:255], v[208:211], a[112:115]
    v_exp_f32 v34, v94
    v_mfma_f32_16x16x32_bf16 a[116:119], a[252:255], v[212:215], a[116:119]
    v_add_f32 v23, v23, v34
    v_mfma_f32_16x16x32_bf16 a[120:123], a[252:255], v[216:219], a[120:123]
    v_exp_f32 v35, v95
    v_mfma_f32_16x16x32_bf16 a[124:127], a[252:255], v[220:223], a[124:127]
    v_add_f32 v23, v23, v35
    v_cvt_pk_bf16_f32 v207, v34, v35
    v_max_f32 v24, v24, v23
    v_cmp_lt_f32 vcc, s25, v24
    s_waitcnt lgkmcnt(0)
    s_cbranch_vccnz rare_stub_25
rare_back_26:
    v_mfma_f32_16x16x32_bf16 v[64:67], a[192:195], v[128:131], v[40:43]
    v_exp_f32 v28, v96
    v_mfma_f32_16x16x32_bf16 v[72:75], a[192:195], v[132:135], v[44:47]
    ds_read_b64_tr_b16 a[224:225], v6 offset:0
    ds_read_b64_tr_b16 a[226:227], v6 offset:4352
    v_add_f32 v16, v16, v20
    v_add_f32 v17, v17, v21
    v_mfma_f32_16x16x32_bf16 v[80:83], a[192:195], v[136:139], v[48:51]
    v_exp_f32 v29, v97
    v_mfma_f32_16x16x32_bf16 v[88:91], a[192:195], v[140:143], v[52:55]
    v_add_f32 v20, v28, v29
    v_cvt_pk_bf16_f32 v208, v28, v29
    v_mfma_f32_16x16x32_bf16 v[64:67], a[196:199], v[144:147], v[64:67]
    v_exp_f32 v30, v98
    v_mfma_f32_16x16x32_bf16 v[72:75], a[196:199], v[148:151], v[72:75]
    ds_read_b64_tr_b16 a[228:229], v7 offset:32
    ds_read_b64_tr_b16 a[230:231], v7 offset:4384
    v_add_f32 v20, v20, v30
    v_mfma_f32_16x16x32_bf16 v[80:83], a[196:199], v[152:155], v[80:83]
    v_exp_f32 v31, v99
    v_mfma_f32_16x16x32_bf16 v[88:91], a[196:199], v[156:159], v[88:91]
    v_add_f32 v20, v20, v31
    v_cvt_pk_bf16_f32 v209, v30, v31
    v_mfma_f32_16x16x32_bf16 v[64:67], a[200:203], v[160:163], v[64:67]
    v_exp_f32 v32, v100
    v_mfma_f32_16x16x32_bf16 v[72:75], a[200:203], v[164:167], v[72:75]
    ds_read_b64_tr_b16 a[232:233], v6 offset:64
    ds_read_b64_tr_b16 a[234:235], v6 offset:4416
    v_add_f32 v20, v20, v32
    v_mfma_f32_16x16x32_bf16 v[80:83], a[200:203], v[168:171], v[80:83]
    v_exp_f32 v33, v101
    v_mfma_f32_16x16x32_bf16 v[88:91], a[200:203], v[172:175], v[88:91]
    v_add_f32 v20, v20, v33
    v_cvt_pk_bf16_f32 v210, v32, v33
    v_mfma_f32_16x16x32_bf16 v[64:67], a[204:207], v[176:179], v[64:67]
    v_exp_f32 v34, v102
    v_mfma_f32_16x16x32_bf16 v[72:75], a[204:207], v[180:183], v[72:75]
    ds_read_b64_tr_b16 a[236:237], v7 offset:96
    ds_read_b64_tr_b16 a[238:239], v7 offset:4448
    v_add_f32 v20, v20, v34
    v_mfma_f32_16x16x32_bf16 v[80:83], a[204:207], v[184:187], v[80:83]
    v_exp_f32 v35, v103
    v_mfma_f32_16x16x32_bf16 v[88:91], a[204:207], v[188:191], v[88:91]
    v_add_f32 v20, v20, v35
    v_cvt_pk_bf16_f32 v211, v34, v35
    v_mfma_f32_16x16x32_bf16 v[68:71], a[208:211], v[128:131], v[40:43]
    v_exp_f32 v28, v104
    v_mfma_f32_16x16x32_bf16 v[76:79], a[208:211], v[132:135], v[44:47]
    ds_read_b64_tr_b16 a[240:241], v6 offset:128
    ds_read_b64_tr_b16 a[242:243], v6 offset:4480
    v_add_f32 v18, v18, v22
    v_add_f32 v19, v19, v23
    v_mfma_f32_16x16x32_bf16 v[84:87], a[208:211], v[136:139], v[48:51]
    v_exp_f32 v29, v105
    v_mfma_f32_16x16x32_bf16 v[92:95], a[208:211], v[140:143], v[52:55]
    v_add_f32 v21, v28, v29
    v_cvt_pk_bf16_f32 v212, v28, v29
    v_mfma_f32_16x16x32_bf16 v[68:71], a[212:215], v[144:147], v[68:71]
    v_exp_f32 v30, v106
    v_mfma_f32_16x16x32_bf16 v[76:79], a[212:215], v[148:151], v[76:79]
    ds_read_b64_tr_b16 a[244:245], v7 offset:160
    ds_read_b64_tr_b16 a[246:247], v7 offset:4512
    v_add_f32 v21, v21, v30
    v_mfma_f32_16x16x32_bf16 v[84:87], a[212:215], v[152:155], v[84:87]
    v_exp_f32 v31, v107
    v_mfma_f32_16x16x32_bf16 v[92:95], a[212:215], v[156:159], v[92:95]
    v_add_f32 v21, v21, v31
    v_cvt_pk_bf16_f32 v213, v30, v31
    v_mfma_f32_16x16x32_bf16 v[68:71], a[216:219], v[160:163], v[68:71]
    v_exp_f32 v32, v108
    v_mfma_f32_16x16x32_bf16 v[76:79], a[216:219], v[164:167], v[76:79]
    ds_read_b64_tr_b16 a[248:249], v6 offset:192
    ds_read_b64_tr_b16 a[250:251], v6 offset:4544
    v_add_f32 v21, v21, v32
    v_mfma_f32_16x16x32_bf16 v[84:87], a[216:219], v[168:171], v[84:87]
    v_exp_f32 v33, v109
    v_mfma_f32_16x16x32_bf16 v[92:95], a[216:219], v[172:175], v[92:95]
    v_add_f32 v21, v21, v33
    v_cvt_pk_bf16_f32 v214, v32, v33
    v_mfma_f32_16x16x32_bf16 v[68:71], a[220:223], v[176:179], v[68:71]
    v_exp_f32 v34, v110
    v_mfma_f32_16x16x32_bf16 v[76:79], a[220:223], v[180:183], v[76:79]
    ds_read_b64_tr_b16 a[252:253], v7 offset:224
    ds_read_b64_tr_b16 a[254:255], v7 offset:4576
    v_add_f32 v21, v21, v34
    v_mfma_f32_16x16x32_bf16 v[84:87], a[220:223], v[184:187], v[84:87]
    v_exp_f32 v35, v111
    v_mfma_f32_16x16x32_bf16 v[92:95], a[220:223], v[188:191], v[92:95]
    v_add_f32 v21, v21, v35
    v_cvt_pk_bf16_f32 v215, v34, v35
    s_waitcnt lgkmcnt(0)
    v_mfma_f32_16x16x32_bf16 a[0:3], a[224:227], v[192:195], a[0:3]
    v_exp_f32 v28, v112
    v_mfma_f32_16x16x32_bf16 a[4:7], a[224:227], v[196:199], a[4:7]
    ds_read_b128 a[192:195], v2 offset:60928
    ds_read_b128 a[196:199], v2 offset:60992
    v_mfma_f32_16x16x32_bf16 a[8:11], a[224:227], v[200:203], a[8:11]
    v_exp_f32 v29, v113
    v_mfma_f32_16x16x32_bf16 a[12:15], a[224:227], v[204:207], a[12:15]
    v_add_f32 v22, v28, v29
    v_cvt_pk_bf16_f32 v216, v28, v29
    v_mfma_f32_16x16x32_bf16 a[16:19], a[228:231], v[192:195], a[16:19]
    v_exp_f32 v30, v114
    v_mfma_f32_16x16x32_bf16 a[20:23], a[228:231], v[196:199], a[20:23]
    ds_read_b128 a[200:203], v2 offset:61056
    ds_read_b128 a[204:207], v2 offset:61120
    v_add_f32 v22, v22, v30
    v_mfma_f32_16x16x32_bf16 a[24:27], a[228:231], v[200:203], a[24:27]
    v_exp_f32 v31, v115
    v_mfma_f32_16x16x32_bf16 a[28:31], a[228:231], v[204:207], a[28:31]
    v_add_f32 v22, v22, v31
    v_cvt_pk_bf16_f32 v217, v30, v31
    v_mfma_f32_16x16x32_bf16 a[32:35], a[232:235], v[192:195], a[32:35]
    v_exp_f32 v32, v116
    v_mfma_f32_16x16x32_bf16 a[36:39], a[232:235], v[196:199], a[36:39]
    ds_read_b128 a[208:211], v2 offset:65280
    ds_read_b128 a[212:215], v2 offset:65344
    v_add_f32 v22, v22, v32
    v_mfma_f32_16x16x32_bf16 a[40:43], a[232:235], v[200:203], a[40:43]
    v_exp_f32 v33, v117
    v_mfma_f32_16x16x32_bf16 a[44:47], a[232:235], v[204:207], a[44:47]
    v_add_f32 v22, v22, v33
    v_cvt_pk_bf16_f32 v218, v32, v33
    v_mfma_f32_16x16x32_bf16 a[48:51], a[236:239], v[192:195], a[48:51]
    v_exp_f32 v34, v118
    v_mfma_f32_16x16x32_bf16 a[52:55], a[236:239], v[196:199], a[52:55]
    ds_read_b128 a[216:219], v2 offset:65408
    ds_read_b128 a[220:223], v2 offset:65472
    v_add_f32 v22, v22, v34
    v_mfma_f32_16x16x32_bf16 a[56:59], a[236:239], v[200:203], a[56:59]
    v_exp_f32 v35, v119
    v_mfma_f32_16x16x32_bf16 a[60:63], a[236:239], v[204:207], a[60:63]
    v_add_f32 v22, v22, v35
    v_cvt_pk_bf16_f32 v219, v34, v35
    v_mfma_f32_16x16x32_bf16 a[64:67], a[240:243], v[192:195], a[64:67]
    v_exp_f32 v28, v120
    v_mfma_f32_16x16x32_bf16 a[68:71], a[240:243], v[196:199], a[68:71]
    v_max3_f32 v24, v20, v21, v22
    v_mfma_f32_16x16x32_bf16 a[72:75], a[240:243], v[200:203], a[72:75]
    v_exp_f32 v29, v121
    v_mfma_f32_16x16x32_bf16 a[76:79], a[240:243], v[204:207], a[76:79]
    v_add_f32 v23, v28, v29
    v_cvt_pk_bf16_f32 v220, v28, v29
    v_mfma_f32_16x16x32_bf16 a[80:83], a[244:247], v[192:195], a[80:83]
    v_exp_f32 v30, v122
    v_mfma_f32_16x16x32_bf16 a[84:87], a[244:247], v[196:199], a[84:87]
    v_add_f32 v23, v23, v30
    v_mfma_f32_16x16x32_bf16 a[88:91], a[244:247], v[200:203], a[88:91]
    v_exp_f32 v31, v123
    v_mfma_f32_16x16x32_bf16 a[92:95], a[244:247], v[204:207], a[92:95]
    v_add_f32 v23, v23, v31
    v_cvt_pk_bf16_f32 v221, v30, v31
    v_mfma_f32_16x16x32_bf16 a[96:99], a[248:251], v[192:195], a[96:99]
    v_exp_f32 v32, v124
    v_mfma_f32_16x16x32_bf16 a[100:103], a[248:251], v[196:199], a[100:103]
    v_add_f32 v23, v23, v32
    v_mfma_f32_16x16x32_bf16 a[104:107], a[248:251], v[200:203], a[104:107]
    v_exp_f32 v33, v125
    v_mfma_f32_16x16x32_bf16 a[108:111], a[248:251], v[204:207], a[108:111]
    v_add_f32 v23, v23, v33
    v_cvt_pk_bf16_f32 v222, v32, v33
    v_mfma_f32_16x16x32_bf16 a[112:115], a[252:255], v[192:195], a[112:115]
    v_exp_f32 v34, v126
    v_mfma_f32_16x16x32_bf16 a[116:119], a[252:255], v[196:199], a[116:119]
    v_add_f32 v23, v23, v34
    v_mfma_f32_16x16x32_bf16 a[120:123], a[252:255], v[200:203], a[120:123]
    v_exp_f32 v35, v127
    v_mfma_f32_16x16x32_bf16 a[124:127], a[252:255], v[204:207], a[124:127]
    v_add_f32 v23, v23, v35
    v_cvt_pk_bf16_f32 v223, v34, v35
    v_max_f32 v24, v24, v23
    v_cmp_lt_f32 vcc, s25, v24
    s_waitcnt lgkmcnt(0)
    s_cbranch_vccnz rare_stub_27
rare_back_28:
    v_mfma_f32_16x16x32_bf16 v[96:99], a[192:195], v[128:131], v[40:43]
    v_exp_f32 v28, v64
    v_mfma_f32_16x16x32_bf16 v[104:107], a[192:195], v[132:135], v[44:47]
    ds_read_b64_tr_b16 a[224:225], v6 offset:8704
    ds_read_b64_tr_b16 a[226:227], v6 offset:13056
    v_add_f32 v16, v16, v20
    v_add_f32 v17, v17, v21
    v_mfma_f32_16x16x32_bf16 v[112:115], a[192:195], v[136:139], v[48:51]
    v_exp_f32 v29, v65
    v_mfma_f32_16x16x32_bf16 v[120:123], a[192:195], v[140:143], v[52:55]
    v_add_f32 v20, v28, v29
    v_cvt_pk_bf16_f32 v192, v28, v29
    v_mfma_f32_16x16x32_bf16 v[96:99], a[196:199], v[144:147], v[96:99]
    v_exp_f32 v30, v66
    v_mfma_f32_16x16x32_bf16 v[104:107], a[196:199], v[148:151], v[104:107]
    ds_read_b64_tr_b16 a[228:229], v7 offset:8736
    ds_read_b64_tr_b16 a[230:231], v7 offset:13088
    v_add_f32 v20, v20, v30
    v_mfma_f32_16x16x32_bf16 v[112:115], a[196:199], v[152:155], v[112:115]
    v_exp_f32 v31, v67
    v_mfma_f32_16x16x32_bf16 v[120:123], a[196:199], v[156:159], v[120:123]
    v_add_f32 v20, v20, v31
    v_cvt_pk_bf16_f32 v193, v30, v31
    v_mfma_f32_16x16x32_bf16 v[96:99], a[200:203], v[160:163], v[96:99]
    v_exp_f32 v32, v68
    v_mfma_f32_16x16x32_bf16 v[104:107], a[200:203], v[164:167], v[104:107]
    ds_read_b64_tr_b16 a[232:233], v6 offset:8768
    ds_read_b64_tr_b16 a[234:235], v6 offset:13120
    v_add_f32 v20, v20, v32
    v_mfma_f32_16x16x32_bf16 v[112:115], a[200:203], v[168:171], v[112:115]
    v_exp_f32 v33, v69
    v_mfma_f32_16x16x32_bf16 v[120:123], a[200:203], v[172:175], v[120:123]
    v_add_f32 v20, v20, v33
    v_cvt_pk_bf16_f32 v194, v32, v33
    v_mfma_f32_16x16x32_bf16 v[96:99], a[204:207], v[176:179], v[96:99]
    v_exp_f32 v34, v70
    v_mfma_f32_16x16x32_bf16 v[104:107], a[204:207], v[180:183], v[104:107]
    ds_read_b64_tr_b16 a[236:237], v7 offset:8800
    ds_read_b64_tr_b16 a[238:239], v7 offset:13152
    v_add_f32 v20, v20, v34
    v_mfma_f32_16x16x32_bf16 v[112:115], a[204:207], v[184:187], v[112:115]
    v_exp_f32 v35, v71
    v_mfma_f32_16x16x32_bf16 v[120:123], a[204:207], v[188:191], v[120:123]
    v_add_f32 v20, v20, v35
    v_cvt_pk_bf16_f32 v195, v34, v35
    v_mfma_f32_16x16x32_bf16 v[100:103], a[208:211], v[128:131], v[40:43]
    v_exp_f32 v28, v72
    v_mfma_f32_16x16x32_bf16 v[108:111], a[208:211], v[132:135], v[44:47]
    ds_read_b64_tr_b16 a[240:241], v6 offset:8832
    ds_read_b64_tr_b16 a[242:243], v6 offset:13184
    v_add_f32 v18, v18, v22
    v_add_f32 v19, v19, v23
    v_mfma_f32_16x16x32_bf16 v[116:119], a[208:211], v[136:139], v[48:51]
    v_exp_f32 v29, v73
    v_mfma_f32_16x16x32_bf16 v[124:127], a[208:211], v[140:143], v[52:55]
    v_add_f32 v21, v28, v29
    v_cvt_pk_bf16_f32 v196, v28, v29
    v_mfma_f32_16x16x32_bf16 v[100:103], a[212:215], v[144:147], v[100:103]
    v_exp_f32 v30, v74
    v_mfma_f32_16x16x32_bf16 v[108:111], a[212:215], v[148:151], v[108:111]
    ds_read_b64_tr_b16 a[244:245], v7 offset:8864
    ds_read_b64_tr_b16 a[246:247], v7 offset:13216
    v_add_f32 v21, v21, v30
    v_mfma_f32_16x16x32_bf16 v[116:119], a[212:215], v[152:155], v[116:119]
    v_exp_f32 v31, v75
    v_mfma_f32_16x16x32_bf16 v[124:127], a[212:215], v[156:159], v[124:127]
    v_add_f32 v21, v21, v31
    v_cvt_pk_bf16_f32 v197, v30, v31
    v_mfma_f32_16x16x32_bf16 v[100:103], a[216:219], v[160:163], v[100:103]
    v_exp_f32 v32, v76
    v_mfma_f32_16x16x32_bf16 v[108:111], a[216:219], v[164:167], v[108:111]
    ds_read_b64_tr_b16 a[248:249], v6 offset:8896
    ds_read_b64_tr_b16 a[250:251], v6 offset:13248
    v_add_f32 v21, v21, v32
    v_mfma_f32_16x16x32_bf16 v[116:119], a[216:219], v[168:171], v[116:119]
    v_exp_f32 v33, v77
    v_mfma_f32_16x16x32_bf16 v[124:127], a[216:219], v[172:175], v[124:127]
    v_add_f32 v21, v21, v33
    v_cvt_pk_bf16_f32 v198, v32, v33
    v_mfma_f32_16x16x32_bf16 v[100:103], a[220:223], v[176:179], v[100:103]
    v_exp_f32 v34, v78
    v_mfma_f32_16x16x32_bf16 v[108:111], a[220:223], v[180:183], v[108:111]
    ds_read_b64_tr_b16 a[252:253], v7 offset:8928
    ds_read_b64_tr_b16 a[254:255], v7 offset:13280
    v_add_f32 v21, v21, v34
    v_mfma_f32_16x16x32_bf16 v[116:119], a[220:223], v[184:187], v[116:119]
    v_exp_f32 v35, v79
    v_mfma_f32_16x16x32_bf16 v[124:127], a[220:223], v[188:191], v[124:127]
    v_add_f32 v21, v21, v35
    v_cvt_pk_bf16_f32 v199, v34, v35
    s_waitcnt vmcnt(0) lgkmcnt(0)
    s_barrier
    v_mfma_f32_16x16x32_bf16 a[0:3], a[224:227], v[208:211], a[0:3]
    v_exp_f32 v28, v80
    v_mfma_f32_16x16x32_bf16 a[4:7], a[224:227], v[212:215], a[4:7]
    v_mfma_f32_16x16x32_bf16 a[8:11], a[224:227], v[216:219], a[8:11]
    v_exp_f32 v29, v81
    v_mfma_f32_16x16x32_bf16 a[12:15], a[224:227], v[220:223], a[12:15]
    v_add_f32 v22, v28, v29
    v_cvt_pk_bf16_f32 v200, v28, v29
    v_mfma_f32_16x16x32_bf16 a[16:19], a[228:231], v[208:211], a[16:19]
    v_exp_f32 v30, v82
    v_mfma_f32_16x16x32_bf16 a[20:23], a[228:231], v[212:215], a[20:23]
    v_add_f32 v22, v22, v30
    v_mfma_f32_16x16x32_bf16 a[24:27], a[228:231], v[216:219], a[24:27]
    v_exp_f32 v31, v83
    v_mfma_f32_16x16x32_bf16 a[28:31], a[228:231], v[220:223], a[28:31]
    v_add_f32 v22, v22, v31
    v_cvt_pk_bf16_f32 v201, v30, v31
    v_mfma_f32_16x16x32_bf16 a[32:35], a[232:235], v[208:211], a[32:35]
    v_exp_f32 v32, v84
    v_mfma_f32_16x16x32_bf16 a[36:39], a[232:235], v[212:215], a[36:39]
    v_add_f32 v22, v22, v32
    v_mfma_f32_16x16x32_bf16 a[40:43], a[232:235], v[216:219], a[40:43]
    v_exp_f32 v33, v85
    v_mfma_f32_16x16x32_bf16 a[44:47], a[232:235], v[220:223], a[44:47]
    v_add_f32 v22, v22, v33
    v_cvt_pk_bf16_f32 v202, v32, v33
    v_mfma_f32_16x16x32_bf16 a[48:51], a[236:239], v[208:211], a[48:51]
    v_exp_f32 v34, v86
    v_mfma_f32_16x16x32_bf16 a[52:55], a[236:239], v[212:215], a[52:55]
    v_add_f32 v22, v22, v34
    v_mfma_f32_16x16x32_bf16 a[56:59], a[236:239], v[216:219], a[56:59]
    v_exp_f32 v35, v87
    v_mfma_f32_16x16x32_bf16 a[60:63], a[236:239], v[220:223], a[60:63]
    v_add_f32 v22, v22, v35
    v_cvt_pk_bf16_f32 v203, v34, v35
    v_mfma_f32_16x16x32_bf16 a[64:67], a[240:243], v[208:211], a[64:67]
    v_exp_f32 v28, v88
    v_mfma_f32_16x16x32_bf16 a[68:71], a[240:243], v[212:215], a[68:71]
    v_max3_f32 v24, v20, v21, v22
    v_mfma_f32_16x16x32_bf16 a[72:75], a[240:243], v[216:219], a[72:75]
    v_exp_f32 v29, v89
    v_mfma_f32_16x16x32_bf16 a[76:79], a[240:243], v[220:223], a[76:79]
    v_add_f32 v23, v28, v29
    v_cvt_pk_bf16_f32 v204, v28, v29
    v_mfma_f32_16x16x32_bf16 a[80:83], a[244:247], v[208:211], a[80:83]
    v_exp_f32 v30, v90
    v_mfma_f32_16x16x32_bf16 a[84:87], a[244:247], v[212:215], a[84:87]
    v_add_f32 v23, v23, v30
    v_mfma_f32_16x16x32_bf16 a[88:91], a[244:247], v[216:219], a[88:91]
    v_exp_f32 v31, v91
    v_mfma_f32_16x16x32_bf16 a[92:95], a[244:247], v[220:223], a[92:95]
    v_add_f32 v23, v23, v31
    v_cvt_pk_bf16_f32 v205, v30, v31
    v_mfma_f32_16x16x32_bf16 a[96:99], a[248:251], v[208:211], a[96:99]
    v_exp_f32 v32, v92
    v_mfma_f32_16x16x32_bf16 a[100:103], a[248:251], v[212:215], a[100:103]
    v_add_f32 v23, v23, v32
    v_mfma_f32_16x16x32_bf16 a[104:107], a[248:251], v[216:219], a[104:107]
    v_exp_f32 v33, v93
    v_mfma_f32_16x16x32_bf16 a[108:111], a[248:251], v[220:223], a[108:111]
    v_add_f32 v23, v23, v33
    v_cvt_pk_bf16_f32 v206, v32, v33
    v_mfma_f32_16x16x32_bf16 a[112:115], a[252:255], v[208:211], a[112:115]
    v_exp_f32 v34, v94
    v_mfma_f32_16x16x32_bf16 a[116:119], a[252:255], v[212:215], a[116:119]
    v_add_f32 v23, v23, v34
    v_mfma_f32_16x16x32_bf16 a[120:123], a[252:255], v[216:219], a[120:123]
    v_exp_f32 v35, v95
    v_mfma_f32_16x16x32_bf16 a[124:127], a[252:255], v[220:223], a[124:127]
    v_add_f32 v23, v23, v35
    v_cvt_pk_bf16_f32 v207, v34, v35
    v_max_f32 v24, v24, v23
    v_cmp_lt_f32 vcc, s25, v24
    s_cbranch_vccnz rare_stub_29
rare_back_30:
    v_cmp_ne_u32 vcc, s63, v241
    s_cbranch_vccz hf_all_set
    s_mov_b32 s62, 0
hf_poll:
    global_load_dword v241, v240, s[38:39] offset:512 sc1
    s_add_u32 s62, s62, 1
    s_waitcnt vmcnt(0)
    v_cmp_ne_u32 vcc, s63, v241
    s_cmp_ge_u32 s62, 0x20000
    s_cbranch_scc1 hf_all_set
    s_cbranch_vccnz hf_poll
hf_all_set:
    s_nop 0
    s_add_u32 m0, s75, 0
    v_exp_f32 v28, v96
    s_nop 0
    ds_read_b64_tr_b16 a[224:225], v6 offset:17408
    ds_read_b64_tr_b16 a[226:227], v6 offset:21760
    s_add_u32 s60, s64, 0
    v_add_f32 v16, v16, v20
    v_add_f32 v17, v17, v21
    s_nop 0
    buffer_load_dwordx4 v230, s[40:43], s60 offen offset:0 lds
    v_exp_f32 v29, v97
    s_nop 0
    buffer_load_dwordx4 v245, s[40:43], s60 offen offset:1024 lds
    v_add_f32 v20, v28, v29
    v_cvt_pk_bf16_f32 v208, v28, v29
    s_nop 0
    s_add_u32 m0, s74, 0
    v_exp_f32 v30, v98
    s_nop 0
    ds_read_b64_tr_b16 a[228:229], v7 offset:17440
    ds_read_b64_tr_b16 a[230:231], v7 offset:21792
    s_add_u32 s61, s65, 0
    v_add_f32 v20, v20, v30
    s_nop 0
    buffer_load_dwordx4 v233, s[48:51], s61 offen offset:0 sc1 lds
    v_exp_f32 v31, v99
    s_nop 0
    buffer_load_dwordx4 v234, s[48:51], s61 offen offset:1024 sc1 lds
    v_add_f32 v20, v20, v31
    v_cvt_pk_bf16_f32 v209, v30, v31
    s_nop 0
    s_add_u32 m0, s75, 16384
    v_exp_f32 v32, v100
    s_nop 0
    ds_read_b64_tr_b16 a[232:233], v6 offset:17472
    ds_read_b64_tr_b16 a[234:235], v6 offset:21824
    s_add_u32 s60, s64, 32768
    v_add_f32 v20, v20, v32
    s_nop 0
    buffer_load_dwordx4 v230, s[40:43], s60 offen offset:0 lds
    v_exp_f32 v33, v101
    s_nop 0
    buffer_load_dwordx4 v245, s[40:43], s60 offen offset:1024 lds
    v_add_f32 v20, v20, v33
    v_cvt_pk_bf16_f32 v210, v32, v33
    s_nop 0
    s_add_u32 m0, s74, 16384
    v_exp_f32 v34, v102
    s_nop 0
    ds_read_b64_tr_b16 a[236:237], v7 offset:17504
    ds_read_b64_tr_b16 a[238:239], v7 offset:21856
    s_add_u32 s61, s65, 1024
    v_add_f32 v20, v20, v34
    s_nop 0
    buffer_load_dwordx4 v233, s[48:51], s61 offen offset:0 sc1 lds
    v_exp_f32 v35, v103
    s_nop 0
    buffer_load_dwordx4 v234, s[48:51], s61 offen offset:1024 sc1 lds
    v_add_f32 v20, v20, v35
    v_cvt_pk_bf16_f32 v211, v34, v35
    s_nop 0
    s_add_u32 m0, s75, 32768
    v_exp_f32 v28, v104
    s_nop 0
    ds_read_b64_tr_b16 a[240:241], v6 offset:17536
    ds_read_b64_tr_b16 a[242:243], v6 offset:21888
    s_add_u32 s60, s64, 65536
    v_add_f32 v18, v18, v22
    v_add_f32 v19, v19, v23
    s_nop 0
    buffer_load_dwordx4 v230, s[40:43], s60 offen offset:0 lds
    v_exp_f32 v29, v105
    s_nop 0
    buffer_load_dwordx4 v245, s[40:43], s60 offen offset:1024 lds
    v_add_f32 v21, v28, v29
    v_cvt_pk_bf16_f32 v212, v28, v29
    s_nop 0
    s_add_u32 m0, s74, 32768
    v_exp_f32 v30, v106
    s_nop 0
    ds_read_b64_tr_b16 a[244:245], v7 offset:17568
    ds_read_b64_tr_b16 a[246:247], v7 offset:21920
    s_add_u32 s61, s65, 2048
    v_add_f32 v21, v21, v30
    s_nop 0
    buffer_load_dwordx4 v233, s[48:51], s61 offen offset:0 sc1 lds
    v_exp_f32 v31, v107
    s_nop 0
    buffer_load_dwordx4 v234, s[48:51], s61 offen offset:1024 sc1 lds
    v_add_f32 v21, v21, v31
    v_cvt_pk_bf16_f32 v213, v30, v31
    s_nop 0
    s_add_u32 m0, s75, 49152
    v_exp_f32 v32, v108
    s_nop 0
    ds_read_b64_tr_b16 a[248:249], v6 offset:17600
    ds_read_b64_tr_b16 a[250:251], v6 offset:21952
    s_add_u32 s60, s64, 98304
    v_add_f32 v21, v21, v32
    s_nop 0
    buffer_load_dwordx4 v230, s[40:43], s60 offen offset:0 lds
    v_exp_f32 v33, v109
    s_nop 0
    buffer_load_dwordx4 v245, s[40:43], s60 offen offset:1024 lds
    v_add_f32 v21, v21, v33
    v_cvt_pk_bf16_f32 v214, v32, v33
    s_nop 0
    s_add_u32 m0, s74, 49152
    v_exp_f32 v34, v110
    s_nop 0
    ds_read_b64_tr_b16 a[252:253], v7 offset:17632
    ds_read_b64_tr_b16 a[254:255], v7 offset:21984
    s_add_u32 s61, s65, 3072
    v_add_f32 v21, v21, v34
    s_nop 0
    buffer_load_dwordx4 v233, s[48:51], s61 offen offset:0 sc1 lds
    v_exp_f32 v35, v111
    s_nop 0
    buffer_load_dwordx4 v234, s[48:51], s61 offen offset:1024 sc1 lds
    v_add_f32 v21, v21, v35
    v_cvt_pk_bf16_f32 v215, v34, v35
    s_waitcnt lgkmcnt(0)
    v_mfma_f32_16x16x32_bf16 a[0:3], a[224:227], v[192:195], a[0:3]
    v_exp_f32 v28, v112
    v_mfma_f32_16x16x32_bf16 a[4:7], a[224:227], v[196:199], a[4:7]
    v_mfma_f32_16x16x32_bf16 a[8:11], a[224:227], v[200:203], a[8:11]
    v_exp_f32 v29, v113
    v_mfma_f32_16x16x32_bf16 a[12:15], a[224:227], v[204:207], a[12:15]
    v_add_f32 v22, v28, v29
    v_cvt_pk_bf16_f32 v216, v28, v29
    v_mfma_f32_16x16x32_bf16 a[16:19], a[228:231], v[192:195], a[16:19]
    v_exp_f32 v30, v114
    v_mfma_f32_16x16x32_bf16 a[20:23], a[228:231], v[196:199], a[20:23]
    v_add_f32 v22, v22, v30
    v_mfma_f32_16x16x32_bf16 a[24:27], a[228:231], v[200:203], a[24:27]
    v_exp_f32 v31, v115
    v_mfma_f32_16x16x32_bf16 a[28:31], a[228:231], v[204:207], a[28:31]
    v_add_f32 v22, v22, v31
    v_cvt_pk_bf16_f32 v217, v30, v31
    v_mfma_f32_16x16x32_bf16 a[32:35], a[232:235], v[192:195], a[32:35]
    v_exp_f32 v32, v116
    v_mfma_f32_16x16x32_bf16 a[36:39], a[232:235], v[196:199], a[36:39]
    v_add_f32 v22, v22, v32
    v_mfma_f32_16x16x32_bf16 a[40:43], a[232:235], v[200:203], a[40:43]
    v_exp_f32 v33, v117
    v_mfma_f32_16x16x32_bf16 a[44:47], a[232:235], v[204:207], a[44:47]
    v_add_f32 v22, v22, v33
    v_cvt_pk_bf16_f32 v218, v32, v33
    v_mfma_f32_16x16x32_bf16 a[48:51], a[236:239], v[192:195], a[48:51]
    v_exp_f32 v34, v118
    v_mfma_f32_16x16x32_bf16 a[52:55], a[236:239], v[196:199], a[52:55]
    v_add_f32 v22, v22, v34
    v_mfma_f32_16x16x32_bf16 a[56:59], a[236:239], v[200:203], a[56:59]
    v_exp_f32 v35, v119
    v_mfma_f32_16x16x32_bf16 a[60:63], a[236:239], v[204:207], a[60:63]
    v_add_f32 v22, v22, v35
    v_cvt_pk_bf16_f32 v219, v34, v35
    v_mfma_f32_16x16x32_bf16 a[64:67], a[240:243], v[192:195], a[64:67]
    v_exp_f32 v28, v120
    v_mfma_f32_16x16x32_bf16 a[68:71], a[240:243], v[196:199], a[68:71]
    v_max3_f32 v24, v20, v21, v22
    v_mfma_f32_16x16x32_bf16 a[72:75], a[240:243], v[200:203], a[72:75]
    v_exp_f32 v29, v121
    v_mfma_f32_16x16x32_bf16 a[76:79], a[240:243], v[204:207], a[76:79]
    v_add_f32 v23, v28, v29
    v_cvt_pk_bf16_f32 v220, v28, v29
    v_mfma_f32_16x16x32_bf16 a[80:83], a[244:247], v[192:195], a[80:83]
    v_exp_f32 v30, v122
    v_mfma_f32_16x16x32_bf16 a[84:87], a[244:247], v[196:199], a[84:87]
    v_add_f32 v23, v23, v30
    v_mfma_f32_16x16x32_bf16 a[88:91], a[244:247], v[200:203], a[88:91]
    v_exp_f32 v31, v123
    v_mfma_f32_16x16x32_bf16 a[92:95], a[244:247], v[204:207], a[92:95]
    v_add_f32 v23, v23, v31
    v_cvt_pk_bf16_f32 v221, v30, v31
    v_mfma_f32_16x16x32_bf16 a[96:99], a[248:251], v[192:195], a[96:99]
    v_exp_f32 v32, v124
    v_mfma_f32_16x16x32_bf16 a[100:103], a[248:251], v[196:199], a[100:103]
    v_add_f32 v23, v23, v32
    v_mfma_f32_16x16x32_bf16 a[104:107], a[248:251], v[200:203], a[104:107]
    v_exp_f32 v33, v125
    v_mfma_f32_16x16x32_bf16 a[108:111], a[248:251], v[204:207], a[108:111]
    v_add_f32 v23, v23, v33
    v_cvt_pk_bf16_f32 v222, v32, v33
    v_mfma_f32_16x16x32_bf16 a[112:115], a[252:255], v[192:195], a[112:115]
    v_exp_f32 v34, v126
    v_mfma_f32_16x16x32_bf16 a[116:119], a[252:255], v[196:199], a[116:119]
    v_add_f32 v23, v23, v34
    v_mfma_f32_16x16x32_bf16 a[120:123], a[252:255], v[200:203], a[120:123]
    v_exp_f32 v35, v127
    v_mfma_f32_16x16x32_bf16 a[124:127], a[252:255], v[204:207], a[124:127]
    v_add_f32 v23, v23, v35
    v_cvt_pk_bf16_f32 v223, v34, v35
    v_max_f32 v24, v24, v23
    v_cmp_lt_f32 vcc, s25, v24
    s_cbranch_vccnz rare_stub_31
rare_back_32:
    s_nop 0
    ds_read_b64_tr_b16 a[224:225], v6 offset:26112
    ds_read_b64_tr_b16 a[226:227], v6 offset:30464
    v_add_f32 v16, v16, v20
    v_add_f32 v17, v17, v21
    v_add_f32 v18, v18, v22
    v_add_f32 v19, v19, v23
    s_nop 0
    ds_read_b64_tr_b16 a[228:229], v7 offset:26144
    ds_read_b64_tr_b16 a[230:231], v7 offset:30496
    s_nop 0
    ds_read_b64_tr_b16 a[232:233], v6 offset:26176
    ds_read_b64_tr_b16 a[234:235], v6 offset:30528
    s_nop 0
    ds_read_b64_tr_b16 a[236:237], v7 offset:26208
    ds_read_b64_tr_b16 a[238:239], v7 offset:30560
    s_nop 0
    ds_read_b64_tr_b16 a[240:241], v6 offset:26240
    ds_read_b64_tr_b16 a[242:243], v6 offset:30592
    s_nop 0
    ds_read_b64_tr_b16 a[244:245], v7 offset:26272
    ds_read_b64_tr_b16 a[246:247], v7 offset:30624
    s_nop 0
    ds_read_b64_tr_b16 a[248:249], v6 offset:26304
    ds_read_b64_tr_b16 a[250:251], v6 offset:30656
    s_nop 0
    ds_read_b64_tr_b16 a[252:253], v7 offset:26336
    ds_read_b64_tr_b16 a[254:255], v7 offset:30688
    s_nop 0
    s_waitcnt lgkmcnt(0)
    v_mfma_f32_16x16x32_bf16 a[0:3], a[224:227], v[208:211], a[0:3]
    v_mfma_f32_16x16x32_bf16 a[4:7], a[224:227], v[212:215], a[4:7]
    v_mfma_f32_16x16x32_bf16 a[8:11], a[224:227], v[216:219], a[8:11]
    v_mfma_f32_16x16x32_bf16 a[12:15], a[224:227], v[220:223], a[12:15]
    v_mfma_f32_16x16x32_bf16 a[16:19], a[228:231], v[208:211], a[16:19]
    v_mfma_f32_16x16x32_bf16 a[20:23], a[228:231], v[212:215], a[20:23]
    v_mfma_f32_16x16x32_bf16 a[24:27], a[228:231], v[216:219], a[24:27]
    v_mfma_f32_16x16x32_bf16 a[28:31], a[228:231], v[220:223], a[28:31]
    v_mfma_f32_16x16x32_bf16 a[32:35], a[232:235], v[208:211], a[32:35]
    v_mfma_f32_16x16x32_bf16 a[36:39], a[232:235], v[212:215], a[36:39]
    v_mfma_f32_16x16x32_bf16 a[40:43], a[232:235], v[216:219], a[40:43]
    v_mfma_f32_16x16x32_bf16 a[44:47], a[232:235], v[220:223], a[44:47]
    v_mfma_f32_16x16x32_bf16 a[48:51], a[236:239], v[208:211], a[48:51]
    v_mfma_f32_16x16x32_bf16 a[52:55], a[236:239], v[212:215], a[52:55]
    v_mfma_f32_16x16x32_bf16 a[56:59], a[236:239], v[216:219], a[56:59]
    v_mfma_f32_16x16x32_bf16 a[60:63], a[236:239], v[220:223], a[60:63]
    v_mfma_f32_16x16x32_bf16 a[64:67], a[240:243], v[208:211], a[64:67]
    v_mfma_f32_16x16x32_bf16 a[68:71], a[240:243], v[212:215], a[68:71]
    v_mfma_f32_16x16x32_bf16 a[72:75], a[240:243], v[216:219], a[72:75]
    v_mfma_f32_16x16x32_bf16 a[76:79], a[240:243], v[220:223], a[76:79]
    v_mfma_f32_16x16x32_bf16 a[80:83], a[244:247], v[208:211], a[80:83]
    v_mfma_f32_16x16x32_bf16 a[84:87], a[244:247], v[212:215], a[84:87]
    v_mfma_f32_16x16x32_bf16 a[88:91], a[244:247], v[216:219], a[88:91]
    v_mfma_f32_16x16x32_bf16 a[92:95], a[244:247], v[220:223], a[92:95]
    v_mfma_f32_16x16x32_bf16 a[96:99], a[248:251], v[208:211], a[96:99]
    v_mfma_f32_16x16x32_bf16 a[100:103], a[248:251], v[212:215], a[100:103]
    v_mfma_f32_16x16x32_bf16 a[104:107], a[248:251], v[216:219], a[104:107]
    v_mfma_f32_16x16x32_bf16 a[108:111], a[248:251], v[220:223], a[108:111]
    v_mfma_f32_16x16x32_bf16 a[112:115], a[252:255], v[208:211], a[112:115]
    v_mfma_f32_16x16x32_bf16 a[116:119], a[252:255], v[212:215], a[116:119]
    v_mfma_f32_16x16x32_bf16 a[120:123], a[252:255], v[216:219], a[120:123]
    v_mfma_f32_16x16x32_bf16 a[124:127], a[252:255], v[220:223], a[124:127]
    s_barrier
    s_nop 7
    v_mov_b32 v224, v16
    s_nop 1
    v_permlane16_swap_b32 v16, v224
    s_nop 1
    v_add_f32 v16, v16, v224
    v_mov_b32 v224, v16
    s_nop 1
    v_permlane32_swap_b32 v16, v224
    s_nop 1
    v_add_f32 v16, v16, v224
    v_rcp_f32 v16, v16
    v_mov_b32 v224, v17
    s_nop 1
    v_permlane16_swap_b32 v17, v224
    s_nop 1
    v_add_f32 v17, v17, v224
    v_mov_b32 v224, v17
    s_nop 1
    v_permlane32_swap_b32 v17, v224
    s_nop 1
    v_add_f32 v17, v17, v224
    v_rcp_f32 v17, v17
    v_mov_b32 v224, v18
    s_nop 1
    v_permlane16_swap_b32 v18, v224
    s_nop 1
    v_add_f32 v18, v18, v224
    v_mov_b32 v224, v18
    s_nop 1
    v_permlane32_swap_b32 v18, v224
    s_nop 1
    v_add_f32 v18, v18, v224
    v_rcp_f32 v18, v18
    v_mov_b32 v224, v19
    s_nop 1
    v_permlane16_swap_b32 v19, v224
    s_nop 1
    v_add_f32 v19, v19, v224
    v_mov_b32 v224, v19
    s_nop 1
    v_permlane32_swap_b32 v19, v224
    s_nop 1
    v_add_f32 v19, v19, v224
    v_rcp_f32 v19, v19
    s_lshl_b32 s26, s35, 7
    s_lshl_b32 s27, s33, 2
    s_add_u32 s26, s26, s27
    s_lshl_b32 s26, s26, 10
    s_add_u32 s27, s26, 0
    v_accvgpr_read_b32 v64, a0
    v_accvgpr_read_b32 v68, a16
    v_accvgpr_read_b32 v65, a1
    v_accvgpr_read_b32 v69, a17
    v_accvgpr_read_b32 v66, a2
    v_accvgpr_read_b32 v70, a18
    v_accvgpr_read_b32 v67, a3
    v_accvgpr_read_b32 v71, a19
    v_mul_f32 v64, v64, v16
    v_mul_f32 v65, v65, v16
    v_mul_f32 v66, v66, v16
    v_mul_f32 v67, v67, v16
    v_mul_f32 v68, v68, v16
    v_mul_f32 v69, v69, v16
    v_mul_f32 v70, v70, v16
    v_mul_f32 v71, v71, v16
    v_cvt_pk_bf16_f32 v72, v64, v65
    v_cvt_pk_bf16_f32 v73, v66, v67
    v_cvt_pk_bf16_f32 v74, v68, v69
    v_cvt_pk_bf16_f32 v75, v70, v71
    buffer_store_dwordx4 v[72:75], v26, s[16:19], s27 offen offset:0 sc1
    v_accvgpr_read_b32 v76, a32
    v_accvgpr_read_b32 v80, a48
    v_accvgpr_read_b32 v77, a33
    v_accvgpr_read_b32 v81, a49
    v_accvgpr_read_b32 v78, a34
    v_accvgpr_read_b32 v82, a50
    v_accvgpr_read_b32 v79, a35
    v_accvgpr_read_b32 v83, a51
    v_mul_f32 v76, v76, v16
    v_mul_f32 v77, v77, v16
    v_mul_f32 v78, v78, v16
    v_mul_f32 v79, v79, v16
    v_mul_f32 v80, v80, v16
    v_mul_f32 v81, v81, v16
    v_mul_f32 v82, v82, v16
    v_mul_f32 v83, v83, v16
    v_cvt_pk_bf16_f32 v84, v76, v77
    v_cvt_pk_bf16_f32 v85, v78, v79
    v_cvt_pk_bf16_f32 v86, v80, v81
    v_cvt_pk_bf16_f32 v87, v82, v83
    buffer_store_dwordx4 v[84:87], v26, s[16:19], s27 offen offset:1024 sc1
    v_accvgpr_read_b32 v88, a64
    v_accvgpr_read_b32 v92, a80
    v_accvgpr_read_b32 v89, a65
    v_accvgpr_read_b32 v93, a81
    v_accvgpr_read_b32 v90, a66
    v_accvgpr_read_b32 v94, a82
    v_accvgpr_read_b32 v91, a67
    v_accvgpr_read_b32 v95, a83
    v_mul_f32 v88, v88, v16
    v_mul_f32 v89, v89, v16
    v_mul_f32 v90, v90, v16
    v_mul_f32 v91, v91, v16
    v_mul_f32 v92, v92, v16
    v_mul_f32 v93, v93, v16
    v_mul_f32 v94, v94, v16
    v_mul_f32 v95, v95, v16
    v_cvt_pk_bf16_f32 v96, v88, v89
    v_cvt_pk_bf16_f32 v97, v90, v91
    v_cvt_pk_bf16_f32 v98, v92, v93
    v_cvt_pk_bf16_f32 v99, v94, v95
    buffer_store_dwordx4 v[96:99], v26, s[16:19], s27 offen offset:2048 sc1
    v_accvgpr_read_b32 v100, a96
    v_accvgpr_read_b32 v104, a112
    v_accvgpr_read_b32 v101, a97
    v_accvgpr_read_b32 v105, a113
    v_accvgpr_read_b32 v102, a98
    v_accvgpr_read_b32 v106, a114
    v_accvgpr_read_b32 v103, a99
    v_accvgpr_read_b32 v107, a115
    v_mul_f32 v100, v100, v16
    v_mul_f32 v101, v101, v16
    v_mul_f32 v102, v102, v16
    v_mul_f32 v103, v103, v16
    v_mul_f32 v104, v104, v16
    v_mul_f32 v105, v105, v16
    v_mul_f32 v106, v106, v16
    v_mul_f32 v107, v107, v16
    v_cvt_pk_bf16_f32 v108, v100, v101
    v_cvt_pk_bf16_f32 v109, v102, v103
    v_cvt_pk_bf16_f32 v110, v104, v105
    v_cvt_pk_bf16_f32 v111, v106, v107
    buffer_store_dwordx4 v[108:111], v26, s[16:19], s27 offen offset:3072 sc1
    s_add_u32 s27, s26, 131072
    v_accvgpr_read_b32 v112, a4
    v_accvgpr_read_b32 v116, a20
    v_accvgpr_read_b32 v113, a5
    v_accvgpr_read_b32 v117, a21
    v_accvgpr_read_b32 v114, a6
    v_accvgpr_read_b32 v118, a22
    v_accvgpr_read_b32 v115, a7
    v_accvgpr_read_b32 v119, a23
    v_mul_f32 v112, v112, v17
    v_mul_f32 v113, v113, v17
    v_mul_f32 v114, v114, v17
    v_mul_f32 v115, v115, v17
    v_mul_f32 v116, v116, v17
    v_mul_f32 v117, v117, v17
    v_mul_f32 v118, v118, v17
    v_mul_f32 v119, v119, v17
    v_cvt_pk_bf16_f32 v120, v112, v113
    v_cvt_pk_bf16_f32 v121, v114, v115
    v_cvt_pk_bf16_f32 v122, v116, v117
    v_cvt_pk_bf16_f32 v123, v118, v119
    buffer_store_dwordx4 v[120:123], v26, s[16:19], s27 offen offset:0 sc1
    v_accvgpr_read_b32 v124, a36
    v_accvgpr_read_b32 v128, a52
    v_accvgpr_read_b32 v125, a37
    v_accvgpr_read_b32 v129, a53
    v_accvgpr_read_b32 v126, a38
    v_accvgpr_read_b32 v130, a54
    v_accvgpr_read_b32 v127, a39
    v_accvgpr_read_b32 v131, a55
    v_mul_f32 v124, v124, v17
    v_mul_f32 v125, v125, v17
    v_mul_f32 v126, v126, v17
    v_mul_f32 v127, v127, v17
    v_mul_f32 v128, v128, v17
    v_mul_f32 v129, v129, v17
    v_mul_f32 v130, v130, v17
    v_mul_f32 v131, v131, v17
    v_cvt_pk_bf16_f32 v132, v124, v125
    v_cvt_pk_bf16_f32 v133, v126, v127
    v_cvt_pk_bf16_f32 v134, v128, v129
    v_cvt_pk_bf16_f32 v135, v130, v131
    buffer_store_dwordx4 v[132:135], v26, s[16:19], s27 offen offset:1024 sc1
    v_accvgpr_read_b32 v136, a68
    v_accvgpr_read_b32 v140, a84
    v_accvgpr_read_b32 v137, a69
    v_accvgpr_read_b32 v141, a85
    v_accvgpr_read_b32 v138, a70
    v_accvgpr_read_b32 v142, a86
    v_accvgpr_read_b32 v139, a71
    v_accvgpr_read_b32 v143, a87
    v_mul_f32 v136, v136, v17
    v_mul_f32 v137, v137, v17
    v_mul_f32 v138, v138, v17
    v_mul_f32 v139, v139, v17
    v_mul_f32 v140, v140, v17
    v_mul_f32 v141, v141, v17
    v_mul_f32 v142, v142, v17
    v_mul_f32 v143, v143, v17
    v_cvt_pk_bf16_f32 v144, v136, v137
    v_cvt_pk_bf16_f32 v145, v138, v139
    v_cvt_pk_bf16_f32 v146, v140, v141
    v_cvt_pk_bf16_f32 v147, v142, v143
    buffer_store_dwordx4 v[144:147], v26, s[16:19], s27 offen offset:2048 sc1
    v_accvgpr_read_b32 v148, a100
    v_accvgpr_read_b32 v152, a116
    v_accvgpr_read_b32 v149, a101
    v_accvgpr_read_b32 v153, a117
    v_accvgpr_read_b32 v150, a102
    v_accvgpr_read_b32 v154, a118
    v_accvgpr_read_b32 v151, a103
    v_accvgpr_read_b32 v155, a119
    v_mul_f32 v148, v148, v17
    v_mul_f32 v149, v149, v17
    v_mul_f32 v150, v150, v17
    v_mul_f32 v151, v151, v17
    v_mul_f32 v152, v152, v17
    v_mul_f32 v153, v153, v17
    v_mul_f32 v154, v154, v17
    v_mul_f32 v155, v155, v17
    v_cvt_pk_bf16_f32 v156, v148, v149
    v_cvt_pk_bf16_f32 v157, v150, v151
    v_cvt_pk_bf16_f32 v158, v152, v153
    v_cvt_pk_bf16_f32 v159, v154, v155
    buffer_store_dwordx4 v[156:159], v26, s[16:19], s27 offen offset:3072 sc1
    s_add_u32 s27, s26, 262144
    v_accvgpr_read_b32 v64, a8
    v_accvgpr_read_b32 v68, a24
    v_accvgpr_read_b32 v65, a9
    v_accvgpr_read_b32 v69, a25
    v_accvgpr_read_b32 v66, a10
    v_accvgpr_read_b32 v70, a26
    v_accvgpr_read_b32 v67, a11
    v_accvgpr_read_b32 v71, a27
    v_mul_f32 v64, v64, v18
    v_mul_f32 v65, v65, v18
    v_mul_f32 v66, v66, v18
    v_mul_f32 v67, v67, v18
    v_mul_f32 v68, v68, v18
    v_mul_f32 v69, v69, v18
    v_mul_f32 v70, v70, v18
    v_mul_f32 v71, v71, v18
    v_cvt_pk_bf16_f32 v72, v64, v65
    v_cvt_pk_bf16_f32 v73, v66, v67
    v_cvt_pk_bf16_f32 v74, v68, v69
    v_cvt_pk_bf16_f32 v75, v70, v71
    buffer_store_dwordx4 v[72:75], v26, s[16:19], s27 offen offset:0 sc1
    v_accvgpr_read_b32 v76, a40
    v_accvgpr_read_b32 v80, a56
    v_accvgpr_read_b32 v77, a41
    v_accvgpr_read_b32 v81, a57
    v_accvgpr_read_b32 v78, a42
    v_accvgpr_read_b32 v82, a58
    v_accvgpr_read_b32 v79, a43
    v_accvgpr_read_b32 v83, a59
    v_mul_f32 v76, v76, v18
    v_mul_f32 v77, v77, v18
    v_mul_f32 v78, v78, v18
    v_mul_f32 v79, v79, v18
    v_mul_f32 v80, v80, v18
    v_mul_f32 v81, v81, v18
    v_mul_f32 v82, v82, v18
    v_mul_f32 v83, v83, v18
    v_cvt_pk_bf16_f32 v84, v76, v77
    v_cvt_pk_bf16_f32 v85, v78, v79
    v_cvt_pk_bf16_f32 v86, v80, v81
    v_cvt_pk_bf16_f32 v87, v82, v83
    buffer_store_dwordx4 v[84:87], v26, s[16:19], s27 offen offset:1024 sc1
    v_accvgpr_read_b32 v88, a72
    v_accvgpr_read_b32 v92, a88
    v_accvgpr_read_b32 v89, a73
    v_accvgpr_read_b32 v93, a89
    v_accvgpr_read_b32 v90, a74
    v_accvgpr_read_b32 v94, a90
    v_accvgpr_read_b32 v91, a75
    v_accvgpr_read_b32 v95, a91
    v_mul_f32 v88, v88, v18
    v_mul_f32 v89, v89, v18
    v_mul_f32 v90, v90, v18
    v_mul_f32 v91, v91, v18
    v_mul_f32 v92, v92, v18
    v_mul_f32 v93, v93, v18
    v_mul_f32 v94, v94, v18
    v_mul_f32 v95, v95, v18
    v_cvt_pk_bf16_f32 v96, v88, v89
    v_cvt_pk_bf16_f32 v97, v90, v91
    v_cvt_pk_bf16_f32 v98, v92, v93
    v_cvt_pk_bf16_f32 v99, v94, v95
    buffer_store_dwordx4 v[96:99], v26, s[16:19], s27 offen offset:2048 sc1
    v_accvgpr_read_b32 v100, a104
    v_accvgpr_read_b32 v104, a120
    v_accvgpr_read_b32 v101, a105
    v_accvgpr_read_b32 v105, a121
    v_accvgpr_read_b32 v102, a106
    v_accvgpr_read_b32 v106, a122
    v_accvgpr_read_b32 v103, a107
    v_accvgpr_read_b32 v107, a123
    v_mul_f32 v100, v100, v18
    v_mul_f32 v101, v101, v18
    v_mul_f32 v102, v102, v18
    v_mul_f32 v103, v103, v18
    v_mul_f32 v104, v104, v18
    v_mul_f32 v105, v105, v18
    v_mul_f32 v106, v106, v18
    v_mul_f32 v107, v107, v18
    v_cvt_pk_bf16_f32 v108, v100, v101
    v_cvt_pk_bf16_f32 v109, v102, v103
    v_cvt_pk_bf16_f32 v110, v104, v105
    v_cvt_pk_bf16_f32 v111, v106, v107
    buffer_store_dwordx4 v[108:111], v26, s[16:19], s27 offen offset:3072 sc1
    s_add_u32 s27, s26, 393216
    v_accvgpr_read_b32 v112, a12
    v_accvgpr_read_b32 v116, a28
    v_accvgpr_read_b32 v113, a13
    v_accvgpr_read_b32 v117, a29
    v_accvgpr_read_b32 v114, a14
    v_accvgpr_read_b32 v118, a30
    v_accvgpr_read_b32 v115, a15
    v_accvgpr_read_b32 v119, a31
    v_mul_f32 v112, v112, v19
    v_mul_f32 v113, v113, v19
    v_mul_f32 v114, v114, v19
    v_mul_f32 v115, v115, v19
    v_mul_f32 v116, v116, v19
    v_mul_f32 v117, v117, v19
    v_mul_f32 v118, v118, v19
    v_mul_f32 v119, v119, v19
    v_cvt_pk_bf16_f32 v120, v112, v113
    v_cvt_pk_bf16_f32 v121, v114, v115
    v_cvt_pk_bf16_f32 v122, v116, v117
    v_cvt_pk_bf16_f32 v123, v118, v119
    buffer_store_dwordx4 v[120:123], v26, s[16:19], s27 offen offset:0 sc1
    v_accvgpr_read_b32 v124, a44
    v_accvgpr_read_b32 v128, a60
    v_accvgpr_read_b32 v125, a45
    v_accvgpr_read_b32 v129, a61
    v_accvgpr_read_b32 v126, a46
    v_accvgpr_read_b32 v130, a62
    v_accvgpr_read_b32 v127, a47
    v_accvgpr_read_b32 v131, a63
    v_mul_f32 v124, v124, v19
    v_mul_f32 v125, v125, v19
    v_mul_f32 v126, v126, v19
    v_mul_f32 v127, v127, v19
    v_mul_f32 v128, v128, v19
    v_mul_f32 v129, v129, v19
    v_mul_f32 v130, v130, v19
    v_mul_f32 v131, v131, v19
    v_cvt_pk_bf16_f32 v132, v124, v125
    v_cvt_pk_bf16_f32 v133, v126, v127
    v_cvt_pk_bf16_f32 v134, v128, v129
    v_cvt_pk_bf16_f32 v135, v130, v131
    buffer_store_dwordx4 v[132:135], v26, s[16:19], s27 offen offset:1024 sc1
    v_accvgpr_read_b32 v136, a76
    v_accvgpr_read_b32 v140, a92
    v_accvgpr_read_b32 v137, a77
    v_accvgpr_read_b32 v141, a93
    v_accvgpr_read_b32 v138, a78
    v_accvgpr_read_b32 v142, a94
    v_accvgpr_read_b32 v139, a79
    v_accvgpr_read_b32 v143, a95
    v_mul_f32 v136, v136, v19
    v_mul_f32 v137, v137, v19
    v_mul_f32 v138, v138, v19
    v_mul_f32 v139, v139, v19
    v_mul_f32 v140, v140, v19
    v_mul_f32 v141, v141, v19
    v_mul_f32 v142, v142, v19
    v_mul_f32 v143, v143, v19
    v_cvt_pk_bf16_f32 v144, v136, v137
    v_cvt_pk_bf16_f32 v145, v138, v139
    v_cvt_pk_bf16_f32 v146, v140, v141
    v_cvt_pk_bf16_f32 v147, v142, v143
    buffer_store_dwordx4 v[144:147], v26, s[16:19], s27 offen offset:2048 sc1
    v_accvgpr_read_b32 v148, a108
    v_accvgpr_read_b32 v152, a124
    v_accvgpr_read_b32 v149, a109
    v_accvgpr_read_b32 v153, a125
    v_accvgpr_read_b32 v150, a110
    v_accvgpr_read_b32 v154, a126
    v_accvgpr_read_b32 v151, a111
    v_accvgpr_read_b32 v155, a127
    v_mul_f32 v148, v148, v19
    v_mul_f32 v149, v149, v19
    v_mul_f32 v150, v150, v19
    v_mul_f32 v151, v151, v19
    v_mul_f32 v152, v152, v19
    v_mul_f32 v153, v153, v19
    v_mul_f32 v154, v154, v19
    v_mul_f32 v155, v155, v19
    v_cvt_pk_bf16_f32 v156, v148, v149
    v_cvt_pk_bf16_f32 v157, v150, v151
    v_cvt_pk_bf16_f32 v158, v152, v153
    v_cvt_pk_bf16_f32 v159, v154, v155
    buffer_store_dwordx4 v[156:159], v26, s[16:19], s27 offen offset:3072 sc1
    s_load_dwordx2 s[4:5], s[0:1], 0
    s_load_dwordx2 s[10:11], s[0:1], 64
    s_load_dwordx2 s[6:7], s[0:1], 32
    s_mov_b32 s30, s38
    s_mov_b32 s31, s39
    s_mov_b32 s67, s63
    v_lshrrev_b32 v40, 4, v1
    v_and_b32 v41, 15, v1
    v_lshrrev_b32 v42, 2, v41
    v_and_b32 v43, 3, v1
    v_lshlrev_b32 v47, 4, v1
    v_lshl_add_u32 v44, v40, 2, v42
    v_bfe_u32 v45, v44, 1, 2
    v_lshlrev_b32 v44, 7, v44
    v_lshl_add_u32 v44, v43, 3, v44
    s_lshl_b32 s26, s72, 12
    s_add_u32 s26, s26, 8192
    v_add_u32 v44, s26, v44
    v_xor_b32 v46, 0, v45
    v_lshl_add_u32 v8, v46, 5, v44
    v_add_u32 v12, 0x10000, v8
    v_add_u32 v16, 0x20000, v8
    v_xor_b32 v46, 1, v45
    v_lshl_add_u32 v9, v46, 5, v44
    v_add_u32 v13, 0x10000, v9
    v_add_u32 v17, 0x20000, v9
    v_xor_b32 v46, 2, v45
    v_lshl_add_u32 v10, v46, 5, v44
    v_add_u32 v14, 0x10000, v10
    v_add_u32 v18, 0x20000, v10
    v_xor_b32 v46, 3, v45
    v_lshl_add_u32 v11, v46, 5, v44
    v_add_u32 v15, 0x10000, v11
    v_add_u32 v19, 0x20000, v11
    s_add_u32 s26, s68, 0
    s_and_b32 s26, s26, 3
    s_lshl_b32 s27, s71, 2
    s_add_u32 s26, s26, s27
    s_lshl_b32 s26, s26, 10
    v_add_u32 v20, s26, v47
    v_add_u32 v24, 0x10000, v20
    v_add_u32 v28, 0x20000, v20
    s_add_u32 s26, s68, 1
    s_and_b32 s26, s26, 3
    s_lshl_b32 s27, s71, 2
    s_add_u32 s26, s26, s27
    s_lshl_b32 s26, s26, 10
    v_add_u32 v21, s26, v47
    v_add_u32 v25, 0x10000, v21
    v_add_u32 v29, 0x20000, v21
    s_add_u32 s26, s68, 2
    s_and_b32 s26, s26, 3
    s_lshl_b32 s27, s71, 2
    s_add_u32 s26, s26, s27
    s_lshl_b32 s26, s26, 10
    v_add_u32 v22, s26, v47
    v_add_u32 v26, 0x10000, v22
    v_add_u32 v30, 0x20000, v22
    s_add_u32 s26, s68, 3
    s_and_b32 s26, s26, 3
    s_lshl_b32 s27, s71, 2
    s_add_u32 s26, s26, s27
    s_lshl_b32 s26, s26, 10
    v_add_u32 v23, s26, v47
    v_add_u32 v27, 0x10000, v23
    v_add_u32 v31, 0x20000, v23
    s_waitcnt lgkmcnt(0)
    s_mov_b32 s36, s6
    s_mov_b32 s37, s7
    s_mov_b32 s38, 4194304
    s_mov_b32 s39, 0x20000
    s_add_u32 s44, s28, 10485760
    s_addc_u32 s45, s29, 0
    s_mov_b32 s46, 16777216
    s_mov_b32 s47, 0x20000
    s_mov_b32 s52, s4
    s_mov_b32 s53, s5
    s_mov_b32 s54, 2097152
    s_mov_b32 s55, 0x20000
    s_mov_b32 s56, s10
    s_mov_b32 s57, s11
    s_mov_b32 s58, 2097152
    s_mov_b32 s59, 0x20000
    s_add_u32 s76, s28, 75497472
    s_addc_u32 s77, s29, 0
    s_mov_b32 s78, 25165824
    s_mov_b32 s79, 0x20000
    s_lshl_b32 s62, s68, 10
    s_lshl_b32 s27, s72, 4
    s_add_u32 s62, s62, s27
    s_lshl_b32 s62, s62, 10
    s_lshl_b32 s26, s70, 1
    s_add_u32 s26, s26, s71
    s_lshl_b32 s26, s26, 7
    s_add_u32 s62, s62, s26
    s_lshl_b32 s63, s73, 7
    s_lshl_b32 s27, s68, 5
    s_add_u32 s63, s63, s27
    s_lshl_b32 s63, s63, 10
    v_lshlrev_b32 v32, 4, v1
    s_lshl_b32 s26, s34, 3
    s_and_b32 s27, s33, 7
    s_add_u32 s26, s26, s27
    s_lshl_b32 s6, s26, 2
    s_add_u32 s26, s68, 1
    s_and_b32 s26, s26, 3
    s_add_u32 s26, s26, s6
    s_mul_i32 s26, s26, 3
    s_add_u32 s26, s26, 0
    s_lshl_b32 s26, s26, 2
    s_add_u32 s26, s26, s32
    s_lshl_b32 s7, s26, 13
    s_add_u32 s26, s68, 2
    s_and_b32 s26, s26, 3
    s_add_u32 s26, s26, s6
    s_mul_i32 s26, s26, 3
    s_add_u32 s26, s26, 1
    s_lshl_b32 s26, s26, 2
    s_add_u32 s26, s26, s32
    s_lshl_b32 s8, s26, 13
    s_add_u32 s26, s68, 3
    s_and_b32 s26, s26, 3
    s_add_u32 s26, s26, s6
    s_mul_i32 s26, s26, 3
    s_add_u32 s26, s26, 2
    s_lshl_b32 s26, s26, 2
    s_add_u32 s26, s26, s32
    s_lshl_b32 s9, s26, 13
    s_add_u32 s26, s6, s68
    s_mul_i32 s26, s26, 12
    s_add_u32 s26, s26, s32
    s_lshl_b32 s12, s26, 13
    s_and_b32 s26, s33, 7
    s_lshl_b32 s13, 0x01010101, s26
    s_add_u32 s17, s7, 4096
    s_add_u32 s18, s8, 4096
    s_add_u32 s19, s9, 4096
    s_add_u32 s20, s12, 4096
    s_add_u32 s21, s12, 36864
    s_add_u32 s22, s12, 69632
    v_and_b32 v246, 31, v1
    v_lshlrev_b32 v246, 2, v246
    s_waitcnt vmcnt(24)
    s_barrier
    ds_read_b128 a[0:3], v20 offset:0
    ds_read_b128 a[4:7], v21 offset:0
    ds_read_b128 a[8:11], v22 offset:0
    ds_read_b128 a[12:15], v23 offset:0
    ds_read_b64_tr_b16 a[32:33], v8 offset:0
    ds_read_b64_tr_b16 a[34:35], v8 offset:2048
    ds_read_b64_tr_b16 a[36:37], v9 offset:0
    ds_read_b64_tr_b16 a[38:39], v9 offset:2048
    ds_read_b64_tr_b16 a[40:41], v10 offset:0
    ds_read_b64_tr_b16 a[42:43], v10 offset:2048
    ds_read_b64_tr_b16 a[44:45], v11 offset:0
    ds_read_b64_tr_b16 a[46:47], v11 offset:2048
    s_waitcnt vmcnt(20) lgkmcnt(0)
    s_barrier
    v_mfma_f32_16x16x32_bf16 v[128:131], a[32:35], a[0:3], 0
    ds_read_b128 a[16:19], v20 offset:16384
    s_add_u32 m0, s75, 65536
    s_add_u32 s60, s64, 131072
    v_mfma_f32_16x16x32_bf16 v[132:135], a[32:35], a[4:7], 0
    ds_read_b128 a[20:23], v21 offset:16384
    buffer_load_dwordx4 v230, s[40:43], s60 offen offset:0 lds
    v_mfma_f32_16x16x32_bf16 v[136:139], a[32:35], a[8:11], 0
    ds_read_b128 a[24:27], v22 offset:16384
    buffer_load_dwordx4 v245, s[40:43], s60 offen offset:1024 lds
    s_add_u32 m0, s74, 65536
    v_mfma_f32_16x16x32_bf16 v[140:143], a[32:35], a[12:15], 0
    ds_read_b128 a[28:31], v23 offset:16384
    s_add_u32 s61, s65, 4096
    v_mfma_f32_16x16x32_bf16 v[144:147], a[36:39], a[0:3], 0
    ds_read_b64_tr_b16 a[48:49], v8 offset:16384
    buffer_load_dwordx4 v233, s[48:51], s61 offen offset:0 sc1 lds
    buffer_load_dwordx4 v234, s[48:51], s61 offen offset:1024 sc1 lds
    v_mfma_f32_16x16x32_bf16 v[148:151], a[36:39], a[4:7], 0
    ds_read_b64_tr_b16 a[50:51], v8 offset:18432
    s_add_u32 m0, s75, 81920
    v_mfma_f32_16x16x32_bf16 v[152:155], a[36:39], a[8:11], 0
    ds_read_b64_tr_b16 a[52:53], v9 offset:16384
    s_add_u32 s60, s64, 163840
    buffer_load_dwordx4 v230, s[40:43], s60 offen offset:0 lds
    v_mfma_f32_16x16x32_bf16 v[156:159], a[36:39], a[12:15], 0
    ds_read_b64_tr_b16 a[54:55], v9 offset:18432
    buffer_load_dwordx4 v245, s[40:43], s60 offen offset:1024 lds
    v_mfma_f32_16x16x32_bf16 v[160:163], a[40:43], a[0:3], 0
    ds_read_b64_tr_b16 a[56:57], v10 offset:16384
    s_add_u32 m0, s74, 81920
    s_add_u32 s61, s65, 5120
    v_mfma_f32_16x16x32_bf16 v[164:167], a[40:43], a[4:7], 0
    ds_read_b64_tr_b16 a[58:59], v10 offset:18432
    buffer_load_dwordx4 v233, s[48:51], s61 offen offset:0 sc1 lds
    v_mfma_f32_16x16x32_bf16 v[168:171], a[40:43], a[8:11], 0
    ds_read_b64_tr_b16 a[60:61], v11 offset:16384
    buffer_load_dwordx4 v234, s[48:51], s61 offen offset:1024 sc1 lds
    s_add_u32 m0, s75, 98304
    v_mfma_f32_16x16x32_bf16 v[172:175], a[40:43], a[12:15], 0
    ds_read_b64_tr_b16 a[62:63], v11 offset:18432
    s_add_u32 s60, s64, 196608
    v_mfma_f32_16x16x32_bf16 v[176:179], a[44:47], a[0:3], 0
    buffer_load_dwordx4 v230, s[40:43], s60 offen offset:0 lds
    buffer_load_dwordx4 v245, s[40:43], s60 offen offset:1024 lds
    v_mfma_f32_16x16x32_bf16 v[180:183], a[44:47], a[4:7], 0
    s_add_u32 m0, s74, 98304
    v_mfma_f32_16x16x32_bf16 v[184:187], a[44:47], a[8:11], 0
    s_add_u32 s61, s65, 6144
    buffer_load_dwordx4 v233, s[48:51], s61 offen offset:0 sc1 lds
    v_mfma_f32_16x16x32_bf16 v[188:191], a[44:47], a[12:15], 0
    buffer_load_dwordx4 v234, s[48:51], s61 offen offset:1024 sc1 lds
    s_waitcnt lgkmcnt(0)
    v_mfma_f32_16x16x32_bf16 v[128:131], a[48:51], a[16:19], v[128:131]
    ds_read_b128 a[0:3], v20 offset:32768
    s_add_u32 m0, s75, 114688
    v_mfma_f32_16x16x32_bf16 v[132:135], a[48:51], a[20:23], v[132:135]
    ds_read_b128 a[4:7], v21 offset:32768
    s_add_u32 s60, s64, 229376
    v_mfma_f32_16x16x32_bf16 v[136:139], a[48:51], a[24:27], v[136:139]
    ds_read_b128 a[8:11], v22 offset:32768
    buffer_load_dwordx4 v230, s[40:43], s60 offen offset:0 lds
    v_mfma_f32_16x16x32_bf16 v[140:143], a[48:51], a[28:31], v[140:143]
    ds_read_b128 a[12:15], v23 offset:32768
    buffer_load_dwordx4 v245, s[40:43], s60 offen offset:1024 lds
    v_mfma_f32_16x16x32_bf16 v[144:147], a[52:55], a[16:19], v[144:147]
    ds_read_b64_tr_b16 a[32:33], v8 offset:32768
    s_add_u32 m0, s74, 114688
    v_mfma_f32_16x16x32_bf16 v[148:151], a[52:55], a[20:23], v[148:151]
    ds_read_b64_tr_b16 a[34:35], v8 offset:34816
    s_add_u32 s61, s65, 7168
    v_mfma_f32_16x16x32_bf16 v[152:155], a[52:55], a[24:27], v[152:155]
    ds_read_b64_tr_b16 a[36:37], v9 offset:32768
    buffer_load_dwordx4 v233, s[48:51], s61 offen offset:0 sc1 lds
    v_mfma_f32_16x16x32_bf16 v[156:159], a[52:55], a[28:31], v[156:159]
    ds_read_b64_tr_b16 a[38:39], v9 offset:34816
    buffer_load_dwordx4 v234, s[48:51], s61 offen offset:1024 sc1 lds
    v_mfma_f32_16x16x32_bf16 v[160:163], a[56:59], a[16:19], v[160:163]
    ds_read_b64_tr_b16 a[40:41], v10 offset:32768
    s_add_u32 m0, s75, 131072
    v_mfma_f32_16x16x32_bf16 v[164:167], a[56:59], a[20:23], v[164:167]
    ds_read_b64_tr_b16 a[42:43], v10 offset:34816
    s_add_u32 s60, s64, 262144
    v_mfma_f32_16x16x32_bf16 v[168:171], a[56:59], a[24:27], v[168:171]
    ds_read_b64_tr_b16 a[44:45], v11 offset:32768
    buffer_load_dwordx4 v230, s[40:43], s60 offen offset:0 lds
    v_mfma_f32_16x16x32_bf16 v[172:175], a[56:59], a[28:31], v[172:175]
    ds_read_b64_tr_b16 a[46:47], v11 offset:34816
    buffer_load_dwordx4 v245, s[40:43], s60 offen offset:1024 lds
    v_mfma_f32_16x16x32_bf16 v[176:179], a[60:63], a[16:19], v[176:179]
    s_add_u32 m0, s74, 131072
    v_mfma_f32_16x16x32_bf16 v[180:183], a[60:63], a[20:23], v[180:183]
    s_add_u32 s61, s65, 8192
    v_mfma_f32_16x16x32_bf16 v[184:187], a[60:63], a[24:27], v[184:187]
    buffer_load_dwordx4 v233, s[48:51], s61 offen offset:0 sc1 lds
    v_mfma_f32_16x16x32_bf16 v[188:191], a[60:63], a[28:31], v[188:191]
    buffer_load_dwordx4 v234, s[48:51], s61 offen offset:1024 sc1 lds
    s_waitcnt vmcnt(16) lgkmcnt(0)
    s_barrier
    s_cmp_lg_u32 s32, 0
    s_cbranch_scc1 of_no_signal
    s_mov_b64 exec, 1
    s_lshl_b32 s61, s33, 2
    v_mov_b32 v248, s61
    v_mov_b32 v249, s67
    global_store_dword v248, v249, s[30:31] offset:256 sc1
    s_mov_b64 exec, -1
of_no_signal:
    v_mfma_f32_16x16x32_bf16 v[128:131], a[32:35], a[0:3], v[128:131]
    ds_read_b128 a[16:19], v20 offset:49152
    s_add_u32 m0, s75, 147456
    v_mfma_f32_16x16x32_bf16 v[132:135], a[32:35], a[4:7], v[132:135]
    ds_read_b128 a[20:23], v21 offset:49152
    s_add_u32 s60, s64, 294912
    v_mfma_f32_16x16x32_bf16 v[136:139], a[32:35], a[8:11], v[136:139]
    ds_read_b128 a[24:27], v22 offset:49152
    buffer_load_dwordx4 v230, s[40:43], s60 offen offset:0 lds
    v_mfma_f32_16x16x32_bf16 v[140:143], a[32:35], a[12:15], v[140:143]
    ds_read_b128 a[28:31], v23 offset:49152
    buffer_load_dwordx4 v245, s[40:43], s60 offen offset:1024 lds
    v_mfma_f32_16x16x32_bf16 v[144:147], a[36:39], a[0:3], v[144:147]
    ds_read_b64_tr_b16 a[48:49], v8 offset:49152
    s_add_u32 m0, s74, 147456
    v_mfma_f32_16x16x32_bf16 v[148:151], a[36:39], a[4:7], v[148:151]
    ds_read_b64_tr_b16 a[50:51], v8 offset:51200
    s_add_u32 s61, s65, 9216
    v_mfma_f32_16x16x32_bf16 v[152:155], a[36:39], a[8:11], v[152:155]
    ds_read_b64_tr_b16 a[52:53], v9 offset:49152
    buffer_load_dwordx4 v233, s[48:51], s61 offen offset:0 sc1 lds
    v_mfma_f32_16x16x32_bf16 v[156:159], a[36:39], a[12:15], v[156:159]
    ds_read_b64_tr_b16 a[54:55], v9 offset:51200
    buffer_load_dwordx4 v234, s[48:51], s61 offen offset:1024 sc1 lds
    v_mfma_f32_16x16x32_bf16 v[160:163], a[40:43], a[0:3], v[160:163]
    ds_read_b64_tr_b16 a[56:57], v10 offset:49152
    s_add_u32 m0, s75, 0
    v_mfma_f32_16x16x32_bf16 v[164:167], a[40:43], a[4:7], v[164:167]
    ds_read_b64_tr_b16 a[58:59], v10 offset:51200
    s_add_u32 s60, s64, 327680
    v_mfma_f32_16x16x32_bf16 v[168:171], a[40:43], a[8:11], v[168:171]
    ds_read_b64_tr_b16 a[60:61], v11 offset:49152
    buffer_load_dwordx4 v230, s[40:43], s60 offen offset:0 lds
    v_mfma_f32_16x16x32_bf16 v[172:175], a[40:43], a[12:15], v[172:175]
    ds_read_b64_tr_b16 a[62:63], v11 offset:51200
    buffer_load_dwordx4 v245, s[40:43], s60 offen offset:1024 lds
    v_mfma_f32_16x16x32_bf16 v[176:179], a[44:47], a[0:3], v[176:179]
    s_add_u32 m0, s74, 0
    v_mfma_f32_16x16x32_bf16 v[180:183], a[44:47], a[4:7], v[180:183]
    s_add_u32 s61, s65, 10240
    v_mfma_f32_16x16x32_bf16 v[184:187], a[44:47], a[8:11], v[184:187]
    buffer_load_dwordx4 v233, s[48:51], s61 offen offset:0 sc1 lds
    v_mfma_f32_16x16x32_bf16 v[188:191], a[44:47], a[12:15], v[188:191]
    buffer_load_dwordx4 v234, s[48:51], s61 offen offset:1024 sc1 lds
    s_waitcnt lgkmcnt(0)
    v_mfma_f32_16x16x32_bf16 v[128:131], a[48:51], a[16:19], v[128:131]
    ds_read_b128 a[0:3], v24 offset:0
    s_add_u32 m0, s75, 16384
    v_mfma_f32_16x16x32_bf16 v[132:135], a[48:51], a[20:23], v[132:135]
    ds_read_b128 a[4:7], v25 offset:0
    s_add_u32 s60, s64, 360448
    v_mfma_f32_16x16x32_bf16 v[136:139], a[48:51], a[24:27], v[136:139]
    ds_read_b128 a[8:11], v26 offset:0
    buffer_load_dwordx4 v230, s[40:43], s60 offen offset:0 lds
    v_mfma_f32_16x16x32_bf16 v[140:143], a[48:51], a[28:31], v[140:143]
    ds_read_b128 a[12:15], v27 offset:0
    buffer_load_dwordx4 v245, s[40:43], s60 offen offset:1024 lds
    v_mfma_f32_16x16x32_bf16 v[144:147], a[52:55], a[16:19], v[144:147]
    ds_read_b64_tr_b16 a[32:33], v12 offset:0
    s_add_u32 m0, s74, 16384
    v_mfma_f32_16x16x32_bf16 v[148:151], a[52:55], a[20:23], v[148:151]
    ds_read_b64_tr_b16 a[34:35], v12 offset:2048
    s_add_u32 s61, s65, 11264
    v_mfma_f32_16x16x32_bf16 v[152:155], a[52:55], a[24:27], v[152:155]
    ds_read_b64_tr_b16 a[36:37], v13 offset:0
    buffer_load_dwordx4 v233, s[48:51], s61 offen offset:0 sc1 lds
    v_mfma_f32_16x16x32_bf16 v[156:159], a[52:55], a[28:31], v[156:159]
    ds_read_b64_tr_b16 a[38:39], v13 offset:2048
    buffer_load_dwordx4 v234, s[48:51], s61 offen offset:1024 sc1 lds
    v_mfma_f32_16x16x32_bf16 v[160:163], a[56:59], a[16:19], v[160:163]
    ds_read_b64_tr_b16 a[40:41], v14 offset:0
    s_add_u32 m0, s75, 32768
    v_mfma_f32_16x16x32_bf16 v[164:167], a[56:59], a[20:23], v[164:167]
    ds_read_b64_tr_b16 a[42:43], v14 offset:2048
    s_add_u32 s60, s64, 393216
    v_mfma_f32_16x16x32_bf16 v[168:171], a[56:59], a[24:27], v[168:171]
    ds_read_b64_tr_b16 a[44:45], v15 offset:0
    buffer_load_dwordx4 v230, s[40:43], s60 offen offset:0 lds
    v_mfma_f32_16x16x32_bf16 v[172:175], a[56:59], a[28:31], v[172:175]
    ds_read_b64_tr_b16 a[46:47], v15 offset:2048
    buffer_load_dwordx4 v245, s[40:43], s60 offen offset:1024 lds
    v_mfma_f32_16x16x32_bf16 v[176:179], a[60:63], a[16:19], v[176:179]
    s_add_u32 m0, s74, 32768
    v_mfma_f32_16x16x32_bf16 v[180:183], a[60:63], a[20:23], v[180:183]
    s_add_u32 s61, s65, 12288
    v_mfma_f32_16x16x32_bf16 v[184:187], a[60:63], a[24:27], v[184:187]
    buffer_load_dwordx4 v233, s[48:51], s61 offen offset:0 sc1 lds
    v_mfma_f32_16x16x32_bf16 v[188:191], a[60:63], a[28:31], v[188:191]
    buffer_load_dwordx4 v234, s[48:51], s61 offen offset:1024 sc1 lds
    s_waitcnt vmcnt(24) lgkmcnt(0)
    s_barrier
    v_mfma_f32_16x16x32_bf16 v[128:131], a[32:35], a[0:3], v[128:131]
    ds_read_b128 a[16:19], v24 offset:16384
    v_mfma_f32_16x16x32_bf16 v[132:135], a[32:35], a[4:7], v[132:135]
    ds_read_b128 a[20:23], v25 offset:16384
    v_mfma_f32_16x16x32_bf16 v[136:139], a[32:35], a[8:11], v[136:139]
    ds_read_b128 a[24:27], v26 offset:16384
    v_mfma_f32_16x16x32_bf16 v[140:143], a[32:35], a[12:15], v[140:143]
    ds_read_b128 a[28:31], v27 offset:16384
    v_mfma_f32_16x16x32_bf16 v[144:147], a[36:39], a[0:3], v[144:147]
    ds_read_b64_tr_b16 a[48:49], v12 offset:16384
    v_mfma_f32_16x16x32_bf16 v[148:151], a[36:39], a[4:7], v[148:151]
    ds_read_b64_tr_b16 a[50:51], v12 offset:18432
    v_mfma_f32_16x16x32_bf16 v[152:155], a[36:39], a[8:11], v[152:155]
    ds_read_b64_tr_b16 a[52:53], v13 offset:16384
    v_mfma_f32_16x16x32_bf16 v[156:159], a[36:39], a[12:15], v[156:159]
    ds_read_b64_tr_b16 a[54:55], v13 offset:18432
    v_mfma_f32_16x16x32_bf16 v[160:163], a[40:43], a[0:3], v[160:163]
    ds_read_b64_tr_b16 a[56:57], v14 offset:16384
    s_add_u32 m0, s75, 49152
    v_mfma_f32_16x16x32_bf16 v[164:167], a[40:43], a[4:7], v[164:167]
    ds_read_b64_tr_b16 a[58:59], v14 offset:18432
    s_add_u32 s60, s64, 425984
    v_mfma_f32_16x16x32_bf16 v[168:171], a[40:43], a[8:11], v[168:171]
    ds_read_b64_tr_b16 a[60:61], v15 offset:16384
    buffer_load_dwordx4 v230, s[40:43], s60 offen offset:0 lds
    v_mfma_f32_16x16x32_bf16 v[172:175], a[40:43], a[12:15], v[172:175]
    ds_read_b64_tr_b16 a[62:63], v15 offset:18432
    buffer_load_dwordx4 v245, s[40:43], s60 offen offset:1024 lds
    v_mfma_f32_16x16x32_bf16 v[176:179], a[44:47], a[0:3], v[176:179]
    s_add_u32 m0, s74, 49152
    v_mfma_f32_16x16x32_bf16 v[180:183], a[44:47], a[4:7], v[180:183]
    s_add_u32 s61, s65, 13312
    v_mfma_f32_16x16x32_bf16 v[184:187], a[44:47], a[8:11], v[184:187]
    buffer_load_dwordx4 v233, s[48:51], s61 offen offset:0 sc1 lds
    v_mfma_f32_16x16x32_bf16 v[188:191], a[44:47], a[12:15], v[188:191]
    buffer_load_dwordx4 v234, s[48:51], s61 offen offset:1024 sc1 lds
    s_waitcnt lgkmcnt(0)
    v_mfma_f32_16x16x32_bf16 v[128:131], a[48:51], a[16:19], v[128:131]
    ds_read_b128 a[0:3], v24 offset:32768
    v_mfma_f32_16x16x32_bf16 v[132:135], a[48:51], a[20:23], v[132:135]
    ds_read_b128 a[4:7], v25 offset:32768
    v_mfma_f32_16x16x32_bf16 v[136:139], a[48:51], a[24:27], v[136:139]
    ds_read_b128 a[8:11], v26 offset:32768
    v_mfma_f32_16x16x32_bf16 v[140:143], a[48:51], a[28:31], v[140:143]
    ds_read_b128 a[12:15], v27 offset:32768
    v_mfma_f32_16x16x32_bf16 v[144:147], a[52:55], a[16:19], v[144:147]
    ds_read_b64_tr_b16 a[32:33], v12 offset:32768
    v_mfma_f32_16x16x32_bf16 v[148:151], a[52:55], a[20:23], v[148:151]
    ds_read_b64_tr_b16 a[34:35], v12 offset:34816
    v_mfma_f32_16x16x32_bf16 v[152:155], a[52:55], a[24:27], v[152:155]
    ds_read_b64_tr_b16 a[36:37], v13 offset:32768
    v_mfma_f32_16x16x32_bf16 v[156:159], a[52:55], a[28:31], v[156:159]
    ds_read_b64_tr_b16 a[38:39], v13 offset:34816
    v_mfma_f32_16x16x32_bf16 v[160:163], a[56:59], a[16:19], v[160:163]
    ds_read_b64_tr_b16 a[40:41], v14 offset:32768
    v_mfma_f32_16x16x32_bf16 v[164:167], a[56:59], a[20:23], v[164:167]
    ds_read_b64_tr_b16 a[42:43], v14 offset:34816
    v_mfma_f32_16x16x32_bf16 v[168:171], a[56:59], a[24:27], v[168:171]
    ds_read_b64_tr_b16 a[44:45], v15 offset:32768
    v_mfma_f32_16x16x32_bf16 v[172:175], a[56:59], a[28:31], v[172:175]
    ds_read_b64_tr_b16 a[46:47], v15 offset:34816
    v_mfma_f32_16x16x32_bf16 v[176:179], a[60:63], a[16:19], v[176:179]
    v_mfma_f32_16x16x32_bf16 v[180:183], a[60:63], a[20:23], v[180:183]
    v_mfma_f32_16x16x32_bf16 v[184:187], a[60:63], a[24:27], v[184:187]
    v_mfma_f32_16x16x32_bf16 v[188:191], a[60:63], a[28:31], v[188:191]
    s_waitcnt vmcnt(20) lgkmcnt(0)
    s_cmp_lg_u32 s32, 0
    s_cbranch_scc1 of_wait_done
    s_lshl_b32 s26, s68, 3
    s_lshl_b32 s26, 0xff, s26
    s_mov_b32 exec_lo, s26
    s_mov_b32 exec_hi, 0
    v_lshlrev_b32 v248, 2, v1
    s_mov_b32 s61, 0
    global_load_dword v250, v248, s[30:31] offset:256 sc1
    s_sleep 2
    global_load_dword v251, v248, s[30:31] offset:256 sc1
    s_sleep 2
of_poll:
    global_load_dword v252, v248, s[30:31] offset:256 sc1
    s_waitcnt vmcnt(2)
    v_cmp_ne_u32 vcc, s67, v250
    s_cbranch_vccz of_poll_out
    global_load_dword v250, v248, s[30:31] offset:256 sc1
    s_waitcnt vmcnt(2)
    v_cmp_ne_u32 vcc, s67, v251
    s_cbranch_vccz of_poll_out
    global_load_dword v251, v248, s[30:31] offset:256 sc1
    s_waitcnt vmcnt(2)
    v_cmp_ne_u32 vcc, s67, v252
    s_cbranch_vccz of_poll_out
    s_add_u32 s61, s61, 1
    s_cmp_lt_u32 s61, 0x20000
    s_cbranch_scc1 of_poll
of_poll_out:
    s_mov_b64 exec, -1
of_wait_done:
    s_barrier
    v_mfma_f32_16x16x32_bf16 v[128:131], a[32:35], a[0:3], v[128:131]
    ds_read_b128 a[16:19], v24 offset:49152
    s_add_u32 m0, s75, 65536
    v_mfma_f32_16x16x32_bf16 v[132:135], a[32:35], a[4:7], v[132:135]
    ds_read_b128 a[20:23], v25 offset:49152
    s_add_u32 s60, s62, 0
    v_mfma_f32_16x16x32_bf16 v[136:139], a[32:35], a[8:11], v[136:139]
    ds_read_b128 a[24:27], v26 offset:49152
    buffer_load_dwordx4 v230, s[36:39], s60 offen offset:0 lds
    v_mfma_f32_16x16x32_bf16 v[140:143], a[32:35], a[12:15], v[140:143]
    ds_read_b128 a[28:31], v27 offset:49152
    buffer_load_dwordx4 v245, s[36:39], s60 offen offset:1024 lds
    v_mfma_f32_16x16x32_bf16 v[144:147], a[36:39], a[0:3], v[144:147]
    ds_read_b64_tr_b16 a[48:49], v12 offset:49152
    s_add_u32 m0, s74, 65536
    v_mfma_f32_16x16x32_bf16 v[148:151], a[36:39], a[4:7], v[148:151]
    ds_read_b64_tr_b16 a[50:51], v12 offset:51200
    s_add_u32 s61, s63, 0
    v_mfma_f32_16x16x32_bf16 v[152:155], a[36:39], a[8:11], v[152:155]
    ds_read_b64_tr_b16 a[52:53], v13 offset:49152
    buffer_load_dwordx4 v231, s[44:47], s61 offen offset:0 sc1 lds
    v_mfma_f32_16x16x32_bf16 v[156:159], a[36:39], a[12:15], v[156:159]
    ds_read_b64_tr_b16 a[54:55], v13 offset:51200
    buffer_load_dwordx4 v232, s[44:47], s61 offen offset:1024 sc1 lds
    v_mfma_f32_16x16x32_bf16 v[160:163], a[40:43], a[0:3], v[160:163]
    ds_read_b64_tr_b16 a[56:57], v14 offset:49152
    s_add_u32 m0, s75, 81920
    v_mfma_f32_16x16x32_bf16 v[164:167], a[40:43], a[4:7], v[164:167]
    ds_read_b64_tr_b16 a[58:59], v14 offset:51200
    s_add_u32 s60, s62, 32768
    v_mfma_f32_16x16x32_bf16 v[168:171], a[40:43], a[8:11], v[168:171]
    ds_read_b64_tr_b16 a[60:61], v15 offset:49152
    buffer_load_dwordx4 v230, s[36:39], s60 offen offset:0 lds
    v_mfma_f32_16x16x32_bf16 v[172:175], a[40:43], a[12:15], v[172:175]
    ds_read_b64_tr_b16 a[62:63], v15 offset:51200
    buffer_load_dwordx4 v245, s[36:39], s60 offen offset:1024 lds
    v_mfma_f32_16x16x32_bf16 v[176:179], a[44:47], a[0:3], v[176:179]
    s_add_u32 m0, s74, 81920
    v_mfma_f32_16x16x32_bf16 v[180:183], a[44:47], a[4:7], v[180:183]
    s_add_u32 s61, s63, 1024
    v_mfma_f32_16x16x32_bf16 v[184:187], a[44:47], a[8:11], v[184:187]
    buffer_load_dwordx4 v231, s[44:47], s61 offen offset:0 sc1 lds
    v_mfma_f32_16x16x32_bf16 v[188:191], a[44:47], a[12:15], v[188:191]
    buffer_load_dwordx4 v232, s[44:47], s61 offen offset:1024 sc1 lds
    s_waitcnt lgkmcnt(0)
    v_mfma_f32_16x16x32_bf16 v[128:131], a[48:51], a[16:19], v[128:131]
    ds_read_b128 a[0:3], v28 offset:0
    v_mfma_f32_16x16x32_bf16 v[132:135], a[48:51], a[20:23], v[132:135]
    ds_read_b128 a[4:7], v29 offset:0
    v_mfma_f32_16x16x32_bf16 v[136:139], a[48:51], a[24:27], v[136:139]
    ds_read_b128 a[8:11], v30 offset:0
    v_mfma_f32_16x16x32_bf16 v[140:143], a[48:51], a[28:31], v[140:143]
    ds_read_b128 a[12:15], v31 offset:0
    v_mfma_f32_16x16x32_bf16 v[144:147], a[52:55], a[16:19], v[144:147]
    ds_read_b64_tr_b16 a[32:33], v16 offset:0
    v_mfma_f32_16x16x32_bf16 v[148:151], a[52:55], a[20:23], v[148:151]
    ds_read_b64_tr_b16 a[34:35], v16 offset:2048
    v_mfma_f32_16x16x32_bf16 v[152:155], a[52:55], a[24:27], v[152:155]
    ds_read_b64_tr_b16 a[36:37], v17 offset:0
    v_mfma_f32_16x16x32_bf16 v[156:159], a[52:55], a[28:31], v[156:159]
    ds_read_b64_tr_b16 a[38:39], v17 offset:2048
    v_mfma_f32_16x16x32_bf16 v[160:163], a[56:59], a[16:19], v[160:163]
    ds_read_b64_tr_b16 a[40:41], v18 offset:0
    s_add_u32 m0, s75, 98304
    v_mfma_f32_16x16x32_bf16 v[164:167], a[56:59], a[20:23], v[164:167]
    ds_read_b64_tr_b16 a[42:43], v18 offset:2048
    s_add_u32 s60, s62, 65536
    v_mfma_f32_16x16x32_bf16 v[168:171], a[56:59], a[24:27], v[168:171]
    ds_read_b64_tr_b16 a[44:45], v19 offset:0
    buffer_load_dwordx4 v230, s[36:39], s60 offen offset:0 lds
    v_mfma_f32_16x16x32_bf16 v[172:175], a[56:59], a[28:31], v[172:175]
    ds_read_b64_tr_b16 a[46:47], v19 offset:2048
    buffer_load_dwordx4 v245, s[36:39], s60 offen offset:1024 lds
    v_mfma_f32_16x16x32_bf16 v[176:179], a[60:63], a[16:19], v[176:179]
    s_add_u32 m0, s74, 98304
    v_mfma_f32_16x16x32_bf16 v[180:183], a[60:63], a[20:23], v[180:183]
    s_add_u32 s61, s63, 2048
    v_mfma_f32_16x16x32_bf16 v[184:187], a[60:63], a[24:27], v[184:187]
    buffer_load_dwordx4 v231, s[44:47], s61 offen offset:0 sc1 lds
    v_mfma_f32_16x16x32_bf16 v[188:191], a[60:63], a[28:31], v[188:191]
    buffer_load_dwordx4 v232, s[44:47], s61 offen offset:1024 sc1 lds
    s_waitcnt vmcnt(24) lgkmcnt(0)
    s_barrier
    v_mfma_f32_16x16x32_bf16 v[128:131], a[32:35], a[0:3], v[128:131]
    ds_read_b128 a[16:19], v28 offset:16384
    v_mfma_f32_16x16x32_bf16 v[132:135], a[32:35], a[4:7], v[132:135]
    ds_read_b128 a[20:23], v29 offset:16384
    v_mfma_f32_16x16x32_bf16 v[136:139], a[32:35], a[8:11], v[136:139]
    ds_read_b128 a[24:27], v30 offset:16384
    v_mfma_f32_16x16x32_bf16 v[140:143], a[32:35], a[12:15], v[140:143]
    ds_read_b128 a[28:31], v31 offset:16384
    v_mfma_f32_16x16x32_bf16 v[144:147], a[36:39], a[0:3], v[144:147]
    ds_read_b64_tr_b16 a[48:49], v16 offset:16384
    v_mfma_f32_16x16x32_bf16 v[148:151], a[36:39], a[4:7], v[148:151]
    ds_read_b64_tr_b16 a[50:51], v16 offset:18432
    v_mfma_f32_16x16x32_bf16 v[152:155], a[36:39], a[8:11], v[152:155]
    ds_read_b64_tr_b16 a[52:53], v17 offset:16384
    v_mfma_f32_16x16x32_bf16 v[156:159], a[36:39], a[12:15], v[156:159]
    ds_read_b64_tr_b16 a[54:55], v17 offset:18432
    v_mfma_f32_16x16x32_bf16 v[160:163], a[40:43], a[0:3], v[160:163]
    ds_read_b64_tr_b16 a[56:57], v18 offset:16384
    s_add_u32 m0, s75, 114688
    v_mfma_f32_16x16x32_bf16 v[164:167], a[40:43], a[4:7], v[164:167]
    ds_read_b64_tr_b16 a[58:59], v18 offset:18432
    s_add_u32 s60, s62, 98304
    v_mfma_f32_16x16x32_bf16 v[168:171], a[40:43], a[8:11], v[168:171]
    ds_read_b64_tr_b16 a[60:61], v19 offset:16384
    buffer_load_dwordx4 v230, s[36:39], s60 offen offset:0 lds
    v_mfma_f32_16x16x32_bf16 v[172:175], a[40:43], a[12:15], v[172:175]
    ds_read_b64_tr_b16 a[62:63], v19 offset:18432
    buffer_load_dwordx4 v245, s[36:39], s60 offen offset:1024 lds
    v_mfma_f32_16x16x32_bf16 v[176:179], a[44:47], a[0:3], v[176:179]
    s_add_u32 m0, s74, 114688
    v_mfma_f32_16x16x32_bf16 v[180:183], a[44:47], a[4:7], v[180:183]
    s_add_u32 s61, s63, 3072
    v_mfma_f32_16x16x32_bf16 v[184:187], a[44:47], a[8:11], v[184:187]
    buffer_load_dwordx4 v231, s[44:47], s61 offen offset:0 sc1 lds
    v_mfma_f32_16x16x32_bf16 v[188:191], a[44:47], a[12:15], v[188:191]
    buffer_load_dwordx4 v232, s[44:47], s61 offen offset:1024 sc1 lds
    s_waitcnt lgkmcnt(0)
    v_mfma_f32_16x16x32_bf16 v[128:131], a[48:51], a[16:19], v[128:131]
    ds_read_b128 a[0:3], v20 offset:0
    v_mfma_f32_16x16x32_bf16 v[132:135], a[48:51], a[20:23], v[132:135]
    ds_read_b128 a[4:7], v21 offset:0
    v_mfma_f32_16x16x32_bf16 v[136:139], a[48:51], a[24:27], v[136:139]
    ds_read_b128 a[8:11], v22 offset:0
    v_mfma_f32_16x16x32_bf16 v[140:143], a[48:51], a[28:31], v[140:143]
    ds_read_b128 a[12:15], v23 offset:0
    v_mfma_f32_16x16x32_bf16 v[144:147], a[52:55], a[16:19], v[144:147]
    ds_read_b64_tr_b16 a[32:33], v8 offset:0
    v_mfma_f32_16x16x32_bf16 v[148:151], a[52:55], a[20:23], v[148:151]
    ds_read_b64_tr_b16 a[34:35], v8 offset:2048
    v_mfma_f32_16x16x32_bf16 v[152:155], a[52:55], a[24:27], v[152:155]
    ds_read_b64_tr_b16 a[36:37], v9 offset:0
    v_mfma_f32_16x16x32_bf16 v[156:159], a[52:55], a[28:31], v[156:159]
    ds_read_b64_tr_b16 a[38:39], v9 offset:2048
    v_mfma_f32_16x16x32_bf16 v[160:163], a[56:59], a[16:19], v[160:163]
    ds_read_b64_tr_b16 a[40:41], v10 offset:0
    s_add_u32 m0, s75, 131072
    v_mfma_f32_16x16x32_bf16 v[164:167], a[56:59], a[20:23], v[164:167]
    ds_read_b64_tr_b16 a[42:43], v10 offset:2048
    s_add_u32 s60, s62, 131072
    v_mfma_f32_16x16x32_bf16 v[168:171], a[56:59], a[24:27], v[168:171]
    ds_read_b64_tr_b16 a[44:45], v11 offset:0
    buffer_load_dwordx4 v230, s[36:39], s60 offen offset:0 lds
    v_mfma_f32_16x16x32_bf16 v[172:175], a[56:59], a[28:31], v[172:175]
    ds_read_b64_tr_b16 a[46:47], v11 offset:2048
    buffer_load_dwordx4 v245, s[36:39], s60 offen offset:1024 lds
    v_mfma_f32_16x16x32_bf16 v[176:179], a[60:63], a[16:19], v[176:179]
    s_add_u32 m0, s74, 131072
    v_mfma_f32_16x16x32_bf16 v[180:183], a[60:63], a[20:23], v[180:183]
    s_add_u32 s61, s63, 4096
    v_mfma_f32_16x16x32_bf16 v[184:187], a[60:63], a[24:27], v[184:187]
    buffer_load_dwordx4 v231, s[44:47], s61 offen offset:0 sc1 lds
    v_mfma_f32_16x16x32_bf16 v[188:191], a[60:63], a[28:31], v[188:191]
    buffer_load_dwordx4 v232, s[44:47], s61 offen offset:1024 sc1 lds
    s_waitcnt vmcnt(24) lgkmcnt(0)
    s_barrier
    v_mfma_f32_16x16x32_bf16 v[128:131], a[32:35], a[0:3], v[128:131]
    ds_read_b128 a[16:19], v20 offset:16384
    v_mfma_f32_16x16x32_bf16 v[132:135], a[32:35], a[4:7], v[132:135]
    ds_read_b128 a[20:23], v21 offset:16384
    v_mfma_f32_16x16x32_bf16 v[136:139], a[32:35], a[8:11], v[136:139]
    ds_read_b128 a[24:27], v22 offset:16384
    v_mfma_f32_16x16x32_bf16 v[140:143], a[32:35], a[12:15], v[140:143]
    ds_read_b128 a[28:31], v23 offset:16384
    v_mfma_f32_16x16x32_bf16 v[144:147], a[36:39], a[0:3], v[144:147]
    ds_read_b64_tr_b16 a[48:49], v8 offset:16384
    v_mfma_f32_16x16x32_bf16 v[148:151], a[36:39], a[4:7], v[148:151]
    ds_read_b64_tr_b16 a[50:51], v8 offset:18432
    v_mfma_f32_16x16x32_bf16 v[152:155], a[36:39], a[8:11], v[152:155]
    ds_read_b64_tr_b16 a[52:53], v9 offset:16384
    v_mfma_f32_16x16x32_bf16 v[156:159], a[36:39], a[12:15], v[156:159]
    ds_read_b64_tr_b16 a[54:55], v9 offset:18432
    v_mfma_f32_16x16x32_bf16 v[160:163], a[40:43], a[0:3], v[160:163]
    ds_read_b64_tr_b16 a[56:57], v10 offset:16384
    s_add_u32 m0, s75, 147456
    v_mfma_f32_16x16x32_bf16 v[164:167], a[40:43], a[4:7], v[164:167]
    ds_read_b64_tr_b16 a[58:59], v10 offset:18432
    s_add_u32 s60, s62, 163840
    v_mfma_f32_16x16x32_bf16 v[168:171], a[40:43], a[8:11], v[168:171]
    ds_read_b64_tr_b16 a[60:61], v11 offset:16384
    buffer_load_dwordx4 v230, s[36:39], s60 offen offset:0 lds
    v_mfma_f32_16x16x32_bf16 v[172:175], a[40:43], a[12:15], v[172:175]
    ds_read_b64_tr_b16 a[62:63], v11 offset:18432
    buffer_load_dwordx4 v245, s[36:39], s60 offen offset:1024 lds
    v_mfma_f32_16x16x32_bf16 v[176:179], a[44:47], a[0:3], v[176:179]
    s_add_u32 m0, s74, 147456
    v_mfma_f32_16x16x32_bf16 v[180:183], a[44:47], a[4:7], v[180:183]
    s_add_u32 s61, s63, 5120
    v_mfma_f32_16x16x32_bf16 v[184:187], a[44:47], a[8:11], v[184:187]
    buffer_load_dwordx4 v231, s[44:47], s61 offen offset:0 sc1 lds
    v_mfma_f32_16x16x32_bf16 v[188:191], a[44:47], a[12:15], v[188:191]
    buffer_load_dwordx4 v232, s[44:47], s61 offen offset:1024 sc1 lds
    s_waitcnt lgkmcnt(0)
    v_mfma_f32_16x16x32_bf16 v[128:131], a[48:51], a[16:19], v[128:131]
    ds_read_b128 a[0:3], v20 offset:32768
    v_mfma_f32_16x16x32_bf16 v[132:135], a[48:51], a[20:23], v[132:135]
    ds_read_b128 a[4:7], v21 offset:32768
    v_mfma_f32_16x16x32_bf16 v[136:139], a[48:51], a[24:27], v[136:139]
    ds_read_b128 a[8:11], v22 offset:32768
    v_mfma_f32_16x16x32_bf16 v[140:143], a[48:51], a[28:31], v[140:143]
    ds_read_b128 a[12:15], v23 offset:32768
    v_mfma_f32_16x16x32_bf16 v[144:147], a[52:55], a[16:19], v[144:147]
    ds_read_b64_tr_b16 a[32:33], v8 offset:32768
    v_mfma_f32_16x16x32_bf16 v[148:151], a[52:55], a[20:23], v[148:151]
    ds_read_b64_tr_b16 a[34:35], v8 offset:34816
    v_mfma_f32_16x16x32_bf16 v[152:155], a[52:55], a[24:27], v[152:155]
    ds_read_b64_tr_b16 a[36:37], v9 offset:32768
    v_mfma_f32_16x16x32_bf16 v[156:159], a[52:55], a[28:31], v[156:159]
    ds_read_b64_tr_b16 a[38:39], v9 offset:34816
    v_mfma_f32_16x16x32_bf16 v[160:163], a[56:59], a[16:19], v[160:163]
    ds_read_b64_tr_b16 a[40:41], v10 offset:32768
    s_add_u32 m0, s75, 0
    v_mfma_f32_16x16x32_bf16 v[164:167], a[56:59], a[20:23], v[164:167]
    ds_read_b64_tr_b16 a[42:43], v10 offset:34816
    s_add_u32 s60, s62, 196608
    v_mfma_f32_16x16x32_bf16 v[168:171], a[56:59], a[24:27], v[168:171]
    ds_read_b64_tr_b16 a[44:45], v11 offset:32768
    buffer_load_dwordx4 v230, s[36:39], s60 offen offset:0 lds
    v_mfma_f32_16x16x32_bf16 v[172:175], a[56:59], a[28:31], v[172:175]
    ds_read_b64_tr_b16 a[46:47], v11 offset:34816
    buffer_load_dwordx4 v245, s[36:39], s60 offen offset:1024 lds
    v_mfma_f32_16x16x32_bf16 v[176:179], a[60:63], a[16:19], v[176:179]
    s_add_u32 m0, s74, 0
    v_mfma_f32_16x16x32_bf16 v[180:183], a[60:63], a[20:23], v[180:183]
    s_add_u32 s61, s63, 6144
    v_mfma_f32_16x16x32_bf16 v[184:187], a[60:63], a[24:27], v[184:187]
    buffer_load_dwordx4 v231, s[44:47], s61 offen offset:0 sc1 lds
    v_mfma_f32_16x16x32_bf16 v[188:191], a[60:63], a[28:31], v[188:191]
    buffer_load_dwordx4 v232, s[44:47], s61 offen offset:1024 sc1 lds
    s_waitcnt vmcnt(24) lgkmcnt(0)
    s_barrier
    v_mfma_f32_16x16x32_bf16 v[128:131], a[32:35], a[0:3], v[128:131]
    ds_read_b128 a[16:19], v20 offset:49152
    v_mfma_f32_16x16x32_bf16 v[132:135], a[32:35], a[4:7], v[132:135]
    ds_read_b128 a[20:23], v21 offset:49152
    v_mfma_f32_16x16x32_bf16 v[136:139], a[32:35], a[8:11], v[136:139]
    ds_read_b128 a[24:27], v22 offset:49152
    v_mfma_f32_16x16x32_bf16 v[140:143], a[32:35], a[12:15], v[140:143]
    ds_read_b128 a[28:31], v23 offset:49152
    v_mfma_f32_16x16x32_bf16 v[144:147], a[36:39], a[0:3], v[144:147]
    ds_read_b64_tr_b16 a[48:49], v8 offset:49152
    v_mfma_f32_16x16x32_bf16 v[148:151], a[36:39], a[4:7], v[148:151]
    ds_read_b64_tr_b16 a[50:51], v8 offset:51200
    v_mfma_f32_16x16x32_bf16 v[152:155], a[36:39], a[8:11], v[152:155]
    ds_read_b64_tr_b16 a[52:53], v9 offset:49152
    v_mfma_f32_16x16x32_bf16 v[156:159], a[36:39], a[12:15], v[156:159]
    ds_read_b64_tr_b16 a[54:55], v9 offset:51200
    v_mfma_f32_16x16x32_bf16 v[160:163], a[40:43], a[0:3], v[160:163]
    ds_read_b64_tr_b16 a[56:57], v10 offset:49152
    s_add_u32 m0, s75, 16384
    v_mfma_f32_16x16x32_bf16 v[164:167], a[40:43], a[4:7], v[164:167]
    ds_read_b64_tr_b16 a[58:59], v10 offset:51200
    s_add_u32 s60, s62, 229376
    v_mfma_f32_16x16x32_bf16 v[168:171], a[40:43], a[8:11], v[168:171]
    ds_read_b64_tr_b16 a[60:61], v11 offset:49152
    buffer_load_dwordx4 v230, s[36:39], s60 offen offset:0 lds
    v_mfma_f32_16x16x32_bf16 v[172:175], a[40:43], a[12:15], v[172:175]
    ds_read_b64_tr_b16 a[62:63], v11 offset:51200
    buffer_load_dwordx4 v245, s[36:39], s60 offen offset:1024 lds
    v_mfma_f32_16x16x32_bf16 v[176:179], a[44:47], a[0:3], v[176:179]
    s_add_u32 m0, s74, 16384
    v_mfma_f32_16x16x32_bf16 v[180:183], a[44:47], a[4:7], v[180:183]
    s_add_u32 s61, s63, 7168
    v_mfma_f32_16x16x32_bf16 v[184:187], a[44:47], a[8:11], v[184:187]
    buffer_load_dwordx4 v231, s[44:47], s61 offen offset:0 sc1 lds
    v_mfma_f32_16x16x32_bf16 v[188:191], a[44:47], a[12:15], v[188:191]
    buffer_load_dwordx4 v232, s[44:47], s61 offen offset:1024 sc1 lds
    s_waitcnt lgkmcnt(0)
    v_mfma_f32_16x16x32_bf16 v[128:131], a[48:51], a[16:19], v[128:131]
    ds_read_b128 a[0:3], v24 offset:0
    v_mfma_f32_16x16x32_bf16 v[132:135], a[48:51], a[20:23], v[132:135]
    ds_read_b128 a[4:7], v25 offset:0
    v_mfma_f32_16x16x32_bf16 v[136:139], a[48:51], a[24:27], v[136:139]
    ds_read_b128 a[8:11], v26 offset:0
    v_mfma_f32_16x16x32_bf16 v[140:143], a[48:51], a[28:31], v[140:143]
    ds_read_b128 a[12:15], v27 offset:0
    v_mfma_f32_16x16x32_bf16 v[144:147], a[52:55], a[16:19], v[144:147]
    ds_read_b64_tr_b16 a[32:33], v12 offset:0
    v_mfma_f32_16x16x32_bf16 v[148:151], a[52:55], a[20:23], v[148:151]
    ds_read_b64_tr_b16 a[34:35], v12 offset:2048
    v_mfma_f32_16x16x32_bf16 v[152:155], a[52:55], a[24:27], v[152:155]
    ds_read_b64_tr_b16 a[36:37], v13 offset:0
    v_mfma_f32_16x16x32_bf16 v[156:159], a[52:55], a[28:31], v[156:159]
    ds_read_b64_tr_b16 a[38:39], v13 offset:2048
    v_mfma_f32_16x16x32_bf16 v[160:163], a[56:59], a[16:19], v[160:163]
    ds_read_b64_tr_b16 a[40:41], v14 offset:0
    s_add_u32 m0, s75, 32768
    v_mfma_f32_16x16x32_bf16 v[164:167], a[56:59], a[20:23], v[164:167]
    ds_read_b64_tr_b16 a[42:43], v14 offset:2048
    s_add_u32 s60, s62, 262144
    v_mfma_f32_16x16x32_bf16 v[168:171], a[56:59], a[24:27], v[168:171]
    ds_read_b64_tr_b16 a[44:45], v15 offset:0
    buffer_load_dwordx4 v230, s[36:39], s60 offen offset:0 lds
    v_mfma_f32_16x16x32_bf16 v[172:175], a[56:59], a[28:31], v[172:175]
    ds_read_b64_tr_b16 a[46:47], v15 offset:2048
    buffer_load_dwordx4 v245, s[36:39], s60 offen offset:1024 lds
    v_mfma_f32_16x16x32_bf16 v[176:179], a[60:63], a[16:19], v[176:179]
    s_add_u32 m0, s74, 32768
    v_mfma_f32_16x16x32_bf16 v[180:183], a[60:63], a[20:23], v[180:183]
    s_add_u32 s61, s63, 8192
    v_mfma_f32_16x16x32_bf16 v[184:187], a[60:63], a[24:27], v[184:187]
    buffer_load_dwordx4 v231, s[44:47], s61 offen offset:0 sc1 lds
    v_mfma_f32_16x16x32_bf16 v[188:191], a[60:63], a[28:31], v[188:191]
    buffer_load_dwordx4 v232, s[44:47], s61 offen offset:1024 sc1 lds
    s_waitcnt vmcnt(24) lgkmcnt(0)
    s_barrier
    v_mfma_f32_16x16x32_bf16 v[64:67], a[32:35], a[0:3], 0
    ds_read_b128 a[16:19], v24 offset:16384
    v_mfma_f32_16x16x32_bf16 v[68:71], a[32:35], a[4:7], 0
    ds_read_b128 a[20:23], v25 offset:16384
    v_mfma_f32_16x16x32_bf16 v[72:75], a[32:35], a[8:11], 0
    ds_read_b128 a[24:27], v26 offset:16384
    v_mfma_f32_16x16x32_bf16 v[76:79], a[32:35], a[12:15], 0
    ds_read_b128 a[28:31], v27 offset:16384
    v_mfma_f32_16x16x32_bf16 v[80:83], a[36:39], a[0:3], 0
    ds_read_b64_tr_b16 a[48:49], v12 offset:16384
    v_mfma_f32_16x16x32_bf16 v[84:87], a[36:39], a[4:7], 0
    ds_read_b64_tr_b16 a[50:51], v12 offset:18432
    v_mfma_f32_16x16x32_bf16 v[88:91], a[36:39], a[8:11], 0
    ds_read_b64_tr_b16 a[52:53], v13 offset:16384
    v_mfma_f32_16x16x32_bf16 v[92:95], a[36:39], a[12:15], 0
    ds_read_b64_tr_b16 a[54:55], v13 offset:18432
    v_mfma_f32_16x16x32_bf16 v[96:99], a[40:43], a[0:3], 0
    ds_read_b64_tr_b16 a[56:57], v14 offset:16384
    s_add_u32 m0, s75, 49152
    v_mfma_f32_16x16x32_bf16 v[100:103], a[40:43], a[4:7], 0
    ds_read_b64_tr_b16 a[58:59], v14 offset:18432
    s_add_u32 s60, s62, 294912
    v_mfma_f32_16x16x32_bf16 v[104:107], a[40:43], a[8:11], 0
    ds_read_b64_tr_b16 a[60:61], v15 offset:16384
    buffer_load_dwordx4 v230, s[36:39], s60 offen offset:0 lds
    v_mfma_f32_16x16x32_bf16 v[108:111], a[40:43], a[12:15], 0
    ds_read_b64_tr_b16 a[62:63], v15 offset:18432
    buffer_load_dwordx4 v245, s[36:39], s60 offen offset:1024 lds
    v_mfma_f32_16x16x32_bf16 v[112:115], a[44:47], a[0:3], 0
    s_add_u32 m0, s74, 49152
    v_mfma_f32_16x16x32_bf16 v[116:119], a[44:47], a[4:7], 0
    s_add_u32 s61, s63, 9216
    v_mfma_f32_16x16x32_bf16 v[120:123], a[44:47], a[8:11], 0
    buffer_load_dwordx4 v231, s[44:47], s61 offen offset:0 sc1 lds
    v_mfma_f32_16x16x32_bf16 v[124:127], a[44:47], a[12:15], 0
    buffer_load_dwordx4 v232, s[44:47], s61 offen offset:1024 sc1 lds
    s_waitcnt lgkmcnt(0)
    v_mfma_f32_16x16x32_bf16 v[64:67], a[48:51], a[16:19], v[64:67]
    ds_read_b128 a[0:3], v24 offset:32768
    v_mfma_f32_16x16x32_bf16 v[68:71], a[48:51], a[20:23], v[68:71]
    ds_read_b128 a[4:7], v25 offset:32768
    v_mfma_f32_16x16x32_bf16 v[72:75], a[48:51], a[24:27], v[72:75]
    ds_read_b128 a[8:11], v26 offset:32768
    v_mfma_f32_16x16x32_bf16 v[76:79], a[48:51], a[28:31], v[76:79]
    ds_read_b128 a[12:15], v27 offset:32768
    v_mfma_f32_16x16x32_bf16 v[80:83], a[52:55], a[16:19], v[80:83]
    ds_read_b64_tr_b16 a[32:33], v12 offset:32768
    v_mfma_f32_16x16x32_bf16 v[84:87], a[52:55], a[20:23], v[84:87]
    ds_read_b64_tr_b16 a[34:35], v12 offset:34816
    v_mfma_f32_16x16x32_bf16 v[88:91], a[52:55], a[24:27], v[88:91]
    ds_read_b64_tr_b16 a[36:37], v13 offset:32768
    v_mfma_f32_16x16x32_bf16 v[92:95], a[52:55], a[28:31], v[92:95]
    ds_read_b64_tr_b16 a[38:39], v13 offset:34816
    v_mfma_f32_16x16x32_bf16 v[96:99], a[56:59], a[16:19], v[96:99]
    ds_read_b64_tr_b16 a[40:41], v14 offset:32768
    s_add_u32 m0, s75, 65536
    v_mfma_f32_16x16x32_bf16 v[100:103], a[56:59], a[20:23], v[100:103]
    ds_read_b64_tr_b16 a[42:43], v14 offset:34816
    s_add_u32 s60, s62, 327680
    v_mfma_f32_16x16x32_bf16 v[104:107], a[56:59], a[24:27], v[104:107]
    ds_read_b64_tr_b16 a[44:45], v15 offset:32768
    buffer_load_dwordx4 v230, s[36:39], s60 offen offset:0 lds
    v_mfma_f32_16x16x32_bf16 v[108:111], a[56:59], a[28:31], v[108:111]
    ds_read_b64_tr_b16 a[46:47], v15 offset:34816
    buffer_load_dwordx4 v245, s[36:39], s60 offen offset:1024 lds
    v_mfma_f32_16x16x32_bf16 v[112:115], a[60:63], a[16:19], v[112:115]
    s_add_u32 m0, s74, 65536
    v_mfma_f32_16x16x32_bf16 v[116:119], a[60:63], a[20:23], v[116:119]
    s_add_u32 s61, s63, 10240
    v_mfma_f32_16x16x32_bf16 v[120:123], a[60:63], a[24:27], v[120:123]
    buffer_load_dwordx4 v231, s[44:47], s61 offen offset:0 sc1 lds
    v_mfma_f32_16x16x32_bf16 v[124:127], a[60:63], a[28:31], v[124:127]
    buffer_load_dwordx4 v232, s[44:47], s61 offen offset:1024 sc1 lds
    s_waitcnt vmcnt(24) lgkmcnt(0)
    s_barrier
    v_mfma_f32_16x16x32_bf16 v[64:67], a[32:35], a[0:3], v[64:67]
    ds_read_b128 a[16:19], v24 offset:49152
    v_mfma_f32_16x16x32_bf16 v[68:71], a[32:35], a[4:7], v[68:71]
    ds_read_b128 a[20:23], v25 offset:49152
    v_mfma_f32_16x16x32_bf16 v[72:75], a[32:35], a[8:11], v[72:75]
    ds_read_b128 a[24:27], v26 offset:49152
    v_mfma_f32_16x16x32_bf16 v[76:79], a[32:35], a[12:15], v[76:79]
    ds_read_b128 a[28:31], v27 offset:49152
    v_mfma_f32_16x16x32_bf16 v[80:83], a[36:39], a[0:3], v[80:83]
    ds_read_b64_tr_b16 a[48:49], v12 offset:49152
    v_mfma_f32_16x16x32_bf16 v[84:87], a[36:39], a[4:7], v[84:87]
    ds_read_b64_tr_b16 a[50:51], v12 offset:51200
    v_mfma_f32_16x16x32_bf16 v[88:91], a[36:39], a[8:11], v[88:91]
    ds_read_b64_tr_b16 a[52:53], v13 offset:49152
    v_mfma_f32_16x16x32_bf16 v[92:95], a[36:39], a[12:15], v[92:95]
    ds_read_b64_tr_b16 a[54:55], v13 offset:51200
    v_mfma_f32_16x16x32_bf16 v[96:99], a[40:43], a[0:3], v[96:99]
    ds_read_b64_tr_b16 a[56:57], v14 offset:49152
    s_add_u32 m0, s75, 81920
    v_mfma_f32_16x16x32_bf16 v[100:103], a[40:43], a[4:7], v[100:103]
    ds_read_b64_tr_b16 a[58:59], v14 offset:51200
    s_add_u32 s60, s62, 360448
    v_mfma_f32_16x16x32_bf16 v[104:107], a[40:43], a[8:11], v[104:107]
    ds_read_b64_tr_b16 a[60:61], v15 offset:49152
    buffer_load_dwordx4 v230, s[36:39], s60 offen offset:0 lds
    v_mfma_f32_16x16x32_bf16 v[108:111], a[40:43], a[12:15], v[108:111]
    ds_read_b64_tr_b16 a[62:63], v15 offset:51200
    buffer_load_dwordx4 v245, s[36:39], s60 offen offset:1024 lds
    v_mfma_f32_16x16x32_bf16 v[112:115], a[44:47], a[0:3], v[112:115]
    s_add_u32 m0, s74, 81920
    v_mfma_f32_16x16x32_bf16 v[116:119], a[44:47], a[4:7], v[116:119]
    s_add_u32 s61, s63, 11264
    v_mfma_f32_16x16x32_bf16 v[120:123], a[44:47], a[8:11], v[120:123]
    buffer_load_dwordx4 v231, s[44:47], s61 offen offset:0 sc1 lds
    v_mfma_f32_16x16x32_bf16 v[124:127], a[44:47], a[12:15], v[124:127]
    buffer_load_dwordx4 v232, s[44:47], s61 offen offset:1024 sc1 lds
    s_waitcnt lgkmcnt(0)
    v_mfma_f32_16x16x32_bf16 v[64:67], a[48:51], a[16:19], v[64:67]
    ds_read_b128 a[0:3], v28 offset:0
    v_mfma_f32_16x16x32_bf16 v[68:71], a[48:51], a[20:23], v[68:71]
    ds_read_b128 a[4:7], v29 offset:0
    v_mfma_f32_16x16x32_bf16 v[72:75], a[48:51], a[24:27], v[72:75]
    ds_read_b128 a[8:11], v30 offset:0
    v_mfma_f32_16x16x32_bf16 v[76:79], a[48:51], a[28:31], v[76:79]
    ds_read_b128 a[12:15], v31 offset:0
    v_mfma_f32_16x16x32_bf16 v[80:83], a[52:55], a[16:19], v[80:83]
    ds_read_b64_tr_b16 a[32:33], v16 offset:0
    v_mfma_f32_16x16x32_bf16 v[84:87], a[52:55], a[20:23], v[84:87]
    ds_read_b64_tr_b16 a[34:35], v16 offset:2048
    v_mfma_f32_16x16x32_bf16 v[88:91], a[52:55], a[24:27], v[88:91]
    ds_read_b64_tr_b16 a[36:37], v17 offset:0
    v_mfma_f32_16x16x32_bf16 v[92:95], a[52:55], a[28:31], v[92:95]
    ds_read_b64_tr_b16 a[38:39], v17 offset:2048
    v_mfma_f32_16x16x32_bf16 v[96:99], a[56:59], a[16:19], v[96:99]
    ds_read_b64_tr_b16 a[40:41], v18 offset:0
    s_add_u32 m0, s75, 98304
    v_mfma_f32_16x16x32_bf16 v[100:103], a[56:59], a[20:23], v[100:103]
    ds_read_b64_tr_b16 a[42:43], v18 offset:2048
    s_add_u32 s60, s62, 393216
    v_mfma_f32_16x16x32_bf16 v[104:107], a[56:59], a[24:27], v[104:107]
    ds_read_b64_tr_b16 a[44:45], v19 offset:0
    buffer_load_dwordx4 v230, s[36:39], s60 offen offset:0 lds
    v_mfma_f32_16x16x32_bf16 v[108:111], a[56:59], a[28:31], v[108:111]
    ds_read_b64_tr_b16 a[46:47], v19 offset:2048
    buffer_load_dwordx4 v245, s[36:39], s60 offen offset:1024 lds
    v_mfma_f32_16x16x32_bf16 v[112:115], a[60:63], a[16:19], v[112:115]
    s_add_u32 m0, s74, 98304
    v_mfma_f32_16x16x32_bf16 v[116:119], a[60:63], a[20:23], v[116:119]
    s_add_u32 s61, s63, 12288
    v_mfma_f32_16x16x32_bf16 v[120:123], a[60:63], a[24:27], v[120:123]
    buffer_load_dwordx4 v231, s[44:47], s61 offen offset:0 sc1 lds
    v_mfma_f32_16x16x32_bf16 v[124:127], a[60:63], a[28:31], v[124:127]
    buffer_load_dwordx4 v232, s[44:47], s61 offen offset:1024 sc1 lds
    s_waitcnt vmcnt(24) lgkmcnt(0)
    s_barrier
    v_mfma_f32_16x16x32_bf16 v[64:67], a[32:35], a[0:3], v[64:67]
    ds_read_b128 a[16:19], v28 offset:16384
    v_mfma_f32_16x16x32_bf16 v[68:71], a[32:35], a[4:7], v[68:71]
    ds_read_b128 a[20:23], v29 offset:16384
    v_mfma_f32_16x16x32_bf16 v[72:75], a[32:35], a[8:11], v[72:75]
    ds_read_b128 a[24:27], v30 offset:16384
    v_mfma_f32_16x16x32_bf16 v[76:79], a[32:35], a[12:15], v[76:79]
    ds_read_b128 a[28:31], v31 offset:16384
    v_mfma_f32_16x16x32_bf16 v[80:83], a[36:39], a[0:3], v[80:83]
    ds_read_b64_tr_b16 a[48:49], v16 offset:16384
    v_mfma_f32_16x16x32_bf16 v[84:87], a[36:39], a[4:7], v[84:87]
    ds_read_b64_tr_b16 a[50:51], v16 offset:18432
    v_mfma_f32_16x16x32_bf16 v[88:91], a[36:39], a[8:11], v[88:91]
    ds_read_b64_tr_b16 a[52:53], v17 offset:16384
    v_mfma_f32_16x16x32_bf16 v[92:95], a[36:39], a[12:15], v[92:95]
    ds_read_b64_tr_b16 a[54:55], v17 offset:18432
    v_mfma_f32_16x16x32_bf16 v[96:99], a[40:43], a[0:3], v[96:99]
    ds_read_b64_tr_b16 a[56:57], v18 offset:16384
    s_add_u32 m0, s75, 114688
    v_mfma_f32_16x16x32_bf16 v[100:103], a[40:43], a[4:7], v[100:103]
    ds_read_b64_tr_b16 a[58:59], v18 offset:18432
    s_add_u32 s60, s62, 425984
    v_mfma_f32_16x16x32_bf16 v[104:107], a[40:43], a[8:11], v[104:107]
    ds_read_b64_tr_b16 a[60:61], v19 offset:16384
    buffer_load_dwordx4 v230, s[36:39], s60 offen offset:0 lds
    v_mfma_f32_16x16x32_bf16 v[108:111], a[40:43], a[12:15], v[108:111]
    ds_read_b64_tr_b16 a[62:63], v19 offset:18432
    buffer_load_dwordx4 v245, s[36:39], s60 offen offset:1024 lds
    v_mfma_f32_16x16x32_bf16 v[112:115], a[44:47], a[0:3], v[112:115]
    s_add_u32 m0, s74, 114688
    v_mfma_f32_16x16x32_bf16 v[116:119], a[44:47], a[4:7], v[116:119]
    s_add_u32 s61, s63, 13312
    v_mfma_f32_16x16x32_bf16 v[120:123], a[44:47], a[8:11], v[120:123]
    buffer_load_dwordx4 v231, s[44:47], s61 offen offset:0 sc1 lds
    v_mfma_f32_16x16x32_bf16 v[124:127], a[44:47], a[12:15], v[124:127]
    buffer_load_dwordx4 v232, s[44:47], s61 offen offset:1024 sc1 lds
    s_waitcnt lgkmcnt(0)
    v_mfma_f32_16x16x32_bf16 v[64:67], a[48:51], a[16:19], v[64:67]
    ds_read_b128 a[0:3], v20 offset:0
    v_mfma_f32_16x16x32_bf16 v[68:71], a[48:51], a[20:23], v[68:71]
    ds_read_b128 a[4:7], v21 offset:0
    v_mfma_f32_16x16x32_bf16 v[72:75], a[48:51], a[24:27], v[72:75]
    ds_read_b128 a[8:11], v22 offset:0
    v_mfma_f32_16x16x32_bf16 v[76:79], a[48:51], a[28:31], v[76:79]
    ds_read_b128 a[12:15], v23 offset:0
    v_mfma_f32_16x16x32_bf16 v[80:83], a[52:55], a[16:19], v[80:83]
    ds_read_b64_tr_b16 a[32:33], v8 offset:0
    v_mfma_f32_16x16x32_bf16 v[84:87], a[52:55], a[20:23], v[84:87]
    ds_read_b64_tr_b16 a[34:35], v8 offset:2048
    v_mfma_f32_16x16x32_bf16 v[88:91], a[52:55], a[24:27], v[88:91]
    ds_read_b64_tr_b16 a[36:37], v9 offset:0
    v_mfma_f32_16x16x32_bf16 v[92:95], a[52:55], a[28:31], v[92:95]
    ds_read_b64_tr_b16 a[38:39], v9 offset:2048
    v_mfma_f32_16x16x32_bf16 v[96:99], a[56:59], a[16:19], v[96:99]
    ds_read_b64_tr_b16 a[40:41], v10 offset:0
    s_add_u32 m0, s75, 131072
    v_mfma_f32_16x16x32_bf16 v[100:103], a[56:59], a[20:23], v[100:103]
    ds_read_b64_tr_b16 a[42:43], v10 offset:2048
    s_add_u32 s60, s62, 458752
    v_mfma_f32_16x16x32_bf16 v[104:107], a[56:59], a[24:27], v[104:107]
    ds_read_b64_tr_b16 a[44:45], v11 offset:0
    buffer_load_dwordx4 v230, s[36:39], s60 offen offset:0 lds
    v_mfma_f32_16x16x32_bf16 v[108:111], a[56:59], a[28:31], v[108:111]
    ds_read_b64_tr_b16 a[46:47], v11 offset:2048
    buffer_load_dwordx4 v245, s[36:39], s60 offen offset:1024 lds
    v_mfma_f32_16x16x32_bf16 v[112:115], a[60:63], a[16:19], v[112:115]
    s_add_u32 m0, s74, 131072
    v_mfma_f32_16x16x32_bf16 v[116:119], a[60:63], a[20:23], v[116:119]
    s_add_u32 s61, s63, 14336
    v_mfma_f32_16x16x32_bf16 v[120:123], a[60:63], a[24:27], v[120:123]
    buffer_load_dwordx4 v231, s[44:47], s61 offen offset:0 sc1 lds
    v_mfma_f32_16x16x32_bf16 v[124:127], a[60:63], a[28:31], v[124:127]
    buffer_load_dwordx4 v232, s[44:47], s61 offen offset:1024 sc1 lds
    s_waitcnt vmcnt(24) lgkmcnt(0)
    s_barrier
    v_mfma_f32_16x16x32_bf16 v[64:67], a[32:35], a[0:3], v[64:67]
    ds_read_b128 a[16:19], v20 offset:16384
    v_mfma_f32_16x16x32_bf16 v[68:71], a[32:35], a[4:7], v[68:71]
    ds_read_b128 a[20:23], v21 offset:16384
    v_mfma_f32_16x16x32_bf16 v[72:75], a[32:35], a[8:11], v[72:75]
    ds_read_b128 a[24:27], v22 offset:16384
    v_mfma_f32_16x16x32_bf16 v[76:79], a[32:35], a[12:15], v[76:79]
    ds_read_b128 a[28:31], v23 offset:16384
    v_mfma_f32_16x16x32_bf16 v[80:83], a[36:39], a[0:3], v[80:83]
    ds_read_b64_tr_b16 a[48:49], v8 offset:16384
    v_mfma_f32_16x16x32_bf16 v[84:87], a[36:39], a[4:7], v[84:87]
    ds_read_b64_tr_b16 a[50:51], v8 offset:18432
    v_mfma_f32_16x16x32_bf16 v[88:91], a[36:39], a[8:11], v[88:91]
    ds_read_b64_tr_b16 a[52:53], v9 offset:16384
    v_mfma_f32_16x16x32_bf16 v[92:95], a[36:39], a[12:15], v[92:95]
    ds_read_b64_tr_b16 a[54:55], v9 offset:18432
    v_mfma_f32_16x16x32_bf16 v[96:99], a[40:43], a[0:3], v[96:99]
    ds_read_b64_tr_b16 a[56:57], v10 offset:16384
    s_add_u32 m0, s75, 147456
    v_mfma_f32_16x16x32_bf16 v[100:103], a[40:43], a[4:7], v[100:103]
    ds_read_b64_tr_b16 a[58:59], v10 offset:18432
    s_add_u32 s60, s62, 491520
    v_mfma_f32_16x16x32_bf16 v[104:107], a[40:43], a[8:11], v[104:107]
    ds_read_b64_tr_b16 a[60:61], v11 offset:16384
    buffer_load_dwordx4 v230, s[36:39], s60 offen offset:0 lds
    v_mfma_f32_16x16x32_bf16 v[108:111], a[40:43], a[12:15], v[108:111]
    ds_read_b64_tr_b16 a[62:63], v11 offset:18432
    buffer_load_dwordx4 v245, s[36:39], s60 offen offset:1024 lds
    v_mfma_f32_16x16x32_bf16 v[112:115], a[44:47], a[0:3], v[112:115]
    s_add_u32 m0, s74, 147456
    v_mfma_f32_16x16x32_bf16 v[116:119], a[44:47], a[4:7], v[116:119]
    s_add_u32 s61, s63, 15360
    v_mfma_f32_16x16x32_bf16 v[120:123], a[44:47], a[8:11], v[120:123]
    buffer_load_dwordx4 v231, s[44:47], s61 offen offset:0 sc1 lds
    v_mfma_f32_16x16x32_bf16 v[124:127], a[44:47], a[12:15], v[124:127]
    buffer_load_dwordx4 v232, s[44:47], s61 offen offset:1024 sc1 lds
    s_waitcnt lgkmcnt(0)
    v_mfma_f32_16x16x32_bf16 v[64:67], a[48:51], a[16:19], v[64:67]
    ds_read_b128 a[0:3], v20 offset:32768
    v_mfma_f32_16x16x32_bf16 v[68:71], a[48:51], a[20:23], v[68:71]
    ds_read_b128 a[4:7], v21 offset:32768
    v_mfma_f32_16x16x32_bf16 v[72:75], a[48:51], a[24:27], v[72:75]
    ds_read_b128 a[8:11], v22 offset:32768
    v_mfma_f32_16x16x32_bf16 v[76:79], a[48:51], a[28:31], v[76:79]
    ds_read_b128 a[12:15], v23 offset:32768
    v_mfma_f32_16x16x32_bf16 v[80:83], a[52:55], a[16:19], v[80:83]
    ds_read_b64_tr_b16 a[32:33], v8 offset:32768
    v_mfma_f32_16x16x32_bf16 v[84:87], a[52:55], a[20:23], v[84:87]
    ds_read_b64_tr_b16 a[34:35], v8 offset:34816
    v_mfma_f32_16x16x32_bf16 v[88:91], a[52:55], a[24:27], v[88:91]
    ds_read_b64_tr_b16 a[36:37], v9 offset:32768
    v_mfma_f32_16x16x32_bf16 v[92:95], a[52:55], a[28:31], v[92:95]
    ds_read_b64_tr_b16 a[38:39], v9 offset:34816
    v_mfma_f32_16x16x32_bf16 v[96:99], a[56:59], a[16:19], v[96:99]
    ds_read_b64_tr_b16 a[40:41], v10 offset:32768
    s_add_u32 m0, s75, 0
    v_mfma_f32_16x16x32_bf16 v[100:103], a[56:59], a[20:23], v[100:103]
    ds_read_b64_tr_b16 a[42:43], v10 offset:34816
    s_add_u32 s60, s62, 524288
    v_mfma_f32_16x16x32_bf16 v[104:107], a[56:59], a[24:27], v[104:107]
    ds_read_b64_tr_b16 a[44:45], v11 offset:32768
    buffer_load_dwordx4 v230, s[36:39], s60 offen offset:0 lds
    v_mfma_f32_16x16x32_bf16 v[108:111], a[56:59], a[28:31], v[108:111]
    ds_read_b64_tr_b16 a[46:47], v11 offset:34816
    buffer_load_dwordx4 v245, s[36:39], s60 offen offset:1024 lds
    v_mfma_f32_16x16x32_bf16 v[112:115], a[60:63], a[16:19], v[112:115]
    s_add_u32 m0, s74, 0
    v_mfma_f32_16x16x32_bf16 v[116:119], a[60:63], a[20:23], v[116:119]
    s_add_u32 s61, s63, 16384
    v_mfma_f32_16x16x32_bf16 v[120:123], a[60:63], a[24:27], v[120:123]
    buffer_load_dwordx4 v231, s[44:47], s61 offen offset:0 sc1 lds
    v_mfma_f32_16x16x32_bf16 v[124:127], a[60:63], a[28:31], v[124:127]
    buffer_load_dwordx4 v232, s[44:47], s61 offen offset:1024 sc1 lds
    s_waitcnt vmcnt(24) lgkmcnt(0)
    s_barrier
    v_mfma_f32_16x16x32_bf16 v[64:67], a[32:35], a[0:3], v[64:67]
    ds_read_b128 a[16:19], v20 offset:49152
    v_mfma_f32_16x16x32_bf16 v[68:71], a[32:35], a[4:7], v[68:71]
    ds_read_b128 a[20:23], v21 offset:49152
    v_mfma_f32_16x16x32_bf16 v[72:75], a[32:35], a[8:11], v[72:75]
    ds_read_b128 a[24:27], v22 offset:49152
    v_mfma_f32_16x16x32_bf16 v[76:79], a[32:35], a[12:15], v[76:79]
    ds_read_b128 a[28:31], v23 offset:49152
    v_mfma_f32_16x16x32_bf16 v[80:83], a[36:39], a[0:3], v[80:83]
    ds_read_b64_tr_b16 a[48:49], v8 offset:49152
    v_mfma_f32_16x16x32_bf16 v[84:87], a[36:39], a[4:7], v[84:87]
    ds_read_b64_tr_b16 a[50:51], v8 offset:51200
    v_mfma_f32_16x16x32_bf16 v[88:91], a[36:39], a[8:11], v[88:91]
    ds_read_b64_tr_b16 a[52:53], v9 offset:49152
    v_mfma_f32_16x16x32_bf16 v[92:95], a[36:39], a[12:15], v[92:95]
    ds_read_b64_tr_b16 a[54:55], v9 offset:51200
    v_mfma_f32_16x16x32_bf16 v[96:99], a[40:43], a[0:3], v[96:99]
    ds_read_b64_tr_b16 a[56:57], v10 offset:49152
    s_add_u32 m0, s75, 16384
    v_mfma_f32_16x16x32_bf16 v[100:103], a[40:43], a[4:7], v[100:103]
    ds_read_b64_tr_b16 a[58:59], v10 offset:51200
    s_add_u32 s60, s62, 557056
    v_mfma_f32_16x16x32_bf16 v[104:107], a[40:43], a[8:11], v[104:107]
    ds_read_b64_tr_b16 a[60:61], v11 offset:49152
    buffer_load_dwordx4 v230, s[36:39], s60 offen offset:0 lds
    v_mfma_f32_16x16x32_bf16 v[108:111], a[40:43], a[12:15], v[108:111]
    ds_read_b64_tr_b16 a[62:63], v11 offset:51200
    buffer_load_dwordx4 v245, s[36:39], s60 offen offset:1024 lds
    v_mfma_f32_16x16x32_bf16 v[112:115], a[44:47], a[0:3], v[112:115]
    s_add_u32 m0, s74, 16384
    v_mfma_f32_16x16x32_bf16 v[116:119], a[44:47], a[4:7], v[116:119]
    s_add_u32 s61, s63, 17408
    v_mfma_f32_16x16x32_bf16 v[120:123], a[44:47], a[8:11], v[120:123]
    buffer_load_dwordx4 v231, s[44:47], s61 offen offset:0 sc1 lds
    v_mfma_f32_16x16x32_bf16 v[124:127], a[44:47], a[12:15], v[124:127]
    buffer_load_dwordx4 v232, s[44:47], s61 offen offset:1024 sc1 lds
    s_waitcnt lgkmcnt(0)
    v_mfma_f32_16x16x32_bf16 v[64:67], a[48:51], a[16:19], v[64:67]
    ds_read_b128 a[0:3], v24 offset:0
    v_mfma_f32_16x16x32_bf16 v[68:71], a[48:51], a[20:23], v[68:71]
    ds_read_b128 a[4:7], v25 offset:0
    v_mfma_f32_16x16x32_bf16 v[72:75], a[48:51], a[24:27], v[72:75]
    ds_read_b128 a[8:11], v26 offset:0
    v_mfma_f32_16x16x32_bf16 v[76:79], a[48:51], a[28:31], v[76:79]
    ds_read_b128 a[12:15], v27 offset:0
    v_mfma_f32_16x16x32_bf16 v[80:83], a[52:55], a[16:19], v[80:83]
    ds_read_b64_tr_b16 a[32:33], v12 offset:0
    v_mfma_f32_16x16x32_bf16 v[84:87], a[52:55], a[20:23], v[84:87]
    ds_read_b64_tr_b16 a[34:35], v12 offset:2048
    v_mfma_f32_16x16x32_bf16 v[88:91], a[52:55], a[24:27], v[88:91]
    ds_read_b64_tr_b16 a[36:37], v13 offset:0
    v_mfma_f32_16x16x32_bf16 v[92:95], a[52:55], a[28:31], v[92:95]
    ds_read_b64_tr_b16 a[38:39], v13 offset:2048
    v_mfma_f32_16x16x32_bf16 v[96:99], a[56:59], a[16:19], v[96:99]
    ds_read_b64_tr_b16 a[40:41], v14 offset:0
    s_add_u32 m0, s75, 32768
    v_mfma_f32_16x16x32_bf16 v[100:103], a[56:59], a[20:23], v[100:103]
    ds_read_b64_tr_b16 a[42:43], v14 offset:2048
    s_add_u32 s60, s62, 589824
    v_mfma_f32_16x16x32_bf16 v[104:107], a[56:59], a[24:27], v[104:107]
    ds_read_b64_tr_b16 a[44:45], v15 offset:0
    buffer_load_dwordx4 v230, s[36:39], s60 offen offset:0 lds
    v_mfma_f32_16x16x32_bf16 v[108:111], a[56:59], a[28:31], v[108:111]
    ds_read_b64_tr_b16 a[46:47], v15 offset:2048
    buffer_load_dwordx4 v245, s[36:39], s60 offen offset:1024 lds
    v_mfma_f32_16x16x32_bf16 v[112:115], a[60:63], a[16:19], v[112:115]
    s_add_u32 m0, s74, 32768
    v_mfma_f32_16x16x32_bf16 v[116:119], a[60:63], a[20:23], v[116:119]
    s_add_u32 s61, s63, 18432
    v_mfma_f32_16x16x32_bf16 v[120:123], a[60:63], a[24:27], v[120:123]
    buffer_load_dwordx4 v231, s[44:47], s61 offen offset:0 sc1 lds
    v_mfma_f32_16x16x32_bf16 v[124:127], a[60:63], a[28:31], v[124:127]
    buffer_load_dwordx4 v232, s[44:47], s61 offen offset:1024 sc1 lds
    s_waitcnt vmcnt(24) lgkmcnt(0)
    s_barrier
    v_mfma_f32_16x16x32_bf16 v[64:67], a[32:35], a[0:3], v[64:67]
    ds_read_b128 a[16:19], v24 offset:16384
    v_mfma_f32_16x16x32_bf16 v[68:71], a[32:35], a[4:7], v[68:71]
    ds_read_b128 a[20:23], v25 offset:16384
    v_mfma_f32_16x16x32_bf16 v[72:75], a[32:35], a[8:11], v[72:75]
    ds_read_b128 a[24:27], v26 offset:16384
    v_mfma_f32_16x16x32_bf16 v[76:79], a[32:35], a[12:15], v[76:79]
    ds_read_b128 a[28:31], v27 offset:16384
    v_mfma_f32_16x16x32_bf16 v[80:83], a[36:39], a[0:3], v[80:83]
    ds_read_b64_tr_b16 a[48:49], v12 offset:16384
    v_mfma_f32_16x16x32_bf16 v[84:87], a[36:39], a[4:7], v[84:87]
    ds_read_b64_tr_b16 a[50:51], v12 offset:18432
    v_mfma_f32_16x16x32_bf16 v[88:91], a[36:39], a[8:11], v[88:91]
    ds_read_b64_tr_b16 a[52:53], v13 offset:16384
    v_mfma_f32_16x16x32_bf16 v[92:95], a[36:39], a[12:15], v[92:95]
    ds_read_b64_tr_b16 a[54:55], v13 offset:18432
    v_mfma_f32_16x16x32_bf16 v[96:99], a[40:43], a[0:3], v[96:99]
    ds_read_b64_tr_b16 a[56:57], v14 offset:16384
    s_add_u32 m0, s75, 49152
    v_mfma_f32_16x16x32_bf16 v[100:103], a[40:43], a[4:7], v[100:103]
    ds_read_b64_tr_b16 a[58:59], v14 offset:18432
    s_add_u32 s60, s62, 622592
    v_mfma_f32_16x16x32_bf16 v[104:107], a[40:43], a[8:11], v[104:107]
    ds_read_b64_tr_b16 a[60:61], v15 offset:16384
    buffer_load_dwordx4 v230, s[36:39], s60 offen offset:0 lds
    v_mfma_f32_16x16x32_bf16 v[108:111], a[40:43], a[12:15], v[108:111]
    ds_read_b64_tr_b16 a[62:63], v15 offset:18432
    buffer_load_dwordx4 v245, s[36:39], s60 offen offset:1024 lds
    v_mfma_f32_16x16x32_bf16 v[112:115], a[44:47], a[0:3], v[112:115]
    s_add_u32 m0, s74, 49152
    v_mfma_f32_16x16x32_bf16 v[116:119], a[44:47], a[4:7], v[116:119]
    s_add_u32 s61, s63, 19456
    v_mfma_f32_16x16x32_bf16 v[120:123], a[44:47], a[8:11], v[120:123]
    buffer_load_dwordx4 v231, s[44:47], s61 offen offset:0 sc1 lds
    v_mfma_f32_16x16x32_bf16 v[124:127], a[44:47], a[12:15], v[124:127]
    buffer_load_dwordx4 v232, s[44:47], s61 offen offset:1024 sc1 lds
    s_waitcnt lgkmcnt(0)
    v_mfma_f32_16x16x32_bf16 v[64:67], a[48:51], a[16:19], v[64:67]
    ds_read_b128 a[0:3], v24 offset:32768
    v_mfma_f32_16x16x32_bf16 v[68:71], a[48:51], a[20:23], v[68:71]
    ds_read_b128 a[4:7], v25 offset:32768
    v_mfma_f32_16x16x32_bf16 v[72:75], a[48:51], a[24:27], v[72:75]
    ds_read_b128 a[8:11], v26 offset:32768
    v_mfma_f32_16x16x32_bf16 v[76:79], a[48:51], a[28:31], v[76:79]
    ds_read_b128 a[12:15], v27 offset:32768
    v_mfma_f32_16x16x32_bf16 v[80:83], a[52:55], a[16:19], v[80:83]
    ds_read_b64_tr_b16 a[32:33], v12 offset:32768
    v_mfma_f32_16x16x32_bf16 v[84:87], a[52:55], a[20:23], v[84:87]
    ds_read_b64_tr_b16 a[34:35], v12 offset:34816
    v_mfma_f32_16x16x32_bf16 v[88:91], a[52:55], a[24:27], v[88:91]
    ds_read_b64_tr_b16 a[36:37], v13 offset:32768
    v_mfma_f32_16x16x32_bf16 v[92:95], a[52:55], a[28:31], v[92:95]
    ds_read_b64_tr_b16 a[38:39], v13 offset:34816
    v_mfma_f32_16x16x32_bf16 v[96:99], a[56:59], a[16:19], v[96:99]
    ds_read_b64_tr_b16 a[40:41], v14 offset:32768
    s_add_u32 m0, s75, 65536
    v_mfma_f32_16x16x32_bf16 v[100:103], a[56:59], a[20:23], v[100:103]
    ds_read_b64_tr_b16 a[42:43], v14 offset:34816
    s_add_u32 s60, s62, 655360
    v_mfma_f32_16x16x32_bf16 v[104:107], a[56:59], a[24:27], v[104:107]
    ds_read_b64_tr_b16 a[44:45], v15 offset:32768
    buffer_load_dwordx4 v230, s[36:39], s60 offen offset:0 lds
    v_mfma_f32_16x16x32_bf16 v[108:111], a[56:59], a[28:31], v[108:111]
    ds_read_b64_tr_b16 a[46:47], v15 offset:34816
    buffer_load_dwordx4 v245, s[36:39], s60 offen offset:1024 lds
    v_mfma_f32_16x16x32_bf16 v[112:115], a[60:63], a[16:19], v[112:115]
    s_add_u32 m0, s74, 65536
    v_mfma_f32_16x16x32_bf16 v[116:119], a[60:63], a[20:23], v[116:119]
    s_add_u32 s61, s63, 20480
    v_mfma_f32_16x16x32_bf16 v[120:123], a[60:63], a[24:27], v[120:123]
    buffer_load_dwordx4 v231, s[44:47], s61 offen offset:0 sc1 lds
    v_mfma_f32_16x16x32_bf16 v[124:127], a[60:63], a[28:31], v[124:127]
    buffer_load_dwordx4 v232, s[44:47], s61 offen offset:1024 sc1 lds
    s_waitcnt vmcnt(24) lgkmcnt(0)
    s_barrier
    v_mfma_f32_16x16x32_bf16 v[64:67], a[32:35], a[0:3], v[64:67]
    ds_read_b128 a[16:19], v24 offset:49152
    v_mfma_f32_16x16x32_bf16 v[68:71], a[32:35], a[4:7], v[68:71]
    ds_read_b128 a[20:23], v25 offset:49152
    v_mfma_f32_16x16x32_bf16 v[72:75], a[32:35], a[8:11], v[72:75]
    ds_read_b128 a[24:27], v26 offset:49152
    v_mfma_f32_16x16x32_bf16 v[76:79], a[32:35], a[12:15], v[76:79]
    ds_read_b128 a[28:31], v27 offset:49152
    v_mfma_f32_16x16x32_bf16 v[80:83], a[36:39], a[0:3], v[80:83]
    ds_read_b64_tr_b16 a[48:49], v12 offset:49152
    v_mfma_f32_16x16x32_bf16 v[84:87], a[36:39], a[4:7], v[84:87]
    ds_read_b64_tr_b16 a[50:51], v12 offset:51200
    v_mfma_f32_16x16x32_bf16 v[88:91], a[36:39], a[8:11], v[88:91]
    ds_read_b64_tr_b16 a[52:53], v13 offset:49152
    v_mfma_f32_16x16x32_bf16 v[92:95], a[36:39], a[12:15], v[92:95]
    ds_read_b64_tr_b16 a[54:55], v13 offset:51200
    v_mfma_f32_16x16x32_bf16 v[96:99], a[40:43], a[0:3], v[96:99]
    ds_read_b64_tr_b16 a[56:57], v14 offset:49152
    s_add_u32 m0, s75, 81920
    v_mfma_f32_16x16x32_bf16 v[100:103], a[40:43], a[4:7], v[100:103]
    ds_read_b64_tr_b16 a[58:59], v14 offset:51200
    s_add_u32 s60, s62, 688128
    v_mfma_f32_16x16x32_bf16 v[104:107], a[40:43], a[8:11], v[104:107]
    ds_read_b64_tr_b16 a[60:61], v15 offset:49152
    buffer_load_dwordx4 v230, s[36:39], s60 offen offset:0 lds
    v_mfma_f32_16x16x32_bf16 v[108:111], a[40:43], a[12:15], v[108:111]
    ds_read_b64_tr_b16 a[62:63], v15 offset:51200
    buffer_load_dwordx4 v245, s[36:39], s60 offen offset:1024 lds
    v_mfma_f32_16x16x32_bf16 v[112:115], a[44:47], a[0:3], v[112:115]
    s_add_u32 m0, s74, 81920
    v_mfma_f32_16x16x32_bf16 v[116:119], a[44:47], a[4:7], v[116:119]
    s_add_u32 s61, s63, 21504
    v_mfma_f32_16x16x32_bf16 v[120:123], a[44:47], a[8:11], v[120:123]
    buffer_load_dwordx4 v231, s[44:47], s61 offen offset:0 sc1 lds
    v_mfma_f32_16x16x32_bf16 v[124:127], a[44:47], a[12:15], v[124:127]
    buffer_load_dwordx4 v232, s[44:47], s61 offen offset:1024 sc1 lds
    s_waitcnt lgkmcnt(0)
    v_mfma_f32_16x16x32_bf16 v[64:67], a[48:51], a[16:19], v[64:67]
    ds_read_b128 a[0:3], v28 offset:0
    v_mfma_f32_16x16x32_bf16 v[68:71], a[48:51], a[20:23], v[68:71]
    ds_read_b128 a[4:7], v29 offset:0
    v_mfma_f32_16x16x32_bf16 v[72:75], a[48:51], a[24:27], v[72:75]
    ds_read_b128 a[8:11], v30 offset:0
    v_mfma_f32_16x16x32_bf16 v[76:79], a[48:51], a[28:31], v[76:79]
    ds_read_b128 a[12:15], v31 offset:0
    v_mfma_f32_16x16x32_bf16 v[80:83], a[52:55], a[16:19], v[80:83]
    ds_read_b64_tr_b16 a[32:33], v16 offset:0
    v_mfma_f32_16x16x32_bf16 v[84:87], a[52:55], a[20:23], v[84:87]
    ds_read_b64_tr_b16 a[34:35], v16 offset:2048
    v_mfma_f32_16x16x32_bf16 v[88:91], a[52:55], a[24:27], v[88:91]
    ds_read_b64_tr_b16 a[36:37], v17 offset:0
    v_mfma_f32_16x16x32_bf16 v[92:95], a[52:55], a[28:31], v[92:95]
    ds_read_b64_tr_b16 a[38:39], v17 offset:2048
    v_mfma_f32_16x16x32_bf16 v[96:99], a[56:59], a[16:19], v[96:99]
    ds_read_b64_tr_b16 a[40:41], v18 offset:0
    s_add_u32 m0, s75, 98304
    v_mfma_f32_16x16x32_bf16 v[100:103], a[56:59], a[20:23], v[100:103]
    ds_read_b64_tr_b16 a[42:43], v18 offset:2048
    s_add_u32 s60, s62, 720896
    v_mfma_f32_16x16x32_bf16 v[104:107], a[56:59], a[24:27], v[104:107]
    ds_read_b64_tr_b16 a[44:45], v19 offset:0
    buffer_load_dwordx4 v230, s[36:39], s60 offen offset:0 lds
    v_mfma_f32_16x16x32_bf16 v[108:111], a[56:59], a[28:31], v[108:111]
    ds_read_b64_tr_b16 a[46:47], v19 offset:2048
    buffer_load_dwordx4 v245, s[36:39], s60 offen offset:1024 lds
    v_mfma_f32_16x16x32_bf16 v[112:115], a[60:63], a[16:19], v[112:115]
    s_add_u32 m0, s74, 98304
    v_mfma_f32_16x16x32_bf16 v[116:119], a[60:63], a[20:23], v[116:119]
    s_add_u32 s61, s63, 22528
    v_mfma_f32_16x16x32_bf16 v[120:123], a[60:63], a[24:27], v[120:123]
    buffer_load_dwordx4 v231, s[44:47], s61 offen offset:0 sc1 lds
    v_mfma_f32_16x16x32_bf16 v[124:127], a[60:63], a[28:31], v[124:127]
    buffer_load_dwordx4 v232, s[44:47], s61 offen offset:1024 sc1 lds
    s_waitcnt vmcnt(24) lgkmcnt(0)
    s_barrier
    v_mfma_f32_16x16x32_bf16 v[64:67], a[32:35], a[0:3], v[64:67]
    ds_read_b128 a[16:19], v28 offset:16384
    v_mfma_f32_16x16x32_bf16 v[68:71], a[32:35], a[4:7], v[68:71]
    ds_read_b128 a[20:23], v29 offset:16384
    v_mfma_f32_16x16x32_bf16 v[72:75], a[32:35], a[8:11], v[72:75]
    ds_read_b128 a[24:27], v30 offset:16384
    v_mfma_f32_16x16x32_bf16 v[76:79], a[32:35], a[12:15], v[76:79]
    ds_read_b128 a[28:31], v31 offset:16384
    v_mfma_f32_16x16x32_bf16 v[80:83], a[36:39], a[0:3], v[80:83]
    ds_read_b64_tr_b16 a[48:49], v16 offset:16384
    v_mfma_f32_16x16x32_bf16 v[84:87], a[36:39], a[4:7], v[84:87]
    ds_read_b64_tr_b16 a[50:51], v16 offset:18432
    v_mfma_f32_16x16x32_bf16 v[88:91], a[36:39], a[8:11], v[88:91]
    ds_read_b64_tr_b16 a[52:53], v17 offset:16384
    v_mfma_f32_16x16x32_bf16 v[92:95], a[36:39], a[12:15], v[92:95]
    ds_read_b64_tr_b16 a[54:55], v17 offset:18432
    v_mfma_f32_16x16x32_bf16 v[96:99], a[40:43], a[0:3], v[96:99]
    ds_read_b64_tr_b16 a[56:57], v18 offset:16384
    s_add_u32 m0, s75, 114688
    v_mfma_f32_16x16x32_bf16 v[100:103], a[40:43], a[4:7], v[100:103]
    ds_read_b64_tr_b16 a[58:59], v18 offset:18432
    s_add_u32 s60, s62, 753664
    v_mfma_f32_16x16x32_bf16 v[104:107], a[40:43], a[8:11], v[104:107]
    ds_read_b64_tr_b16 a[60:61], v19 offset:16384
    buffer_load_dwordx4 v230, s[36:39], s60 offen offset:0 lds
    v_mfma_f32_16x16x32_bf16 v[108:111], a[40:43], a[12:15], v[108:111]
    ds_read_b64_tr_b16 a[62:63], v19 offset:18432
    buffer_load_dwordx4 v245, s[36:39], s60 offen offset:1024 lds
    v_mfma_f32_16x16x32_bf16 v[112:115], a[44:47], a[0:3], v[112:115]
    s_add_u32 m0, s74, 114688
    v_mfma_f32_16x16x32_bf16 v[116:119], a[44:47], a[4:7], v[116:119]
    s_add_u32 s61, s63, 23552
    v_mfma_f32_16x16x32_bf16 v[120:123], a[44:47], a[8:11], v[120:123]
    buffer_load_dwordx4 v231, s[44:47], s61 offen offset:0 sc1 lds
    v_mfma_f32_16x16x32_bf16 v[124:127], a[44:47], a[12:15], v[124:127]
    buffer_load_dwordx4 v232, s[44:47], s61 offen offset:1024 sc1 lds
    s_waitcnt lgkmcnt(0)
    v_mfma_f32_16x16x32_bf16 v[64:67], a[48:51], a[16:19], v[64:67]
    ds_read_b128 a[0:3], v20 offset:0
    v_mfma_f32_16x16x32_bf16 v[68:71], a[48:51], a[20:23], v[68:71]
    ds_read_b128 a[4:7], v21 offset:0
    v_mfma_f32_16x16x32_bf16 v[72:75], a[48:51], a[24:27], v[72:75]
    ds_read_b128 a[8:11], v22 offset:0
    v_mfma_f32_16x16x32_bf16 v[76:79], a[48:51], a[28:31], v[76:79]
    ds_read_b128 a[12:15], v23 offset:0
    v_mfma_f32_16x16x32_bf16 v[80:83], a[52:55], a[16:19], v[80:83]
    ds_read_b64_tr_b16 a[32:33], v8 offset:0
    v_mfma_f32_16x16x32_bf16 v[84:87], a[52:55], a[20:23], v[84:87]
    ds_read_b64_tr_b16 a[34:35], v8 offset:2048
    v_mfma_f32_16x16x32_bf16 v[88:91], a[52:55], a[24:27], v[88:91]
    ds_read_b64_tr_b16 a[36:37], v9 offset:0
    v_mfma_f32_16x16x32_bf16 v[92:95], a[52:55], a[28:31], v[92:95]
    ds_read_b64_tr_b16 a[38:39], v9 offset:2048
    v_mfma_f32_16x16x32_bf16 v[96:99], a[56:59], a[16:19], v[96:99]
    ds_read_b64_tr_b16 a[40:41], v10 offset:0
    s_add_u32 m0, s75, 131072
    v_mfma_f32_16x16x32_bf16 v[100:103], a[56:59], a[20:23], v[100:103]
    ds_read_b64_tr_b16 a[42:43], v10 offset:2048
    s_add_u32 s60, s62, 786432
    v_mfma_f32_16x16x32_bf16 v[104:107], a[56:59], a[24:27], v[104:107]
    ds_read_b64_tr_b16 a[44:45], v11 offset:0
    buffer_load_dwordx4 v230, s[36:39], s60 offen offset:0 lds
    v_mfma_f32_16x16x32_bf16 v[108:111], a[56:59], a[28:31], v[108:111]
    ds_read_b64_tr_b16 a[46:47], v11 offset:2048
    buffer_load_dwordx4 v245, s[36:39], s60 offen offset:1024 lds
    v_mfma_f32_16x16x32_bf16 v[112:115], a[60:63], a[16:19], v[112:115]
    s_add_u32 m0, s74, 131072
    v_mfma_f32_16x16x32_bf16 v[116:119], a[60:63], a[20:23], v[116:119]
    s_add_u32 s61, s63, 24576
    v_mfma_f32_16x16x32_bf16 v[120:123], a[60:63], a[24:27], v[120:123]
    buffer_load_dwordx4 v231, s[44:47], s61 offen offset:0 sc1 lds
    v_mfma_f32_16x16x32_bf16 v[124:127], a[60:63], a[28:31], v[124:127]
    buffer_load_dwordx4 v232, s[44:47], s61 offen offset:1024 sc1 lds
    s_waitcnt vmcnt(24) lgkmcnt(0)
    s_barrier
    v_mfma_f32_16x16x32_bf16 v[64:67], a[32:35], a[0:3], v[64:67]
    ds_read_b128 a[16:19], v20 offset:16384
    v_mfma_f32_16x16x32_bf16 v[68:71], a[32:35], a[4:7], v[68:71]
    ds_read_b128 a[20:23], v21 offset:16384
    v_mfma_f32_16x16x32_bf16 v[72:75], a[32:35], a[8:11], v[72:75]
    ds_read_b128 a[24:27], v22 offset:16384
    v_mfma_f32_16x16x32_bf16 v[76:79], a[32:35], a[12:15], v[76:79]
    ds_read_b128 a[28:31], v23 offset:16384
    v_mfma_f32_16x16x32_bf16 v[80:83], a[36:39], a[0:3], v[80:83]
    ds_read_b64_tr_b16 a[48:49], v8 offset:16384
    v_mfma_f32_16x16x32_bf16 v[84:87], a[36:39], a[4:7], v[84:87]
    ds_read_b64_tr_b16 a[50:51], v8 offset:18432
    v_mfma_f32_16x16x32_bf16 v[88:91], a[36:39], a[8:11], v[88:91]
    ds_read_b64_tr_b16 a[52:53], v9 offset:16384
    v_mfma_f32_16x16x32_bf16 v[92:95], a[36:39], a[12:15], v[92:95]
    ds_read_b64_tr_b16 a[54:55], v9 offset:18432
    v_mfma_f32_16x16x32_bf16 v[96:99], a[40:43], a[0:3], v[96:99]
    ds_read_b64_tr_b16 a[56:57], v10 offset:16384
    s_add_u32 m0, s75, 147456
    v_mfma_f32_16x16x32_bf16 v[100:103], a[40:43], a[4:7], v[100:103]
    ds_read_b64_tr_b16 a[58:59], v10 offset:18432
    s_add_u32 s60, s62, 819200
    v_mfma_f32_16x16x32_bf16 v[104:107], a[40:43], a[8:11], v[104:107]
    ds_read_b64_tr_b16 a[60:61], v11 offset:16384
    buffer_load_dwordx4 v230, s[36:39], s60 offen offset:0 lds
    v_mfma_f32_16x16x32_bf16 v[108:111], a[40:43], a[12:15], v[108:111]
    ds_read_b64_tr_b16 a[62:63], v11 offset:18432
    buffer_load_dwordx4 v245, s[36:39], s60 offen offset:1024 lds
    v_mfma_f32_16x16x32_bf16 v[112:115], a[44:47], a[0:3], v[112:115]
    s_add_u32 m0, s74, 147456
    v_mfma_f32_16x16x32_bf16 v[116:119], a[44:47], a[4:7], v[116:119]
    s_add_u32 s61, s63, 25600
    v_mfma_f32_16x16x32_bf16 v[120:123], a[44:47], a[8:11], v[120:123]
    buffer_load_dwordx4 v231, s[44:47], s61 offen offset:0 sc1 lds
    v_mfma_f32_16x16x32_bf16 v[124:127], a[44:47], a[12:15], v[124:127]
    buffer_load_dwordx4 v232, s[44:47], s61 offen offset:1024 sc1 lds
    s_waitcnt lgkmcnt(0)
    v_mfma_f32_16x16x32_bf16 v[64:67], a[48:51], a[16:19], v[64:67]
    ds_read_b128 a[0:3], v20 offset:32768
    v_mfma_f32_16x16x32_bf16 v[68:71], a[48:51], a[20:23], v[68:71]
    ds_read_b128 a[4:7], v21 offset:32768
    v_mfma_f32_16x16x32_bf16 v[72:75], a[48:51], a[24:27], v[72:75]
    ds_read_b128 a[8:11], v22 offset:32768
    v_mfma_f32_16x16x32_bf16 v[76:79], a[48:51], a[28:31], v[76:79]
    ds_read_b128 a[12:15], v23 offset:32768
    v_mfma_f32_16x16x32_bf16 v[80:83], a[52:55], a[16:19], v[80:83]
    ds_read_b64_tr_b16 a[32:33], v8 offset:32768
    v_mfma_f32_16x16x32_bf16 v[84:87], a[52:55], a[20:23], v[84:87]
    ds_read_b64_tr_b16 a[34:35], v8 offset:34816
    v_mfma_f32_16x16x32_bf16 v[88:91], a[52:55], a[24:27], v[88:91]
    ds_read_b64_tr_b16 a[36:37], v9 offset:32768
    v_mfma_f32_16x16x32_bf16 v[92:95], a[52:55], a[28:31], v[92:95]
    ds_read_b64_tr_b16 a[38:39], v9 offset:34816
    v_mfma_f32_16x16x32_bf16 v[96:99], a[56:59], a[16:19], v[96:99]
    ds_read_b64_tr_b16 a[40:41], v10 offset:32768
    s_add_u32 m0, s75, 0
    v_mfma_f32_16x16x32_bf16 v[100:103], a[56:59], a[20:23], v[100:103]
    ds_read_b64_tr_b16 a[42:43], v10 offset:34816
    s_add_u32 s60, s62, 851968
    v_mfma_f32_16x16x32_bf16 v[104:107], a[56:59], a[24:27], v[104:107]
    ds_read_b64_tr_b16 a[44:45], v11 offset:32768
    buffer_load_dwordx4 v230, s[36:39], s60 offen offset:0 lds
    v_mfma_f32_16x16x32_bf16 v[108:111], a[56:59], a[28:31], v[108:111]
    ds_read_b64_tr_b16 a[46:47], v11 offset:34816
    buffer_load_dwordx4 v245, s[36:39], s60 offen offset:1024 lds
    v_mfma_f32_16x16x32_bf16 v[112:115], a[60:63], a[16:19], v[112:115]
    s_add_u32 m0, s74, 0
    v_mfma_f32_16x16x32_bf16 v[116:119], a[60:63], a[20:23], v[116:119]
    s_add_u32 s61, s63, 26624
    v_mfma_f32_16x16x32_bf16 v[120:123], a[60:63], a[24:27], v[120:123]
    buffer_load_dwordx4 v231, s[44:47], s61 offen offset:0 sc1 lds
    v_mfma_f32_16x16x32_bf16 v[124:127], a[60:63], a[28:31], v[124:127]
    buffer_load_dwordx4 v232, s[44:47], s61 offen offset:1024 sc1 lds
    s_waitcnt vmcnt(24) lgkmcnt(0)
    s_barrier
    v_mfma_f32_16x16x32_bf16 v[64:67], a[32:35], a[0:3], v[64:67]
    ds_read_b128 a[16:19], v20 offset:49152
    v_mfma_f32_16x16x32_bf16 v[68:71], a[32:35], a[4:7], v[68:71]
    ds_read_b128 a[20:23], v21 offset:49152
    v_mfma_f32_16x16x32_bf16 v[72:75], a[32:35], a[8:11], v[72:75]
    ds_read_b128 a[24:27], v22 offset:49152
    v_mfma_f32_16x16x32_bf16 v[76:79], a[32:35], a[12:15], v[76:79]
    ds_read_b128 a[28:31], v23 offset:49152
    v_mfma_f32_16x16x32_bf16 v[80:83], a[36:39], a[0:3], v[80:83]
    ds_read_b64_tr_b16 a[48:49], v8 offset:49152
    v_mfma_f32_16x16x32_bf16 v[84:87], a[36:39], a[4:7], v[84:87]
    ds_read_b64_tr_b16 a[50:51], v8 offset:51200
    v_mfma_f32_16x16x32_bf16 v[88:91], a[36:39], a[8:11], v[88:91]
    ds_read_b64_tr_b16 a[52:53], v9 offset:49152
    v_mfma_f32_16x16x32_bf16 v[92:95], a[36:39], a[12:15], v[92:95]
    ds_read_b64_tr_b16 a[54:55], v9 offset:51200
    v_mfma_f32_16x16x32_bf16 v[96:99], a[40:43], a[0:3], v[96:99]
    ds_read_b64_tr_b16 a[56:57], v10 offset:49152
    s_add_u32 m0, s75, 16384
    v_mfma_f32_16x16x32_bf16 v[100:103], a[40:43], a[4:7], v[100:103]
    ds_read_b64_tr_b16 a[58:59], v10 offset:51200
    s_add_u32 s60, s62, 884736
    v_mfma_f32_16x16x32_bf16 v[104:107], a[40:43], a[8:11], v[104:107]
    ds_read_b64_tr_b16 a[60:61], v11 offset:49152
    buffer_load_dwordx4 v230, s[36:39], s60 offen offset:0 lds
    v_mfma_f32_16x16x32_bf16 v[108:111], a[40:43], a[12:15], v[108:111]
    ds_read_b64_tr_b16 a[62:63], v11 offset:51200
    buffer_load_dwordx4 v245, s[36:39], s60 offen offset:1024 lds
    v_mfma_f32_16x16x32_bf16 v[112:115], a[44:47], a[0:3], v[112:115]
    s_add_u32 m0, s74, 16384
    v_mfma_f32_16x16x32_bf16 v[116:119], a[44:47], a[4:7], v[116:119]
    s_add_u32 s61, s63, 27648
    v_mfma_f32_16x16x32_bf16 v[120:123], a[44:47], a[8:11], v[120:123]
    buffer_load_dwordx4 v231, s[44:47], s61 offen offset:0 sc1 lds
    v_mfma_f32_16x16x32_bf16 v[124:127], a[44:47], a[12:15], v[124:127]
    buffer_load_dwordx4 v232, s[44:47], s61 offen offset:1024 sc1 lds
    s_waitcnt lgkmcnt(0)
    v_mfma_f32_16x16x32_bf16 v[64:67], a[48:51], a[16:19], v[64:67]
    ds_read_b128 a[0:3], v24 offset:0
    v_mfma_f32_16x16x32_bf16 v[68:71], a[48:51], a[20:23], v[68:71]
    ds_read_b128 a[4:7], v25 offset:0
    v_mfma_f32_16x16x32_bf16 v[72:75], a[48:51], a[24:27], v[72:75]
    ds_read_b128 a[8:11], v26 offset:0
    v_mfma_f32_16x16x32_bf16 v[76:79], a[48:51], a[28:31], v[76:79]
    ds_read_b128 a[12:15], v27 offset:0
    v_mfma_f32_16x16x32_bf16 v[80:83], a[52:55], a[16:19], v[80:83]
    ds_read_b64_tr_b16 a[32:33], v12 offset:0
    v_mfma_f32_16x16x32_bf16 v[84:87], a[52:55], a[20:23], v[84:87]
    ds_read_b64_tr_b16 a[34:35], v12 offset:2048
    v_mfma_f32_16x16x32_bf16 v[88:91], a[52:55], a[24:27], v[88:91]
    ds_read_b64_tr_b16 a[36:37], v13 offset:0
    v_mfma_f32_16x16x32_bf16 v[92:95], a[52:55], a[28:31], v[92:95]
    ds_read_b64_tr_b16 a[38:39], v13 offset:2048
    v_mfma_f32_16x16x32_bf16 v[96:99], a[56:59], a[16:19], v[96:99]
    ds_read_b64_tr_b16 a[40:41], v14 offset:0
    s_add_u32 m0, s75, 32768
    v_mfma_f32_16x16x32_bf16 v[100:103], a[56:59], a[20:23], v[100:103]
    ds_read_b64_tr_b16 a[42:43], v14 offset:2048
    s_add_u32 s60, s62, 917504
    v_mfma_f32_16x16x32_bf16 v[104:107], a[56:59], a[24:27], v[104:107]
    ds_read_b64_tr_b16 a[44:45], v15 offset:0
    buffer_load_dwordx4 v230, s[36:39], s60 offen offset:0 lds
    v_mfma_f32_16x16x32_bf16 v[108:111], a[56:59], a[28:31], v[108:111]
    ds_read_b64_tr_b16 a[46:47], v15 offset:2048
    buffer_load_dwordx4 v245, s[36:39], s60 offen offset:1024 lds
    v_mfma_f32_16x16x32_bf16 v[112:115], a[60:63], a[16:19], v[112:115]
    s_add_u32 m0, s74, 32768
    v_mfma_f32_16x16x32_bf16 v[116:119], a[60:63], a[20:23], v[116:119]
    s_add_u32 s61, s63, 28672
    v_mfma_f32_16x16x32_bf16 v[120:123], a[60:63], a[24:27], v[120:123]
    buffer_load_dwordx4 v231, s[44:47], s61 offen offset:0 sc1 lds
    v_mfma_f32_16x16x32_bf16 v[124:127], a[60:63], a[28:31], v[124:127]
    buffer_load_dwordx4 v232, s[44:47], s61 offen offset:1024 sc1 lds
    s_waitcnt vmcnt(24) lgkmcnt(0)
    s_barrier
    v_mfma_f32_16x16x32_bf16 v[64:67], a[32:35], a[0:3], v[64:67]
    ds_read_b128 a[16:19], v24 offset:16384
    v_mfma_f32_16x16x32_bf16 v[68:71], a[32:35], a[4:7], v[68:71]
    ds_read_b128 a[20:23], v25 offset:16384
    v_mfma_f32_16x16x32_bf16 v[72:75], a[32:35], a[8:11], v[72:75]
    ds_read_b128 a[24:27], v26 offset:16384
    v_mfma_f32_16x16x32_bf16 v[76:79], a[32:35], a[12:15], v[76:79]
    ds_read_b128 a[28:31], v27 offset:16384
    v_mfma_f32_16x16x32_bf16 v[80:83], a[36:39], a[0:3], v[80:83]
    ds_read_b64_tr_b16 a[48:49], v12 offset:16384
    v_mfma_f32_16x16x32_bf16 v[84:87], a[36:39], a[4:7], v[84:87]
    ds_read_b64_tr_b16 a[50:51], v12 offset:18432
    v_mfma_f32_16x16x32_bf16 v[88:91], a[36:39], a[8:11], v[88:91]
    ds_read_b64_tr_b16 a[52:53], v13 offset:16384
    v_mfma_f32_16x16x32_bf16 v[92:95], a[36:39], a[12:15], v[92:95]
    ds_read_b64_tr_b16 a[54:55], v13 offset:18432
    v_mfma_f32_16x16x32_bf16 v[96:99], a[40:43], a[0:3], v[96:99]
    ds_read_b64_tr_b16 a[56:57], v14 offset:16384
    s_add_u32 m0, s75, 49152
    v_mfma_f32_16x16x32_bf16 v[100:103], a[40:43], a[4:7], v[100:103]
    ds_read_b64_tr_b16 a[58:59], v14 offset:18432
    s_add_u32 s60, s62, 950272
    v_mfma_f32_16x16x32_bf16 v[104:107], a[40:43], a[8:11], v[104:107]
    ds_read_b64_tr_b16 a[60:61], v15 offset:16384
    buffer_load_dwordx4 v230, s[36:39], s60 offen offset:0 lds
    v_mfma_f32_16x16x32_bf16 v[108:111], a[40:43], a[12:15], v[108:111]
    ds_read_b64_tr_b16 a[62:63], v15 offset:18432
    buffer_load_dwordx4 v245, s[36:39], s60 offen offset:1024 lds
    v_mfma_f32_16x16x32_bf16 v[112:115], a[44:47], a[0:3], v[112:115]
    s_add_u32 m0, s74, 49152
    v_mfma_f32_16x16x32_bf16 v[116:119], a[44:47], a[4:7], v[116:119]
    s_add_u32 s61, s63, 29696
    v_mfma_f32_16x16x32_bf16 v[120:123], a[44:47], a[8:11], v[120:123]
    buffer_load_dwordx4 v231, s[44:47], s61 offen offset:0 sc1 lds
    v_mfma_f32_16x16x32_bf16 v[124:127], a[44:47], a[12:15], v[124:127]
    buffer_load_dwordx4 v232, s[44:47], s61 offen offset:1024 sc1 lds
    s_waitcnt lgkmcnt(0)
    v_mfma_f32_16x16x32_bf16 v[64:67], a[48:51], a[16:19], v[64:67]
    ds_read_b128 a[0:3], v24 offset:32768
    v_mfma_f32_16x16x32_bf16 v[68:71], a[48:51], a[20:23], v[68:71]
    ds_read_b128 a[4:7], v25 offset:32768
    v_mfma_f32_16x16x32_bf16 v[72:75], a[48:51], a[24:27], v[72:75]
    ds_read_b128 a[8:11], v26 offset:32768
    v_mfma_f32_16x16x32_bf16 v[76:79], a[48:51], a[28:31], v[76:79]
    ds_read_b128 a[12:15], v27 offset:32768
    v_mfma_f32_16x16x32_bf16 v[80:83], a[52:55], a[16:19], v[80:83]
    ds_read_b64_tr_b16 a[32:33], v12 offset:32768
    v_mfma_f32_16x16x32_bf16 v[84:87], a[52:55], a[20:23], v[84:87]
    ds_read_b64_tr_b16 a[34:35], v12 offset:34816
    v_mfma_f32_16x16x32_bf16 v[88:91], a[52:55], a[24:27], v[88:91]
    ds_read_b64_tr_b16 a[36:37], v13 offset:32768
    v_mfma_f32_16x16x32_bf16 v[92:95], a[52:55], a[28:31], v[92:95]
    ds_read_b64_tr_b16 a[38:39], v13 offset:34816
    v_mfma_f32_16x16x32_bf16 v[96:99], a[56:59], a[16:19], v[96:99]
    ds_read_b64_tr_b16 a[40:41], v14 offset:32768
    s_add_u32 m0, s75, 65536
    v_mfma_f32_16x16x32_bf16 v[100:103], a[56:59], a[20:23], v[100:103]
    ds_read_b64_tr_b16 a[42:43], v14 offset:34816
    s_add_u32 s60, s62, 983040
    v_mfma_f32_16x16x32_bf16 v[104:107], a[56:59], a[24:27], v[104:107]
    ds_read_b64_tr_b16 a[44:45], v15 offset:32768
    buffer_load_dwordx4 v230, s[36:39], s60 offen offset:0 lds
    v_mfma_f32_16x16x32_bf16 v[108:111], a[56:59], a[28:31], v[108:111]
    ds_read_b64_tr_b16 a[46:47], v15 offset:34816
    buffer_load_dwordx4 v245, s[36:39], s60 offen offset:1024 lds
    v_mfma_f32_16x16x32_bf16 v[112:115], a[60:63], a[16:19], v[112:115]
    s_add_u32 m0, s74, 65536
    v_mfma_f32_16x16x32_bf16 v[116:119], a[60:63], a[20:23], v[116:119]
    s_add_u32 s61, s63, 30720
    v_mfma_f32_16x16x32_bf16 v[120:123], a[60:63], a[24:27], v[120:123]
    buffer_load_dwordx4 v231, s[44:47], s61 offen offset:0 sc1 lds
    v_mfma_f32_16x16x32_bf16 v[124:127], a[60:63], a[28:31], v[124:127]
    buffer_load_dwordx4 v232, s[44:47], s61 offen offset:1024 sc1 lds
    s_waitcnt vmcnt(24) lgkmcnt(0)
    s_barrier
    v_mfma_f32_16x16x32_bf16 v[64:67], a[32:35], a[0:3], v[64:67]
    ds_read_b128 a[16:19], v24 offset:49152
    v_mfma_f32_16x16x32_bf16 v[68:71], a[32:35], a[4:7], v[68:71]
    ds_read_b128 a[20:23], v25 offset:49152
    v_mfma_f32_16x16x32_bf16 v[72:75], a[32:35], a[8:11], v[72:75]
    ds_read_b128 a[24:27], v26 offset:49152
    v_mfma_f32_16x16x32_bf16 v[76:79], a[32:35], a[12:15], v[76:79]
    ds_read_b128 a[28:31], v27 offset:49152
    v_mfma_f32_16x16x32_bf16 v[80:83], a[36:39], a[0:3], v[80:83]
    ds_read_b64_tr_b16 a[48:49], v12 offset:49152
    v_mfma_f32_16x16x32_bf16 v[84:87], a[36:39], a[4:7], v[84:87]
    ds_read_b64_tr_b16 a[50:51], v12 offset:51200
    v_mfma_f32_16x16x32_bf16 v[88:91], a[36:39], a[8:11], v[88:91]
    ds_read_b64_tr_b16 a[52:53], v13 offset:49152
    v_mfma_f32_16x16x32_bf16 v[92:95], a[36:39], a[12:15], v[92:95]
    ds_read_b64_tr_b16 a[54:55], v13 offset:51200
    v_mfma_f32_16x16x32_bf16 v[96:99], a[40:43], a[0:3], v[96:99]
    ds_read_b64_tr_b16 a[56:57], v14 offset:49152
    s_add_u32 m0, s75, 81920
    v_mfma_f32_16x16x32_bf16 v[100:103], a[40:43], a[4:7], v[100:103]
    ds_read_b64_tr_b16 a[58:59], v14 offset:51200
    s_add_u32 s60, s62, 1015808
    v_mfma_f32_16x16x32_bf16 v[104:107], a[40:43], a[8:11], v[104:107]
    ds_read_b64_tr_b16 a[60:61], v15 offset:49152
    buffer_load_dwordx4 v230, s[36:39], s60 offen offset:0 lds
    v_mfma_f32_16x16x32_bf16 v[108:111], a[40:43], a[12:15], v[108:111]
    ds_read_b64_tr_b16 a[62:63], v15 offset:51200
    buffer_load_dwordx4 v245, s[36:39], s60 offen offset:1024 lds
    v_mfma_f32_16x16x32_bf16 v[112:115], a[44:47], a[0:3], v[112:115]
    s_add_u32 m0, s74, 81920
    v_mfma_f32_16x16x32_bf16 v[116:119], a[44:47], a[4:7], v[116:119]
    s_add_u32 s61, s63, 31744
    v_mfma_f32_16x16x32_bf16 v[120:123], a[44:47], a[8:11], v[120:123]
    buffer_load_dwordx4 v231, s[44:47], s61 offen offset:0 sc1 lds
    v_mfma_f32_16x16x32_bf16 v[124:127], a[44:47], a[12:15], v[124:127]
    buffer_load_dwordx4 v232, s[44:47], s61 offen offset:1024 sc1 lds
    s_waitcnt lgkmcnt(0)
    v_mfma_f32_16x16x32_bf16 v[64:67], a[48:51], a[16:19], v[64:67]
    ds_read_b128 a[0:3], v28 offset:0
    v_mfma_f32_16x16x32_bf16 v[68:71], a[48:51], a[20:23], v[68:71]
    ds_read_b128 a[4:7], v29 offset:0
    v_mfma_f32_16x16x32_bf16 v[72:75], a[48:51], a[24:27], v[72:75]
    ds_read_b128 a[8:11], v30 offset:0
    v_mfma_f32_16x16x32_bf16 v[76:79], a[48:51], a[28:31], v[76:79]
    ds_read_b128 a[12:15], v31 offset:0
    v_mfma_f32_16x16x32_bf16 v[80:83], a[52:55], a[16:19], v[80:83]
    ds_read_b64_tr_b16 a[32:33], v16 offset:0
    v_mfma_f32_16x16x32_bf16 v[84:87], a[52:55], a[20:23], v[84:87]
    ds_read_b64_tr_b16 a[34:35], v16 offset:2048
    v_mfma_f32_16x16x32_bf16 v[88:91], a[52:55], a[24:27], v[88:91]
    ds_read_b64_tr_b16 a[36:37], v17 offset:0
    v_mfma_f32_16x16x32_bf16 v[92:95], a[52:55], a[28:31], v[92:95]
    ds_read_b64_tr_b16 a[38:39], v17 offset:2048
    v_mfma_f32_16x16x32_bf16 v[96:99], a[56:59], a[16:19], v[96:99]
    ds_read_b64_tr_b16 a[40:41], v18 offset:0
    v_mfma_f32_16x16x32_bf16 v[100:103], a[56:59], a[20:23], v[100:103]
    ds_read_b64_tr_b16 a[42:43], v18 offset:2048
    v_mfma_f32_16x16x32_bf16 v[104:107], a[56:59], a[24:27], v[104:107]
    ds_read_b64_tr_b16 a[44:45], v19 offset:0
    v_mfma_f32_16x16x32_bf16 v[108:111], a[56:59], a[28:31], v[108:111]
    ds_read_b64_tr_b16 a[46:47], v19 offset:2048
    v_mfma_f32_16x16x32_bf16 v[112:115], a[60:63], a[16:19], v[112:115]
    v_mfma_f32_16x16x32_bf16 v[116:119], a[60:63], a[20:23], v[116:119]
    v_mfma_f32_16x16x32_bf16 v[120:123], a[60:63], a[24:27], v[120:123]
    v_mfma_f32_16x16x32_bf16 v[124:127], a[60:63], a[28:31], v[124:127]
    s_waitcnt vmcnt(20) lgkmcnt(0)
    s_barrier
    v_mfma_f32_16x16x32_bf16 v[64:67], a[32:35], a[0:3], v[64:67]
    ds_read_b128 a[16:19], v28 offset:16384
    v_mfma_f32_16x16x32_bf16 v[68:71], a[32:35], a[4:7], v[68:71]
    ds_read_b128 a[20:23], v29 offset:16384
    v_mfma_f32_16x16x32_bf16 v[72:75], a[32:35], a[8:11], v[72:75]
    ds_read_b128 a[24:27], v30 offset:16384
    v_mfma_f32_16x16x32_bf16 v[76:79], a[32:35], a[12:15], v[76:79]
    ds_read_b128 a[28:31], v31 offset:16384
    v_mfma_f32_16x16x32_bf16 v[80:83], a[36:39], a[0:3], v[80:83]
    ds_read_b64_tr_b16 a[48:49], v16 offset:16384
    v_mfma_f32_16x16x32_bf16 v[84:87], a[36:39], a[4:7], v[84:87]
    ds_read_b64_tr_b16 a[50:51], v16 offset:18432
    v_mfma_f32_16x16x32_bf16 v[88:91], a[36:39], a[8:11], v[88:91]
    ds_read_b64_tr_b16 a[52:53], v17 offset:16384
    v_mfma_f32_16x16x32_bf16 v[92:95], a[36:39], a[12:15], v[92:95]
    ds_read_b64_tr_b16 a[54:55], v17 offset:18432
    v_mfma_f32_16x16x32_bf16 v[96:99], a[40:43], a[0:3], v[96:99]
    ds_read_b64_tr_b16 a[56:57], v18 offset:16384
    v_mfma_f32_16x16x32_bf16 v[100:103], a[40:43], a[4:7], v[100:103]
    ds_read_b64_tr_b16 a[58:59], v18 offset:18432
    v_mfma_f32_16x16x32_bf16 v[104:107], a[40:43], a[8:11], v[104:107]
    ds_read_b64_tr_b16 a[60:61], v19 offset:16384
    v_mfma_f32_16x16x32_bf16 v[108:111], a[40:43], a[12:15], v[108:111]
    ds_read_b64_tr_b16 a[62:63], v19 offset:18432
    v_mfma_f32_16x16x32_bf16 v[112:115], a[44:47], a[0:3], v[112:115]
    v_mfma_f32_16x16x32_bf16 v[116:119], a[44:47], a[4:7], v[116:119]
    v_mfma_f32_16x16x32_bf16 v[120:123], a[44:47], a[8:11], v[120:123]
    v_mfma_f32_16x16x32_bf16 v[124:127], a[44:47], a[12:15], v[124:127]
    s_waitcnt lgkmcnt(0)
    v_mfma_f32_16x16x32_bf16 v[64:67], a[48:51], a[16:19], v[64:67]
    ds_read_b128 a[0:3], v20 offset:0
    v_mfma_f32_16x16x32_bf16 v[68:71], a[48:51], a[20:23], v[68:71]
    ds_read_b128 a[4:7], v21 offset:0
    v_mfma_f32_16x16x32_bf16 v[72:75], a[48:51], a[24:27], v[72:75]
    ds_read_b128 a[8:11], v22 offset:0
    v_mfma_f32_16x16x32_bf16 v[76:79], a[48:51], a[28:31], v[76:79]
    ds_read_b128 a[12:15], v23 offset:0
    v_mfma_f32_16x16x32_bf16 v[80:83], a[52:55], a[16:19], v[80:83]
    ds_read_b64_tr_b16 a[32:33], v8 offset:0
    v_mfma_f32_16x16x32_bf16 v[84:87], a[52:55], a[20:23], v[84:87]
    ds_read_b64_tr_b16 a[34:35], v8 offset:2048
    v_mfma_f32_16x16x32_bf16 v[88:91], a[52:55], a[24:27], v[88:91]
    ds_read_b64_tr_b16 a[36:37], v9 offset:0
    v_mfma_f32_16x16x32_bf16 v[92:95], a[52:55], a[28:31], v[92:95]
    ds_read_b64_tr_b16 a[38:39], v9 offset:2048
    v_mfma_f32_16x16x32_bf16 v[96:99], a[56:59], a[16:19], v[96:99]
    ds_read_b64_tr_b16 a[40:41], v10 offset:0
    v_mfma_f32_16x16x32_bf16 v[100:103], a[56:59], a[20:23], v[100:103]
    ds_read_b64_tr_b16 a[42:43], v10 offset:2048
    v_mfma_f32_16x16x32_bf16 v[104:107], a[56:59], a[24:27], v[104:107]
    ds_read_b64_tr_b16 a[44:45], v11 offset:0
    v_mfma_f32_16x16x32_bf16 v[108:111], a[56:59], a[28:31], v[108:111]
    ds_read_b64_tr_b16 a[46:47], v11 offset:2048
    v_mfma_f32_16x16x32_bf16 v[112:115], a[60:63], a[16:19], v[112:115]
    v_mfma_f32_16x16x32_bf16 v[116:119], a[60:63], a[20:23], v[116:119]
    v_mfma_f32_16x16x32_bf16 v[120:123], a[60:63], a[24:27], v[120:123]
    v_mfma_f32_16x16x32_bf16 v[124:127], a[60:63], a[28:31], v[124:127]
    s_waitcnt vmcnt(12) lgkmcnt(0)
    s_barrier
    v_mfma_f32_16x16x32_bf16 v[64:67], a[32:35], a[0:3], v[64:67]
    ds_read_b128 a[16:19], v20 offset:16384
    v_mfma_f32_16x16x32_bf16 v[68:71], a[32:35], a[4:7], v[68:71]
    ds_read_b128 a[20:23], v21 offset:16384
    v_mfma_f32_16x16x32_bf16 v[72:75], a[32:35], a[8:11], v[72:75]
    ds_read_b128 a[24:27], v22 offset:16384
    v_mfma_f32_16x16x32_bf16 v[76:79], a[32:35], a[12:15], v[76:79]
    ds_read_b128 a[28:31], v23 offset:16384
    v_mfma_f32_16x16x32_bf16 v[80:83], a[36:39], a[0:3], v[80:83]
    ds_read_b64_tr_b16 a[48:49], v8 offset:16384
    v_mfma_f32_16x16x32_bf16 v[84:87], a[36:39], a[4:7], v[84:87]
    ds_read_b64_tr_b16 a[50:51], v8 offset:18432
    v_mfma_f32_16x16x32_bf16 v[88:91], a[36:39], a[8:11], v[88:91]
    ds_read_b64_tr_b16 a[52:53], v9 offset:16384
    v_mfma_f32_16x16x32_bf16 v[92:95], a[36:39], a[12:15], v[92:95]
    ds_read_b64_tr_b16 a[54:55], v9 offset:18432
    v_mfma_f32_16x16x32_bf16 v[96:99], a[40:43], a[0:3], v[96:99]
    ds_read_b64_tr_b16 a[56:57], v10 offset:16384
    v_mfma_f32_16x16x32_bf16 v[100:103], a[40:43], a[4:7], v[100:103]
    ds_read_b64_tr_b16 a[58:59], v10 offset:18432
    v_mfma_f32_16x16x32_bf16 v[104:107], a[40:43], a[8:11], v[104:107]
    ds_read_b64_tr_b16 a[60:61], v11 offset:16384
    v_mfma_f32_16x16x32_bf16 v[108:111], a[40:43], a[12:15], v[108:111]
    ds_read_b64_tr_b16 a[62:63], v11 offset:18432
    v_mfma_f32_16x16x32_bf16 v[112:115], a[44:47], a[0:3], v[112:115]
    v_mfma_f32_16x16x32_bf16 v[116:119], a[44:47], a[4:7], v[116:119]
    v_mfma_f32_16x16x32_bf16 v[120:123], a[44:47], a[8:11], v[120:123]
    v_mfma_f32_16x16x32_bf16 v[124:127], a[44:47], a[12:15], v[124:127]
    s_waitcnt lgkmcnt(0)
    v_mfma_f32_16x16x32_bf16 v[64:67], a[48:51], a[16:19], v[64:67]
    ds_read_b128 a[0:3], v20 offset:32768
    v_mfma_f32_16x16x32_bf16 v[68:71], a[48:51], a[20:23], v[68:71]
    ds_read_b128 a[4:7], v21 offset:32768
    v_mfma_f32_16x16x32_bf16 v[72:75], a[48:51], a[24:27], v[72:75]
    ds_read_b128 a[8:11], v22 offset:32768
    v_mfma_f32_16x16x32_bf16 v[76:79], a[48:51], a[28:31], v[76:79]
    ds_read_b128 a[12:15], v23 offset:32768
    v_mfma_f32_16x16x32_bf16 v[80:83], a[52:55], a[16:19], v[80:83]
    ds_read_b64_tr_b16 a[32:33], v8 offset:32768
    v_mfma_f32_16x16x32_bf16 v[84:87], a[52:55], a[20:23], v[84:87]
    ds_read_b64_tr_b16 a[34:35], v8 offset:34816
    v_mfma_f32_16x16x32_bf16 v[88:91], a[52:55], a[24:27], v[88:91]
    ds_read_b64_tr_b16 a[36:37], v9 offset:32768
    v_mfma_f32_16x16x32_bf16 v[92:95], a[52:55], a[28:31], v[92:95]
    ds_read_b64_tr_b16 a[38:39], v9 offset:34816
    v_mfma_f32_16x16x32_bf16 v[96:99], a[56:59], a[16:19], v[96:99]
    ds_read_b64_tr_b16 a[40:41], v10 offset:32768
    v_mfma_f32_16x16x32_bf16 v[100:103], a[56:59], a[20:23], v[100:103]
    ds_read_b64_tr_b16 a[42:43], v10 offset:34816
    v_mfma_f32_16x16x32_bf16 v[104:107], a[56:59], a[24:27], v[104:107]
    ds_read_b64_tr_b16 a[44:45], v11 offset:32768
    v_mfma_f32_16x16x32_bf16 v[108:111], a[56:59], a[28:31], v[108:111]
    ds_read_b64_tr_b16 a[46:47], v11 offset:34816
    v_mfma_f32_16x16x32_bf16 v[112:115], a[60:63], a[16:19], v[112:115]
    v_mfma_f32_16x16x32_bf16 v[116:119], a[60:63], a[20:23], v[116:119]
    v_mfma_f32_16x16x32_bf16 v[120:123], a[60:63], a[24:27], v[120:123]
    v_mfma_f32_16x16x32_bf16 v[124:127], a[60:63], a[28:31], v[124:127]
    s_waitcnt vmcnt(4) lgkmcnt(0)
    s_barrier
    v_mfma_f32_16x16x32_bf16 v[64:67], a[32:35], a[0:3], v[64:67]
    ds_read_b128 a[16:19], v20 offset:49152
    v_mfma_f32_16x16x32_bf16 v[68:71], a[32:35], a[4:7], v[68:71]
    ds_read_b128 a[20:23], v21 offset:49152
    v_mfma_f32_16x16x32_bf16 v[72:75], a[32:35], a[8:11], v[72:75]
    ds_read_b128 a[24:27], v22 offset:49152
    v_mfma_f32_16x16x32_bf16 v[76:79], a[32:35], a[12:15], v[76:79]
    ds_read_b128 a[28:31], v23 offset:49152
    v_mfma_f32_16x16x32_bf16 v[80:83], a[36:39], a[0:3], v[80:83]
    ds_read_b64_tr_b16 a[48:49], v8 offset:49152
    v_mfma_f32_16x16x32_bf16 v[84:87], a[36:39], a[4:7], v[84:87]
    ds_read_b64_tr_b16 a[50:51], v8 offset:51200
    v_mfma_f32_16x16x32_bf16 v[88:91], a[36:39], a[8:11], v[88:91]
    ds_read_b64_tr_b16 a[52:53], v9 offset:49152
    v_mfma_f32_16x16x32_bf16 v[92:95], a[36:39], a[12:15], v[92:95]
    ds_read_b64_tr_b16 a[54:55], v9 offset:51200
    v_mfma_f32_16x16x32_bf16 v[96:99], a[40:43], a[0:3], v[96:99]
    ds_read_b64_tr_b16 a[56:57], v10 offset:49152
    v_mfma_f32_16x16x32_bf16 v[100:103], a[40:43], a[4:7], v[100:103]
    ds_read_b64_tr_b16 a[58:59], v10 offset:51200
    v_mfma_f32_16x16x32_bf16 v[104:107], a[40:43], a[8:11], v[104:107]
    ds_read_b64_tr_b16 a[60:61], v11 offset:49152
    v_mfma_f32_16x16x32_bf16 v[108:111], a[40:43], a[12:15], v[108:111]
    ds_read_b64_tr_b16 a[62:63], v11 offset:51200
    v_mfma_f32_16x16x32_bf16 v[112:115], a[44:47], a[0:3], v[112:115]
    v_mfma_f32_16x16x32_bf16 v[116:119], a[44:47], a[4:7], v[116:119]
    v_mfma_f32_16x16x32_bf16 v[120:123], a[44:47], a[8:11], v[120:123]
    v_mfma_f32_16x16x32_bf16 v[124:127], a[44:47], a[12:15], v[124:127]
    s_waitcnt lgkmcnt(0)
    v_mfma_f32_16x16x32_bf16 v[64:67], a[48:51], a[16:19], v[64:67]
    ds_read_b128 a[0:3], v24 offset:0
    v_mfma_f32_16x16x32_bf16 v[68:71], a[48:51], a[20:23], v[68:71]
    ds_read_b128 a[4:7], v25 offset:0
    v_mfma_f32_16x16x32_bf16 v[72:75], a[48:51], a[24:27], v[72:75]
    ds_read_b128 a[8:11], v26 offset:0
    v_mfma_f32_16x16x32_bf16 v[76:79], a[48:51], a[28:31], v[76:79]
    ds_read_b128 a[12:15], v27 offset:0
    v_mfma_f32_16x16x32_bf16 v[80:83], a[52:55], a[16:19], v[80:83]
    ds_read_b64_tr_b16 a[32:33], v12 offset:0
    v_mfma_f32_16x16x32_bf16 v[84:87], a[52:55], a[20:23], v[84:87]
    ds_read_b64_tr_b16 a[34:35], v12 offset:2048
    v_mfma_f32_16x16x32_bf16 v[88:91], a[52:55], a[24:27], v[88:91]
    ds_read_b64_tr_b16 a[36:37], v13 offset:0
    v_mfma_f32_16x16x32_bf16 v[92:95], a[52:55], a[28:31], v[92:95]
    ds_read_b64_tr_b16 a[38:39], v13 offset:2048
    v_mfma_f32_16x16x32_bf16 v[96:99], a[56:59], a[16:19], v[96:99]
    ds_read_b64_tr_b16 a[40:41], v14 offset:0
    v_mfma_f32_16x16x32_bf16 v[100:103], a[56:59], a[20:23], v[100:103]
    ds_read_b64_tr_b16 a[42:43], v14 offset:2048
    v_mfma_f32_16x16x32_bf16 v[104:107], a[56:59], a[24:27], v[104:107]
    ds_read_b64_tr_b16 a[44:45], v15 offset:0
    v_mfma_f32_16x16x32_bf16 v[108:111], a[56:59], a[28:31], v[108:111]
    ds_read_b64_tr_b16 a[46:47], v15 offset:2048
    v_mfma_f32_16x16x32_bf16 v[112:115], a[60:63], a[16:19], v[112:115]
    v_mfma_f32_16x16x32_bf16 v[116:119], a[60:63], a[20:23], v[116:119]
    v_mfma_f32_16x16x32_bf16 v[120:123], a[60:63], a[24:27], v[120:123]
    v_mfma_f32_16x16x32_bf16 v[124:127], a[60:63], a[28:31], v[124:127]
    s_waitcnt vmcnt(0) lgkmcnt(0)
    s_barrier
    v_mfma_f32_16x16x32_bf16 v[64:67], a[32:35], a[0:3], v[64:67]
    ds_read_b128 a[16:19], v24 offset:16384
    v_mfma_f32_16x16x32_bf16 v[68:71], a[32:35], a[4:7], v[68:71]
    ds_read_b128 a[20:23], v25 offset:16384
    v_mfma_f32_16x16x32_bf16 v[72:75], a[32:35], a[8:11], v[72:75]
    ds_read_b128 a[24:27], v26 offset:16384
    v_mfma_f32_16x16x32_bf16 v[76:79], a[32:35], a[12:15], v[76:79]
    ds_read_b128 a[28:31], v27 offset:16384
    v_mfma_f32_16x16x32_bf16 v[80:83], a[36:39], a[0:3], v[80:83]
    ds_read_b64_tr_b16 a[48:49], v12 offset:16384
    v_mfma_f32_16x16x32_bf16 v[84:87], a[36:39], a[4:7], v[84:87]
    ds_read_b64_tr_b16 a[50:51], v12 offset:18432
    v_mfma_f32_16x16x32_bf16 v[88:91], a[36:39], a[8:11], v[88:91]
    ds_read_b64_tr_b16 a[52:53], v13 offset:16384
    v_mfma_f32_16x16x32_bf16 v[92:95], a[36:39], a[12:15], v[92:95]
    ds_read_b64_tr_b16 a[54:55], v13 offset:18432
    v_mfma_f32_16x16x32_bf16 v[96:99], a[40:43], a[0:3], v[96:99]
    ds_read_b64_tr_b16 a[56:57], v14 offset:16384
    v_mfma_f32_16x16x32_bf16 v[100:103], a[40:43], a[4:7], v[100:103]
    ds_read_b64_tr_b16 a[58:59], v14 offset:18432
    v_mfma_f32_16x16x32_bf16 v[104:107], a[40:43], a[8:11], v[104:107]
    ds_read_b64_tr_b16 a[60:61], v15 offset:16384
    v_mfma_f32_16x16x32_bf16 v[108:111], a[40:43], a[12:15], v[108:111]
    ds_read_b64_tr_b16 a[62:63], v15 offset:18432
    v_mfma_f32_16x16x32_bf16 v[112:115], a[44:47], a[0:3], v[112:115]
    v_mfma_f32_16x16x32_bf16 v[116:119], a[44:47], a[4:7], v[116:119]
    v_mfma_f32_16x16x32_bf16 v[120:123], a[44:47], a[8:11], v[120:123]
    v_mfma_f32_16x16x32_bf16 v[124:127], a[44:47], a[12:15], v[124:127]
    s_waitcnt lgkmcnt(0)
    v_mfma_f32_16x16x32_bf16 v[64:67], a[48:51], a[16:19], v[64:67]
    v_mfma_f32_16x16x32_bf16 v[68:71], a[48:51], a[20:23], v[68:71]
    v_mfma_f32_16x16x32_bf16 v[72:75], a[48:51], a[24:27], v[72:75]
    v_mfma_f32_16x16x32_bf16 v[76:79], a[48:51], a[28:31], v[76:79]
    v_mfma_f32_16x16x32_bf16 v[80:83], a[52:55], a[16:19], v[80:83]
    v_mfma_f32_16x16x32_bf16 v[84:87], a[52:55], a[20:23], v[84:87]
    v_mfma_f32_16x16x32_bf16 v[88:91], a[52:55], a[24:27], v[88:91]
    v_mfma_f32_16x16x32_bf16 v[92:95], a[52:55], a[28:31], v[92:95]
    v_mfma_f32_16x16x32_bf16 v[96:99], a[56:59], a[16:19], v[96:99]
    v_mfma_f32_16x16x32_bf16 v[100:103], a[56:59], a[20:23], v[100:103]
    v_mfma_f32_16x16x32_bf16 v[104:107], a[56:59], a[24:27], v[104:107]
    v_mfma_f32_16x16x32_bf16 v[108:111], a[56:59], a[28:31], v[108:111]
    v_mfma_f32_16x16x32_bf16 v[112:115], a[60:63], a[16:19], v[112:115]
    v_mfma_f32_16x16x32_bf16 v[116:119], a[60:63], a[20:23], v[116:119]
    v_mfma_f32_16x16x32_bf16 v[120:123], a[60:63], a[24:27], v[120:123]
    v_mfma_f32_16x16x32_bf16 v[124:127], a[60:63], a[28:31], v[124:127]
    v_and_b32 v44, 15, v1
    v_lshrrev_b32 v45, 4, v1
    v_lshlrev_b32 v44, 10, v44
    v_lshl_add_u32 v44, v45, 3, v44
    s_lshl_b32 s26, s71, 2
    s_add_u32 s26, s26, s73
    s_add_u32 s26, s26, s68
    s_lshl_b32 s26, s26, 14
    s_lshl_b32 s27, s70, 8
    s_add_u32 s26, s26, s27
    s_lshl_b32 s27, s72, 7
    s_add_u32 s66, s26, s27
    buffer_load_dwordx2 v[34:35], v44, s[52:55], s66 offen offset:0
    buffer_load_dwordx2 v[36:37], v44, s[52:55], s66 offen offset:32
    buffer_load_dwordx2 v[38:39], v44, s[52:55], s66 offen offset:64
    buffer_load_dwordx2 v[40:41], v44, s[52:55], s66 offen offset:96
    s_nop 4
    v_cvt_pk_bf16_f32 v68, v68, v69
    v_cvt_pk_bf16_f32 v69, v70, v71
    v_cvt_pk_bf16_f32 v70, v132, v133
    v_cvt_pk_bf16_f32 v71, v134, v135
    buffer_store_dwordx4 v[68:71], v32, s[76:79], s7 offen offset:0 sc1
    v_cvt_pk_bf16_f32 v84, v84, v85
    v_cvt_pk_bf16_f32 v85, v86, v87
    v_cvt_pk_bf16_f32 v86, v148, v149
    v_cvt_pk_bf16_f32 v87, v150, v151
    buffer_store_dwordx4 v[84:87], v32, s[76:79], s7 offen offset:1024 sc1
    v_cvt_pk_bf16_f32 v100, v100, v101
    v_cvt_pk_bf16_f32 v101, v102, v103
    v_cvt_pk_bf16_f32 v102, v164, v165
    v_cvt_pk_bf16_f32 v103, v166, v167
    buffer_store_dwordx4 v[100:103], v32, s[76:79], s7 offen offset:2048 sc1
    v_cvt_pk_bf16_f32 v116, v116, v117
    v_cvt_pk_bf16_f32 v117, v118, v119
    v_cvt_pk_bf16_f32 v118, v180, v181
    v_cvt_pk_bf16_f32 v119, v182, v183
    buffer_store_dwordx4 v[116:119], v32, s[76:79], s7 offen offset:3072 sc1
    v_cvt_pk_bf16_f32 v72, v72, v73
    v_cvt_pk_bf16_f32 v73, v74, v75
    v_cvt_pk_bf16_f32 v74, v136, v137
    v_cvt_pk_bf16_f32 v75, v138, v139
    buffer_store_dwordx4 v[72:75], v32, s[76:79], s8 offen offset:0 sc1
    v_cvt_pk_bf16_f32 v88, v88, v89
    v_cvt_pk_bf16_f32 v89, v90, v91
    v_cvt_pk_bf16_f32 v90, v152, v153
    v_cvt_pk_bf16_f32 v91, v154, v155
    buffer_store_dwordx4 v[88:91], v32, s[76:79], s8 offen offset:1024 sc1
    v_cvt_pk_bf16_f32 v104, v104, v105
    v_cvt_pk_bf16_f32 v105, v106, v107
    v_cvt_pk_bf16_f32 v106, v168, v169
    v_cvt_pk_bf16_f32 v107, v170, v171
    buffer_store_dwordx4 v[104:107], v32, s[76:79], s8 offen offset:2048 sc1
    v_cvt_pk_bf16_f32 v120, v120, v121
    v_cvt_pk_bf16_f32 v121, v122, v123
    v_cvt_pk_bf16_f32 v122, v184, v185
    v_cvt_pk_bf16_f32 v123, v186, v187
    buffer_store_dwordx4 v[120:123], v32, s[76:79], s8 offen offset:3072 sc1
    v_cvt_pk_bf16_f32 v76, v76, v77
    v_cvt_pk_bf16_f32 v77, v78, v79
    v_cvt_pk_bf16_f32 v78, v140, v141
    v_cvt_pk_bf16_f32 v79, v142, v143
    buffer_store_dwordx4 v[76:79], v32, s[76:79], s9 offen offset:0 sc1
    v_cvt_pk_bf16_f32 v92, v92, v93
    v_cvt_pk_bf16_f32 v93, v94, v95
    v_cvt_pk_bf16_f32 v94, v156, v157
    v_cvt_pk_bf16_f32 v95, v158, v159
    buffer_store_dwordx4 v[92:95], v32, s[76:79], s9 offen offset:1024 sc1
    v_cvt_pk_bf16_f32 v108, v108, v109
    v_cvt_pk_bf16_f32 v109, v110, v111
    v_cvt_pk_bf16_f32 v110, v172, v173
    v_cvt_pk_bf16_f32 v111, v174, v175
    buffer_store_dwordx4 v[108:111], v32, s[76:79], s9 offen offset:2048 sc1
    v_cvt_pk_bf16_f32 v124, v124, v125
    v_cvt_pk_bf16_f32 v125, v126, v127
    v_cvt_pk_bf16_f32 v126, v188, v189
    v_cvt_pk_bf16_f32 v127, v190, v191
    buffer_store_dwordx4 v[124:127], v32, s[76:79], s9 offen offset:3072 sc1
    s_waitcnt vmcnt(0)
    s_barrier
    s_cmp_lg_u32 s32, 0
    s_cbranch_scc1 xf_wait_done
    s_mov_b64 exec, 1
    s_lshl_b32 s61, s33, 2
    v_mov_b32 v248, s61
    v_mov_b32 v249, s67
    global_store_dword v248, v249, s[30:31] offset:768 sc1
    s_mov_b64 exec, -1
    s_mov_b32 exec_lo, s13
    s_mov_b32 exec_hi, 0
    v_lshlrev_b32 v248, 2, v1
    s_mov_b32 s61, 0
    global_load_dword v250, v248, s[30:31] offset:768 sc1
    s_sleep 2
    global_load_dword v251, v248, s[30:31] offset:768 sc1
    s_sleep 2
xf_poll:
    global_load_dword v252, v248, s[30:31] offset:768 sc1
    s_waitcnt vmcnt(2)
    v_cmp_ne_u32 vcc, s67, v250
    s_cbranch_vccz xf_poll_out
    global_load_dword v250, v248, s[30:31] offset:768 sc1
    s_waitcnt vmcnt(2)
    v_cmp_ne_u32 vcc, s67, v251
    s_cbranch_vccz xf_poll_out
    global_load_dword v251, v248, s[30:31] offset:768 sc1
    s_waitcnt vmcnt(2)
    v_cmp_ne_u32 vcc, s67, v252
    s_cbranch_vccz xf_poll_out
    s_add_u32 s61, s61, 1
    s_cmp_lt_u32 s61, 0x20000
    s_cbranch_scc1 xf_poll
xf_poll_out:
    s_mov_b64 exec, -1
xf_wait_done:
    s_barrier
    s_add_u32 s27, s12, 0
    buffer_load_dwordx4 v[192:195], v32, s[76:79], s27 offen offset:0 sc1
    buffer_load_dwordx4 v[196:199], v32, s[76:79], s27 offen offset:1024 sc1
    buffer_load_dwordx4 v[200:203], v32, s[76:79], s27 offen offset:2048 sc1
    buffer_load_dwordx4 v[204:207], v32, s[76:79], s27 offen offset:3072 sc1
    s_add_u32 s27, s12, 32768
    buffer_load_dwordx4 v[208:211], v32, s[76:79], s27 offen offset:0 sc1
    buffer_load_dwordx4 v[212:215], v32, s[76:79], s27 offen offset:1024 sc1
    buffer_load_dwordx4 v[216:219], v32, s[76:79], s27 offen offset:2048 sc1
    buffer_load_dwordx4 v[220:223], v32, s[76:79], s27 offen offset:3072 sc1
    s_add_u32 s27, s12, 65536
    buffer_load_dwordx4 v[224:227], v32, s[76:79], s27 offen offset:0 sc1
    buffer_load_dwordx4 v[228:231], v32, s[76:79], s27 offen offset:1024 sc1
    buffer_load_dwordx4 v[232:235], v32, s[76:79], s27 offen offset:2048 sc1
    buffer_load_dwordx4 v[236:239], v32, s[76:79], s27 offen offset:3072 sc1
    s_waitcnt vmcnt(8)
    v_lshlrev_b32 v48, 16, v192
    v_and_b32 v49, 0xffff0000, v192
    v_add_f32 v64, v64, v48
    v_add_f32 v65, v65, v49
    v_lshlrev_b32 v48, 16, v193
    v_and_b32 v49, 0xffff0000, v193
    v_add_f32 v66, v66, v48
    v_add_f32 v67, v67, v49
    v_lshlrev_b32 v48, 16, v194
    v_and_b32 v49, 0xffff0000, v194
    v_add_f32 v128, v128, v48
    v_add_f32 v129, v129, v49
    v_lshlrev_b32 v48, 16, v195
    v_and_b32 v49, 0xffff0000, v195
    v_add_f32 v130, v130, v48
    v_add_f32 v131, v131, v49
    v_lshlrev_b32 v48, 16, v196
    v_and_b32 v49, 0xffff0000, v196
    v_add_f32 v80, v80, v48
    v_add_f32 v81, v81, v49
    v_lshlrev_b32 v48, 16, v197
    v_and_b32 v49, 0xffff0000, v197
    v_add_f32 v82, v82, v48
    v_add_f32 v83, v83, v49
    v_lshlrev_b32 v48, 16, v198
    v_and_b32 v49, 0xffff0000, v198
    v_add_f32 v144, v144, v48
    v_add_f32 v145, v145, v49
    v_lshlrev_b32 v48, 16, v199
    v_and_b32 v49, 0xffff0000, v199
    v_add_f32 v146, v146, v48
    v_add_f32 v147, v147, v49
    v_lshlrev_b32 v48, 16, v200
    v_and_b32 v49, 0xffff0000, v200
    v_add_f32 v96, v96, v48
    v_add_f32 v97, v97, v49
    v_lshlrev_b32 v48, 16, v201
    v_and_b32 v49, 0xffff0000, v201
    v_add_f32 v98, v98, v48
    v_add_f32 v99, v99, v49
    v_lshlrev_b32 v48, 16, v202
    v_and_b32 v49, 0xffff0000, v202
    v_add_f32 v160, v160, v48
    v_add_f32 v161, v161, v49
    v_lshlrev_b32 v48, 16, v203
    v_and_b32 v49, 0xffff0000, v203
    v_add_f32 v162, v162, v48
    v_add_f32 v163, v163, v49
    v_lshlrev_b32 v48, 16, v204
    v_and_b32 v49, 0xffff0000, v204
    v_add_f32 v112, v112, v48
    v_add_f32 v113, v113, v49
    v_lshlrev_b32 v48, 16, v205
    v_and_b32 v49, 0xffff0000, v205
    v_add_f32 v114, v114, v48
    v_add_f32 v115, v115, v49
    v_lshlrev_b32 v48, 16, v206
    v_and_b32 v49, 0xffff0000, v206
    v_add_f32 v176, v176, v48
    v_add_f32 v177, v177, v49
    v_lshlrev_b32 v48, 16, v207
    v_and_b32 v49, 0xffff0000, v207
    v_add_f32 v178, v178, v48
    v_add_f32 v179, v179, v49
    s_waitcnt vmcnt(4)
    v_lshlrev_b32 v48, 16, v208
    v_and_b32 v49, 0xffff0000, v208
    v_add_f32 v64, v64, v48
    v_add_f32 v65, v65, v49
    v_lshlrev_b32 v48, 16, v209
    v_and_b32 v49, 0xffff0000, v209
    v_add_f32 v66, v66, v48
    v_add_f32 v67, v67, v49
    v_lshlrev_b32 v48, 16, v210
    v_and_b32 v49, 0xffff0000, v210
    v_add_f32 v128, v128, v48
    v_add_f32 v129, v129, v49
    v_lshlrev_b32 v48, 16, v211
    v_and_b32 v49, 0xffff0000, v211
    v_add_f32 v130, v130, v48
    v_add_f32 v131, v131, v49
    v_lshlrev_b32 v48, 16, v212
    v_and_b32 v49, 0xffff0000, v212
    v_add_f32 v80, v80, v48
    v_add_f32 v81, v81, v49
    v_lshlrev_b32 v48, 16, v213
    v_and_b32 v49, 0xffff0000, v213
    v_add_f32 v82, v82, v48
    v_add_f32 v83, v83, v49
    v_lshlrev_b32 v48, 16, v214
    v_and_b32 v49, 0xffff0000, v214
    v_add_f32 v144, v144, v48
    v_add_f32 v145, v145, v49
    v_lshlrev_b32 v48, 16, v215
    v_and_b32 v49, 0xffff0000, v215
    v_add_f32 v146, v146, v48
    v_add_f32 v147, v147, v49
    v_lshlrev_b32 v48, 16, v216
    v_and_b32 v49, 0xffff0000, v216
    v_add_f32 v96, v96, v48
    v_add_f32 v97, v97, v49
    v_lshlrev_b32 v48, 16, v217
    v_and_b32 v49, 0xffff0000, v217
    v_add_f32 v98, v98, v48
    v_add_f32 v99, v99, v49
    v_lshlrev_b32 v48, 16, v218
    v_and_b32 v49, 0xffff0000, v218
    v_add_f32 v160, v160, v48
    v_add_f32 v161, v161, v49
    v_lshlrev_b32 v48, 16, v219
    v_and_b32 v49, 0xffff0000, v219
    v_add_f32 v162, v162, v48
    v_add_f32 v163, v163, v49
    v_lshlrev_b32 v48, 16, v220
    v_and_b32 v49, 0xffff0000, v220
    v_add_f32 v112, v112, v48
    v_add_f32 v113, v113, v49
    v_lshlrev_b32 v48, 16, v221
    v_and_b32 v49, 0xffff0000, v221
    v_add_f32 v114, v114, v48
    v_add_f32 v115, v115, v49
    v_lshlrev_b32 v48, 16, v222
    v_and_b32 v49, 0xffff0000, v222
    v_add_f32 v176, v176, v48
    v_add_f32 v177, v177, v49
    v_lshlrev_b32 v48, 16, v223
    v_and_b32 v49, 0xffff0000, v223
    v_add_f32 v178, v178, v48
    v_add_f32 v179, v179, v49
    s_waitcnt vmcnt(0)
    v_lshlrev_b32 v48, 16, v224
    v_and_b32 v49, 0xffff0000, v224
    v_add_f32 v64, v64, v48
    v_add_f32 v65, v65, v49
    v_lshlrev_b32 v48, 16, v225
    v_and_b32 v49, 0xffff0000, v225
    v_add_f32 v66, v66, v48
    v_add_f32 v67, v67, v49
    v_lshlrev_b32 v48, 16, v226
    v_and_b32 v49, 0xffff0000, v226
    v_add_f32 v128, v128, v48
    v_add_f32 v129, v129, v49
    v_lshlrev_b32 v48, 16, v227
    v_and_b32 v49, 0xffff0000, v227
    v_add_f32 v130, v130, v48
    v_add_f32 v131, v131, v49
    v_lshlrev_b32 v48, 16, v228
    v_and_b32 v49, 0xffff0000, v228
    v_add_f32 v80, v80, v48
    v_add_f32 v81, v81, v49
    v_lshlrev_b32 v48, 16, v229
    v_and_b32 v49, 0xffff0000, v229
    v_add_f32 v82, v82, v48
    v_add_f32 v83, v83, v49
    v_lshlrev_b32 v48, 16, v230
    v_and_b32 v49, 0xffff0000, v230
    v_add_f32 v144, v144, v48
    v_add_f32 v145, v145, v49
    v_lshlrev_b32 v48, 16, v231
    v_and_b32 v49, 0xffff0000, v231
    v_add_f32 v146, v146, v48
    v_add_f32 v147, v147, v49
    v_lshlrev_b32 v48, 16, v232
    v_and_b32 v49, 0xffff0000, v232
    v_add_f32 v96, v96, v48
    v_add_f32 v97, v97, v49
    v_lshlrev_b32 v48, 16, v233
    v_and_b32 v49, 0xffff0000, v233
    v_add_f32 v98, v98, v48
    v_add_f32 v99, v99, v49
    v_lshlrev_b32 v48, 16, v234
    v_and_b32 v49, 0xffff0000, v234
    v_add_f32 v160, v160, v48
    v_add_f32 v161, v161, v49
    v_lshlrev_b32 v48, 16, v235
    v_and_b32 v49, 0xffff0000, v235
    v_add_f32 v162, v162, v48
    v_add_f32 v163, v163, v49
    v_lshlrev_b32 v48, 16, v236
    v_and_b32 v49, 0xffff0000, v236
    v_add_f32 v112, v112, v48
    v_add_f32 v113, v113, v49
    v_lshlrev_b32 v48, 16, v237
    v_and_b32 v49, 0xffff0000, v237
    v_add_f32 v114, v114, v48
    v_add_f32 v115, v115, v49
    v_lshlrev_b32 v48, 16, v238
    v_and_b32 v49, 0xffff0000, v238
    v_add_f32 v176, v176, v48
    v_add_f32 v177, v177, v49
    v_lshlrev_b32 v48, 16, v239
    v_and_b32 v49, 0xffff0000, v239
    v_add_f32 v178, v178, v48
    v_add_f32 v179, v179, v49
    v_cvt_pk_bf16_f32 v192, v64, v65
    v_cvt_pk_bf16_f32 v193, v66, v67
    v_cvt_pk_bf16_f32 v194, v128, v129
    v_cvt_pk_bf16_f32 v195, v130, v131
    v_lshlrev_b32 v64, 16, v192
    v_lshlrev_b32 v128, 16, v194
    v_and_b32 v65, 0xffff0000, v192
    v_and_b32 v129, 0xffff0000, v194
    v_lshlrev_b32 v66, 16, v193
    v_lshlrev_b32 v130, 16, v195
    v_and_b32 v67, 0xffff0000, v193
    v_and_b32 v131, 0xffff0000, v195
    v_mul_f32 v196, 0xbfb8aa3b, v128
    v_mul_f32 v197, 0xbfb8aa3b, v129
    v_mul_f32 v198, 0xbfb8aa3b, v130
    v_mul_f32 v199, 0xbfb8aa3b, v131
    v_exp_f32 v196, v196
    v_exp_f32 v197, v197
    v_exp_f32 v198, v198
    v_exp_f32 v199, v199
    s_nop 0
    v_add_f32 v196, 1.0, v196
    v_add_f32 v197, 1.0, v197
    v_add_f32 v198, 1.0, v198
    v_add_f32 v199, 1.0, v199
    v_rcp_f32 v196, v196
    v_rcp_f32 v197, v197
    v_rcp_f32 v198, v198
    v_rcp_f32 v199, v199
    s_nop 0
    v_mul_f32 v196, v196, v128
    v_mul_f32 v197, v197, v129
    v_mul_f32 v198, v198, v130
    v_mul_f32 v199, v199, v131
    v_cvt_pk_bf16_f32 v192, v196, v197
    v_cvt_pk_bf16_f32 v193, v198, v199
    v_lshlrev_b32 v196, 16, v192
    v_and_b32 v197, 0xffff0000, v192
    v_lshlrev_b32 v198, 16, v193
    v_and_b32 v199, 0xffff0000, v193
    v_mul_f32 v196, v196, v64
    v_mul_f32 v197, v197, v65
    v_mul_f32 v198, v198, v66
    v_mul_f32 v199, v199, v67
    v_cvt_pk_bf16_f32 v192, v196, v197
    v_cvt_pk_bf16_f32 v193, v198, v199
    v_lshlrev_b32 v196, 16, v192
    v_and_b32 v197, 0xffff0000, v192
    v_lshlrev_b32 v198, 16, v193
    v_and_b32 v199, 0xffff0000, v193
    v_lshlrev_b32 v200, 16, v34
    v_and_b32 v201, 0xffff0000, v34
    v_lshlrev_b32 v202, 16, v35
    v_and_b32 v203, 0xffff0000, v35
    v_add_f32 v196, v196, v200
    v_add_f32 v197, v197, v201
    v_add_f32 v198, v198, v202
    v_add_f32 v199, v199, v203
    v_cvt_pk_bf16_f32 v192, v196, v197
    v_cvt_pk_bf16_f32 v193, v198, v199
    buffer_store_dwordx2 v[192:193], v44, s[56:59], s66 offen offset:0 sc1
    v_cvt_pk_bf16_f32 v208, v80, v81
    v_cvt_pk_bf16_f32 v209, v82, v83
    v_cvt_pk_bf16_f32 v210, v144, v145
    v_cvt_pk_bf16_f32 v211, v146, v147
    v_lshlrev_b32 v80, 16, v208
    v_lshlrev_b32 v144, 16, v210
    v_and_b32 v81, 0xffff0000, v208
    v_and_b32 v145, 0xffff0000, v210
    v_lshlrev_b32 v82, 16, v209
    v_lshlrev_b32 v146, 16, v211
    v_and_b32 v83, 0xffff0000, v209
    v_and_b32 v147, 0xffff0000, v211
    v_mul_f32 v212, 0xbfb8aa3b, v144
    v_mul_f32 v213, 0xbfb8aa3b, v145
    v_mul_f32 v214, 0xbfb8aa3b, v146
    v_mul_f32 v215, 0xbfb8aa3b, v147
    v_exp_f32 v212, v212
    v_exp_f32 v213, v213
    v_exp_f32 v214, v214
    v_exp_f32 v215, v215
    s_nop 0
    v_add_f32 v212, 1.0, v212
    v_add_f32 v213, 1.0, v213
    v_add_f32 v214, 1.0, v214
    v_add_f32 v215, 1.0, v215
    v_rcp_f32 v212, v212
    v_rcp_f32 v213, v213
    v_rcp_f32 v214, v214
    v_rcp_f32 v215, v215
    s_nop 0
    v_mul_f32 v212, v212, v144
    v_mul_f32 v213, v213, v145
    v_mul_f32 v214, v214, v146
    v_mul_f32 v215, v215, v147
    v_cvt_pk_bf16_f32 v208, v212, v213
    v_cvt_pk_bf16_f32 v209, v214, v215
    v_lshlrev_b32 v212, 16, v208
    v_and_b32 v213, 0xffff0000, v208
    v_lshlrev_b32 v214, 16, v209
    v_and_b32 v215, 0xffff0000, v209
    v_mul_f32 v212, v212, v80
    v_mul_f32 v213, v213, v81
    v_mul_f32 v214, v214, v82
    v_mul_f32 v215, v215, v83
    v_cvt_pk_bf16_f32 v208, v212, v213
    v_cvt_pk_bf16_f32 v209, v214, v215
    v_lshlrev_b32 v212, 16, v208
    v_and_b32 v213, 0xffff0000, v208
    v_lshlrev_b32 v214, 16, v209
    v_and_b32 v215, 0xffff0000, v209
    v_lshlrev_b32 v216, 16, v36
    v_and_b32 v217, 0xffff0000, v36
    v_lshlrev_b32 v218, 16, v37
    v_and_b32 v219, 0xffff0000, v37
    v_add_f32 v212, v212, v216
    v_add_f32 v213, v213, v217
    v_add_f32 v214, v214, v218
    v_add_f32 v215, v215, v219
    v_cvt_pk_bf16_f32 v208, v212, v213
    v_cvt_pk_bf16_f32 v209, v214, v215
    buffer_store_dwordx2 v[208:209], v44, s[56:59], s66 offen offset:32 sc1
    v_cvt_pk_bf16_f32 v224, v96, v97
    v_cvt_pk_bf16_f32 v225, v98, v99
    v_cvt_pk_bf16_f32 v226, v160, v161
    v_cvt_pk_bf16_f32 v227, v162, v163
    v_lshlrev_b32 v96, 16, v224
    v_lshlrev_b32 v160, 16, v226
    v_and_b32 v97, 0xffff0000, v224
    v_and_b32 v161, 0xffff0000, v226
    v_lshlrev_b32 v98, 16, v225
    v_lshlrev_b32 v162, 16, v227
    v_and_b32 v99, 0xffff0000, v225
    v_and_b32 v163, 0xffff0000, v227
    v_mul_f32 v228, 0xbfb8aa3b, v160
    v_mul_f32 v229, 0xbfb8aa3b, v161
    v_mul_f32 v230, 0xbfb8aa3b, v162
    v_mul_f32 v231, 0xbfb8aa3b, v163
    v_exp_f32 v228, v228
    v_exp_f32 v229, v229
    v_exp_f32 v230, v230
    v_exp_f32 v231, v231
    s_nop 0
    v_add_f32 v228, 1.0, v228
    v_add_f32 v229, 1.0, v229
    v_add_f32 v230, 1.0, v230
    v_add_f32 v231, 1.0, v231
    v_rcp_f32 v228, v228
    v_rcp_f32 v229, v229
    v_rcp_f32 v230, v230
    v_rcp_f32 v231, v231
    s_nop 0
    v_mul_f32 v228, v228, v160
    v_mul_f32 v229, v229, v161
    v_mul_f32 v230, v230, v162
    v_mul_f32 v231, v231, v163
    v_cvt_pk_bf16_f32 v224, v228, v229
    v_cvt_pk_bf16_f32 v225, v230, v231
    v_lshlrev_b32 v228, 16, v224
    v_and_b32 v229, 0xffff0000, v224
    v_lshlrev_b32 v230, 16, v225
    v_and_b32 v231, 0xffff0000, v225
    v_mul_f32 v228, v228, v96
    v_mul_f32 v229, v229, v97
    v_mul_f32 v230, v230, v98
    v_mul_f32 v231, v231, v99
    v_cvt_pk_bf16_f32 v224, v228, v229
    v_cvt_pk_bf16_f32 v225, v230, v231
    v_lshlrev_b32 v228, 16, v224
    v_and_b32 v229, 0xffff0000, v224
    v_lshlrev_b32 v230, 16, v225
    v_and_b32 v231, 0xffff0000, v225
    v_lshlrev_b32 v232, 16, v38
    v_and_b32 v233, 0xffff0000, v38
    v_lshlrev_b32 v234, 16, v39
    v_and_b32 v235, 0xffff0000, v39
    v_add_f32 v228, v228, v232
    v_add_f32 v229, v229, v233
    v_add_f32 v230, v230, v234
    v_add_f32 v231, v231, v235
    v_cvt_pk_bf16_f32 v224, v228, v229
    v_cvt_pk_bf16_f32 v225, v230, v231
    buffer_store_dwordx2 v[224:225], v44, s[56:59], s66 offen offset:64 sc1
    v_cvt_pk_bf16_f32 v240, v112, v113
    v_cvt_pk_bf16_f32 v241, v114, v115
    v_cvt_pk_bf16_f32 v242, v176, v177
    v_cvt_pk_bf16_f32 v243, v178, v179
    v_lshlrev_b32 v112, 16, v240
    v_lshlrev_b32 v176, 16, v242
    v_and_b32 v113, 0xffff0000, v240
    v_and_b32 v177, 0xffff0000, v242
    v_lshlrev_b32 v114, 16, v241
    v_lshlrev_b32 v178, 16, v243
    v_and_b32 v115, 0xffff0000, v241
    v_and_b32 v179, 0xffff0000, v243
    v_mul_f32 v244, 0xbfb8aa3b, v176
    v_mul_f32 v245, 0xbfb8aa3b, v177
    v_mul_f32 v246, 0xbfb8aa3b, v178
    v_mul_f32 v247, 0xbfb8aa3b, v179
    v_exp_f32 v244, v244
    v_exp_f32 v245, v245
    v_exp_f32 v246, v246
    v_exp_f32 v247, v247
    s_nop 0
    v_add_f32 v244, 1.0, v244
    v_add_f32 v245, 1.0, v245
    v_add_f32 v246, 1.0, v246
    v_add_f32 v247, 1.0, v247
    v_rcp_f32 v244, v244
    v_rcp_f32 v245, v245
    v_rcp_f32 v246, v246
    v_rcp_f32 v247, v247
    s_nop 0
    v_mul_f32 v244, v244, v176
    v_mul_f32 v245, v245, v177
    v_mul_f32 v246, v246, v178
    v_mul_f32 v247, v247, v179
    v_cvt_pk_bf16_f32 v240, v244, v245
    v_cvt_pk_bf16_f32 v241, v246, v247
    v_lshlrev_b32 v244, 16, v240
    v_and_b32 v245, 0xffff0000, v240
    v_lshlrev_b32 v246, 16, v241
    v_and_b32 v247, 0xffff0000, v241
    v_mul_f32 v244, v244, v112
    v_mul_f32 v245, v245, v113
    v_mul_f32 v246, v246, v114
    v_mul_f32 v247, v247, v115
    v_cvt_pk_bf16_f32 v240, v244, v245
    v_cvt_pk_bf16_f32 v241, v246, v247
    v_lshlrev_b32 v244, 16, v240
    v_and_b32 v245, 0xffff0000, v240
    v_lshlrev_b32 v246, 16, v241
    v_and_b32 v247, 0xffff0000, v241
    v_lshlrev_b32 v248, 16, v40
    v_and_b32 v249, 0xffff0000, v40
    v_lshlrev_b32 v250, 16, v41
    v_and_b32 v251, 0xffff0000, v41
    v_add_f32 v244, v244, v248
    v_add_f32 v245, v245, v249
    v_add_f32 v246, v246, v250
    v_add_f32 v247, v247, v251
    v_cvt_pk_bf16_f32 v240, v244, v245
    v_cvt_pk_bf16_f32 v241, v246, v247
    buffer_store_dwordx2 v[240:241], v44, s[56:59], s66 offen offset:96 sc1
    s_or_b32 s26, s33, s32
    s_cmp_lg_u32 s26, 0
    s_cbranch_scc1 no_epoch
    s_mov_b64 exec, 1
    v_mov_b32 v8, 0
    v_mov_b32 v9, s67
    global_store_dword v8, v9, s[30:31] offset:896 sc1
    s_mov_b64 exec, -1
no_epoch:
attn_end:
    s_endpgm
rare_stub_1:
    s_call_b64 s[30:31], rare_path_0
    s_branch rare_back_2
rare_stub_3:
    s_call_b64 s[30:31], rare_path_1
    s_branch rare_back_4
rare_stub_5:
    s_call_b64 s[30:31], rare_path_0
    s_branch rare_back_6
rare_stub_7:
    s_call_b64 s[30:31], rare_path_1
    s_branch rare_back_8
rare_stub_9:
    s_call_b64 s[30:31], rare_path_0
    s_branch rare_back_10
rare_stub_11:
    s_call_b64 s[30:31], rare_path_1
    s_branch rare_back_12
rare_stub_13:
    s_call_b64 s[30:31], rare_path_0
    s_branch rare_back_14
rare_stub_15:
    s_call_b64 s[30:31], rare_path_1
    s_branch rare_back_16
rare_stub_17:
    s_call_b64 s[30:31], rare_path_0
    s_branch rare_back_18
rare_stub_19:
    s_call_b64 s[30:31], rare_path_1
    s_branch rare_back_20
rare_stub_21:
    s_call_b64 s[30:31], rare_path_0
    s_branch rare_back_22
rare_stub_23:
    s_call_b64 s[30:31], rare_path_1
    s_branch rare_back_24
rare_stub_25:
    s_call_b64 s[30:31], rare_path_0
    s_branch rare_back_26
rare_stub_27:
    s_call_b64 s[30:31], rare_path_1
    s_branch rare_back_28
rare_stub_29:
    s_call_b64 s[30:31], rare_path_0
    s_branch rare_back_30
rare_stub_31:
    s_call_b64 s[30:31], rare_path_1
    s_branch rare_back_32
rare_path_0:
    s_nop 15
    v_max3_f32 v224, v64, v65, v66
    v_max3_f32 v224, v224, v67, v68
    v_max3_f32 v224, v224, v69, v70
    v_max_f32 v224, v224, v71
    v_mov_b32 v225, v224
    s_nop 1
    v_permlane16_swap_b32 v224, v225
    s_nop 1
    v_max_f32 v224, v224, v225
    v_mov_b32 v225, v224
    s_nop 1
    v_permlane32_swap_b32 v224, v225
    s_nop 1
    v_max_f32 v224, v224, v225
    v_max_f32 v224, 0, v224
    v_sub_f32 v225, 0, v224
    v_exp_f32 v225, v225
    v_sub_f32 v40, v40, v224
    v_sub_f32 v41, v41, v224
    v_sub_f32 v42, v42, v224
    v_sub_f32 v43, v43, v224
    v_sub_f32 v64, v64, v224
    v_sub_f32 v96, v96, v224
    v_sub_f32 v65, v65, v224
    v_sub_f32 v97, v97, v224
    v_sub_f32 v66, v66, v224
    v_sub_f32 v98, v98, v224
    v_sub_f32 v67, v67, v224
    v_sub_f32 v99, v99, v224
    v_sub_f32 v68, v68, v224
    v_sub_f32 v100, v100, v224
    v_sub_f32 v69, v69, v224
    v_sub_f32 v101, v101, v224
    v_sub_f32 v70, v70, v224
    v_sub_f32 v102, v102, v224
    v_sub_f32 v71, v71, v224
    v_sub_f32 v103, v103, v224
    v_mul_f32 v16, v16, v225
    v_accvgpr_read_b32 v226, a0
    v_accvgpr_read_b32 v227, a1
    v_accvgpr_read_b32 v228, a2
    v_accvgpr_read_b32 v229, a3
    v_mul_f32 v226, v226, v225
    v_mul_f32 v227, v227, v225
    v_mul_f32 v228, v228, v225
    v_mul_f32 v229, v229, v225
    v_accvgpr_write_b32 a0, v226
    v_accvgpr_write_b32 a1, v227
    v_accvgpr_write_b32 a2, v228
    v_accvgpr_write_b32 a3, v229
    v_accvgpr_read_b32 v226, a16
    v_accvgpr_read_b32 v227, a17
    v_accvgpr_read_b32 v228, a18
    v_accvgpr_read_b32 v229, a19
    v_mul_f32 v226, v226, v225
    v_mul_f32 v227, v227, v225
    v_mul_f32 v228, v228, v225
    v_mul_f32 v229, v229, v225
    v_accvgpr_write_b32 a16, v226
    v_accvgpr_write_b32 a17, v227
    v_accvgpr_write_b32 a18, v228
    v_accvgpr_write_b32 a19, v229
    v_accvgpr_read_b32 v226, a32
    v_accvgpr_read_b32 v227, a33
    v_accvgpr_read_b32 v228, a34
    v_accvgpr_read_b32 v229, a35
    v_mul_f32 v226, v226, v225
    v_mul_f32 v227, v227, v225
    v_mul_f32 v228, v228, v225
    v_mul_f32 v229, v229, v225
    v_accvgpr_write_b32 a32, v226
    v_accvgpr_write_b32 a33, v227
    v_accvgpr_write_b32 a34, v228
    v_accvgpr_write_b32 a35, v229
    v_accvgpr_read_b32 v226, a48
    v_accvgpr_read_b32 v227, a49
    v_accvgpr_read_b32 v228, a50
    v_accvgpr_read_b32 v229, a51
    v_mul_f32 v226, v226, v225
    v_mul_f32 v227, v227, v225
    v_mul_f32 v228, v228, v225
    v_mul_f32 v229, v229, v225
    v_accvgpr_write_b32 a48, v226
    v_accvgpr_write_b32 a49, v227
    v_accvgpr_write_b32 a50, v228
    v_accvgpr_write_b32 a51, v229
    v_accvgpr_read_b32 v226, a64
    v_accvgpr_read_b32 v227, a65
    v_accvgpr_read_b32 v228, a66
    v_accvgpr_read_b32 v229, a67
    v_mul_f32 v226, v226, v225
    v_mul_f32 v227, v227, v225
    v_mul_f32 v228, v228, v225
    v_mul_f32 v229, v229, v225
    v_accvgpr_write_b32 a64, v226
    v_accvgpr_write_b32 a65, v227
    v_accvgpr_write_b32 a66, v228
    v_accvgpr_write_b32 a67, v229
    v_accvgpr_read_b32 v226, a80
    v_accvgpr_read_b32 v227, a81
    v_accvgpr_read_b32 v228, a82
    v_accvgpr_read_b32 v229, a83
    v_mul_f32 v226, v226, v225
    v_mul_f32 v227, v227, v225
    v_mul_f32 v228, v228, v225
    v_mul_f32 v229, v229, v225
    v_accvgpr_write_b32 a80, v226
    v_accvgpr_write_b32 a81, v227
    v_accvgpr_write_b32 a82, v228
    v_accvgpr_write_b32 a83, v229
    v_accvgpr_read_b32 v226, a96
    v_accvgpr_read_b32 v227, a97
    v_accvgpr_read_b32 v228, a98
    v_accvgpr_read_b32 v229, a99
    v_mul_f32 v226, v226, v225
    v_mul_f32 v227, v227, v225
    v_mul_f32 v228, v228, v225
    v_mul_f32 v229, v229, v225
    v_accvgpr_write_b32 a96, v226
    v_accvgpr_write_b32 a97, v227
    v_accvgpr_write_b32 a98, v228
    v_accvgpr_write_b32 a99, v229
    v_accvgpr_read_b32 v226, a112
    v_accvgpr_read_b32 v227, a113
    v_accvgpr_read_b32 v228, a114
    v_accvgpr_read_b32 v229, a115
    v_mul_f32 v226, v226, v225
    v_mul_f32 v227, v227, v225
    v_mul_f32 v228, v228, v225
    v_mul_f32 v229, v229, v225
    v_accvgpr_write_b32 a112, v226
    v_accvgpr_write_b32 a113, v227
    v_accvgpr_write_b32 a114, v228
    v_accvgpr_write_b32 a115, v229
    v_exp_f32 v226, v64
    v_exp_f32 v227, v65
    s_nop 0
    v_add_f32 v20, v226, v227
    v_cvt_pk_bf16_f32 v192, v226, v227
    v_exp_f32 v226, v66
    v_exp_f32 v227, v67
    s_nop 0
    v_add_f32 v20, v20, v226
    v_add_f32 v20, v20, v227
    v_cvt_pk_bf16_f32 v193, v226, v227
    v_exp_f32 v226, v68
    v_exp_f32 v227, v69
    s_nop 0
    v_add_f32 v20, v20, v226
    v_add_f32 v20, v20, v227
    v_cvt_pk_bf16_f32 v194, v226, v227
    v_exp_f32 v226, v70
    v_exp_f32 v227, v71
    s_nop 0
    v_add_f32 v20, v20, v226
    v_add_f32 v20, v20, v227
    v_cvt_pk_bf16_f32 v195, v226, v227
    v_max3_f32 v224, v72, v73, v74
    v_max3_f32 v224, v224, v75, v76
    v_max3_f32 v224, v224, v77, v78
    v_max_f32 v224, v224, v79
    v_mov_b32 v225, v224
    s_nop 1
    v_permlane16_swap_b32 v224, v225
    s_nop 1
    v_max_f32 v224, v224, v225
    v_mov_b32 v225, v224
    s_nop 1
    v_permlane32_swap_b32 v224, v225
    s_nop 1
    v_max_f32 v224, v224, v225
    v_max_f32 v224, 0, v224
    v_sub_f32 v225, 0, v224
    v_exp_f32 v225, v225
    v_sub_f32 v44, v44, v224
    v_sub_f32 v45, v45, v224
    v_sub_f32 v46, v46, v224
    v_sub_f32 v47, v47, v224
    v_sub_f32 v72, v72, v224
    v_sub_f32 v104, v104, v224
    v_sub_f32 v73, v73, v224
    v_sub_f32 v105, v105, v224
    v_sub_f32 v74, v74, v224
    v_sub_f32 v106, v106, v224
    v_sub_f32 v75, v75, v224
    v_sub_f32 v107, v107, v224
    v_sub_f32 v76, v76, v224
    v_sub_f32 v108, v108, v224
    v_sub_f32 v77, v77, v224
    v_sub_f32 v109, v109, v224
    v_sub_f32 v78, v78, v224
    v_sub_f32 v110, v110, v224
    v_sub_f32 v79, v79, v224
    v_sub_f32 v111, v111, v224
    v_mul_f32 v17, v17, v225
    v_accvgpr_read_b32 v226, a4
    v_accvgpr_read_b32 v227, a5
    v_accvgpr_read_b32 v228, a6
    v_accvgpr_read_b32 v229, a7
    v_mul_f32 v226, v226, v225
    v_mul_f32 v227, v227, v225
    v_mul_f32 v228, v228, v225
    v_mul_f32 v229, v229, v225
    v_accvgpr_write_b32 a4, v226
    v_accvgpr_write_b32 a5, v227
    v_accvgpr_write_b32 a6, v228
    v_accvgpr_write_b32 a7, v229
    v_accvgpr_read_b32 v226, a20
    v_accvgpr_read_b32 v227, a21
    v_accvgpr_read_b32 v228, a22
    v_accvgpr_read_b32 v229, a23
    v_mul_f32 v226, v226, v225
    v_mul_f32 v227, v227, v225
    v_mul_f32 v228, v228, v225
    v_mul_f32 v229, v229, v225
    v_accvgpr_write_b32 a20, v226
    v_accvgpr_write_b32 a21, v227
    v_accvgpr_write_b32 a22, v228
    v_accvgpr_write_b32 a23, v229
    v_accvgpr_read_b32 v226, a36
    v_accvgpr_read_b32 v227, a37
    v_accvgpr_read_b32 v228, a38
    v_accvgpr_read_b32 v229, a39
    v_mul_f32 v226, v226, v225
    v_mul_f32 v227, v227, v225
    v_mul_f32 v228, v228, v225
    v_mul_f32 v229, v229, v225
    v_accvgpr_write_b32 a36, v226
    v_accvgpr_write_b32 a37, v227
    v_accvgpr_write_b32 a38, v228
    v_accvgpr_write_b32 a39, v229
    v_accvgpr_read_b32 v226, a52
    v_accvgpr_read_b32 v227, a53
    v_accvgpr_read_b32 v228, a54
    v_accvgpr_read_b32 v229, a55
    v_mul_f32 v226, v226, v225
    v_mul_f32 v227, v227, v225
    v_mul_f32 v228, v228, v225
    v_mul_f32 v229, v229, v225
    v_accvgpr_write_b32 a52, v226
    v_accvgpr_write_b32 a53, v227
    v_accvgpr_write_b32 a54, v228
    v_accvgpr_write_b32 a55, v229
    v_accvgpr_read_b32 v226, a68
    v_accvgpr_read_b32 v227, a69
    v_accvgpr_read_b32 v228, a70
    v_accvgpr_read_b32 v229, a71
    v_mul_f32 v226, v226, v225
    v_mul_f32 v227, v227, v225
    v_mul_f32 v228, v228, v225
    v_mul_f32 v229, v229, v225
    v_accvgpr_write_b32 a68, v226
    v_accvgpr_write_b32 a69, v227
    v_accvgpr_write_b32 a70, v228
    v_accvgpr_write_b32 a71, v229
    v_accvgpr_read_b32 v226, a84
    v_accvgpr_read_b32 v227, a85
    v_accvgpr_read_b32 v228, a86
    v_accvgpr_read_b32 v229, a87
    v_mul_f32 v226, v226, v225
    v_mul_f32 v227, v227, v225
    v_mul_f32 v228, v228, v225
    v_mul_f32 v229, v229, v225
    v_accvgpr_write_b32 a84, v226
    v_accvgpr_write_b32 a85, v227
    v_accvgpr_write_b32 a86, v228
    v_accvgpr_write_b32 a87, v229
    v_accvgpr_read_b32 v226, a100
    v_accvgpr_read_b32 v227, a101
    v_accvgpr_read_b32 v228, a102
    v_accvgpr_read_b32 v229, a103
    v_mul_f32 v226, v226, v225
    v_mul_f32 v227, v227, v225
    v_mul_f32 v228, v228, v225
    v_mul_f32 v229, v229, v225
    v_accvgpr_write_b32 a100, v226
    v_accvgpr_write_b32 a101, v227
    v_accvgpr_write_b32 a102, v228
    v_accvgpr_write_b32 a103, v229
    v_accvgpr_read_b32 v226, a116
    v_accvgpr_read_b32 v227, a117
    v_accvgpr_read_b32 v228, a118
    v_accvgpr_read_b32 v229, a119
    v_mul_f32 v226, v226, v225
    v_mul_f32 v227, v227, v225
    v_mul_f32 v228, v228, v225
    v_mul_f32 v229, v229, v225
    v_accvgpr_write_b32 a116, v226
    v_accvgpr_write_b32 a117, v227
    v_accvgpr_write_b32 a118, v228
    v_accvgpr_write_b32 a119, v229
    v_exp_f32 v226, v72
    v_exp_f32 v227, v73
    s_nop 0
    v_add_f32 v21, v226, v227
    v_cvt_pk_bf16_f32 v196, v226, v227
    v_exp_f32 v226, v74
    v_exp_f32 v227, v75
    s_nop 0
    v_add_f32 v21, v21, v226
    v_add_f32 v21, v21, v227
    v_cvt_pk_bf16_f32 v197, v226, v227
    v_exp_f32 v226, v76
    v_exp_f32 v227, v77
    s_nop 0
    v_add_f32 v21, v21, v226
    v_add_f32 v21, v21, v227
    v_cvt_pk_bf16_f32 v198, v226, v227
    v_exp_f32 v226, v78
    v_exp_f32 v227, v79
    s_nop 0
    v_add_f32 v21, v21, v226
    v_add_f32 v21, v21, v227
    v_cvt_pk_bf16_f32 v199, v226, v227
    v_max3_f32 v224, v80, v81, v82
    v_max3_f32 v224, v224, v83, v84
    v_max3_f32 v224, v224, v85, v86
    v_max_f32 v224, v224, v87
    v_mov_b32 v225, v224
    s_nop 1
    v_permlane16_swap_b32 v224, v225
    s_nop 1
    v_max_f32 v224, v224, v225
    v_mov_b32 v225, v224
    s_nop 1
    v_permlane32_swap_b32 v224, v225
    s_nop 1
    v_max_f32 v224, v224, v225
    v_max_f32 v224, 0, v224
    v_sub_f32 v225, 0, v224
    v_exp_f32 v225, v225
    v_sub_f32 v48, v48, v224
    v_sub_f32 v49, v49, v224
    v_sub_f32 v50, v50, v224
    v_sub_f32 v51, v51, v224
    v_sub_f32 v80, v80, v224
    v_sub_f32 v112, v112, v224
    v_sub_f32 v81, v81, v224
    v_sub_f32 v113, v113, v224
    v_sub_f32 v82, v82, v224
    v_sub_f32 v114, v114, v224
    v_sub_f32 v83, v83, v224
    v_sub_f32 v115, v115, v224
    v_sub_f32 v84, v84, v224
    v_sub_f32 v116, v116, v224
    v_sub_f32 v85, v85, v224
    v_sub_f32 v117, v117, v224
    v_sub_f32 v86, v86, v224
    v_sub_f32 v118, v118, v224
    v_sub_f32 v87, v87, v224
    v_sub_f32 v119, v119, v224
    v_mul_f32 v18, v18, v225
    v_accvgpr_read_b32 v226, a8
    v_accvgpr_read_b32 v227, a9
    v_accvgpr_read_b32 v228, a10
    v_accvgpr_read_b32 v229, a11
    v_mul_f32 v226, v226, v225
    v_mul_f32 v227, v227, v225
    v_mul_f32 v228, v228, v225
    v_mul_f32 v229, v229, v225
    v_accvgpr_write_b32 a8, v226
    v_accvgpr_write_b32 a9, v227
    v_accvgpr_write_b32 a10, v228
    v_accvgpr_write_b32 a11, v229
    v_accvgpr_read_b32 v226, a24
    v_accvgpr_read_b32 v227, a25
    v_accvgpr_read_b32 v228, a26
    v_accvgpr_read_b32 v229, a27
    v_mul_f32 v226, v226, v225
    v_mul_f32 v227, v227, v225
    v_mul_f32 v228, v228, v225
    v_mul_f32 v229, v229, v225
    v_accvgpr_write_b32 a24, v226
    v_accvgpr_write_b32 a25, v227
    v_accvgpr_write_b32 a26, v228
    v_accvgpr_write_b32 a27, v229
    v_accvgpr_read_b32 v226, a40
    v_accvgpr_read_b32 v227, a41
    v_accvgpr_read_b32 v228, a42
    v_accvgpr_read_b32 v229, a43
    v_mul_f32 v226, v226, v225
    v_mul_f32 v227, v227, v225
    v_mul_f32 v228, v228, v225
    v_mul_f32 v229, v229, v225
    v_accvgpr_write_b32 a40, v226
    v_accvgpr_write_b32 a41, v227
    v_accvgpr_write_b32 a42, v228
    v_accvgpr_write_b32 a43, v229
    v_accvgpr_read_b32 v226, a56
    v_accvgpr_read_b32 v227, a57
    v_accvgpr_read_b32 v228, a58
    v_accvgpr_read_b32 v229, a59
    v_mul_f32 v226, v226, v225
    v_mul_f32 v227, v227, v225
    v_mul_f32 v228, v228, v225
    v_mul_f32 v229, v229, v225
    v_accvgpr_write_b32 a56, v226
    v_accvgpr_write_b32 a57, v227
    v_accvgpr_write_b32 a58, v228
    v_accvgpr_write_b32 a59, v229
    v_accvgpr_read_b32 v226, a72
    v_accvgpr_read_b32 v227, a73
    v_accvgpr_read_b32 v228, a74
    v_accvgpr_read_b32 v229, a75
    v_mul_f32 v226, v226, v225
    v_mul_f32 v227, v227, v225
    v_mul_f32 v228, v228, v225
    v_mul_f32 v229, v229, v225
    v_accvgpr_write_b32 a72, v226
    v_accvgpr_write_b32 a73, v227
    v_accvgpr_write_b32 a74, v228
    v_accvgpr_write_b32 a75, v229
    v_accvgpr_read_b32 v226, a88
    v_accvgpr_read_b32 v227, a89
    v_accvgpr_read_b32 v228, a90
    v_accvgpr_read_b32 v229, a91
    v_mul_f32 v226, v226, v225
    v_mul_f32 v227, v227, v225
    v_mul_f32 v228, v228, v225
    v_mul_f32 v229, v229, v225
    v_accvgpr_write_b32 a88, v226
    v_accvgpr_write_b32 a89, v227
    v_accvgpr_write_b32 a90, v228
    v_accvgpr_write_b32 a91, v229
    v_accvgpr_read_b32 v226, a104
    v_accvgpr_read_b32 v227, a105
    v_accvgpr_read_b32 v228, a106
    v_accvgpr_read_b32 v229, a107
    v_mul_f32 v226, v226, v225
    v_mul_f32 v227, v227, v225
    v_mul_f32 v228, v228, v225
    v_mul_f32 v229, v229, v225
    v_accvgpr_write_b32 a104, v226
    v_accvgpr_write_b32 a105, v227
    v_accvgpr_write_b32 a106, v228
    v_accvgpr_write_b32 a107, v229
    v_accvgpr_read_b32 v226, a120
    v_accvgpr_read_b32 v227, a121
    v_accvgpr_read_b32 v228, a122
    v_accvgpr_read_b32 v229, a123
    v_mul_f32 v226, v226, v225
    v_mul_f32 v227, v227, v225
    v_mul_f32 v228, v228, v225
    v_mul_f32 v229, v229, v225
    v_accvgpr_write_b32 a120, v226
    v_accvgpr_write_b32 a121, v227
    v_accvgpr_write_b32 a122, v228
    v_accvgpr_write_b32 a123, v229
    v_exp_f32 v226, v80
    v_exp_f32 v227, v81
    s_nop 0
    v_add_f32 v22, v226, v227
    v_cvt_pk_bf16_f32 v200, v226, v227
    v_exp_f32 v226, v82
    v_exp_f32 v227, v83
    s_nop 0
    v_add_f32 v22, v22, v226
    v_add_f32 v22, v22, v227
    v_cvt_pk_bf16_f32 v201, v226, v227
    v_exp_f32 v226, v84
    v_exp_f32 v227, v85
    s_nop 0
    v_add_f32 v22, v22, v226
    v_add_f32 v22, v22, v227
    v_cvt_pk_bf16_f32 v202, v226, v227
    v_exp_f32 v226, v86
    v_exp_f32 v227, v87
    s_nop 0
    v_add_f32 v22, v22, v226
    v_add_f32 v22, v22, v227
    v_cvt_pk_bf16_f32 v203, v226, v227
    v_max3_f32 v224, v88, v89, v90
    v_max3_f32 v224, v224, v91, v92
    v_max3_f32 v224, v224, v93, v94
    v_max_f32 v224, v224, v95
    v_mov_b32 v225, v224
    s_nop 1
    v_permlane16_swap_b32 v224, v225
    s_nop 1
    v_max_f32 v224, v224, v225
    v_mov_b32 v225, v224
    s_nop 1
    v_permlane32_swap_b32 v224, v225
    s_nop 1
    v_max_f32 v224, v224, v225
    v_max_f32 v224, 0, v224
    v_sub_f32 v225, 0, v224
    v_exp_f32 v225, v225
    v_sub_f32 v52, v52, v224
    v_sub_f32 v53, v53, v224
    v_sub_f32 v54, v54, v224
    v_sub_f32 v55, v55, v224
    v_sub_f32 v88, v88, v224
    v_sub_f32 v120, v120, v224
    v_sub_f32 v89, v89, v224
    v_sub_f32 v121, v121, v224
    v_sub_f32 v90, v90, v224
    v_sub_f32 v122, v122, v224
    v_sub_f32 v91, v91, v224
    v_sub_f32 v123, v123, v224
    v_sub_f32 v92, v92, v224
    v_sub_f32 v124, v124, v224
    v_sub_f32 v93, v93, v224
    v_sub_f32 v125, v125, v224
    v_sub_f32 v94, v94, v224
    v_sub_f32 v126, v126, v224
    v_sub_f32 v95, v95, v224
    v_sub_f32 v127, v127, v224
    v_mul_f32 v19, v19, v225
    v_accvgpr_read_b32 v226, a12
    v_accvgpr_read_b32 v227, a13
    v_accvgpr_read_b32 v228, a14
    v_accvgpr_read_b32 v229, a15
    v_mul_f32 v226, v226, v225
    v_mul_f32 v227, v227, v225
    v_mul_f32 v228, v228, v225
    v_mul_f32 v229, v229, v225
    v_accvgpr_write_b32 a12, v226
    v_accvgpr_write_b32 a13, v227
    v_accvgpr_write_b32 a14, v228
    v_accvgpr_write_b32 a15, v229
    v_accvgpr_read_b32 v226, a28
    v_accvgpr_read_b32 v227, a29
    v_accvgpr_read_b32 v228, a30
    v_accvgpr_read_b32 v229, a31
    v_mul_f32 v226, v226, v225
    v_mul_f32 v227, v227, v225
    v_mul_f32 v228, v228, v225
    v_mul_f32 v229, v229, v225
    v_accvgpr_write_b32 a28, v226
    v_accvgpr_write_b32 a29, v227
    v_accvgpr_write_b32 a30, v228
    v_accvgpr_write_b32 a31, v229
    v_accvgpr_read_b32 v226, a44
    v_accvgpr_read_b32 v227, a45
    v_accvgpr_read_b32 v228, a46
    v_accvgpr_read_b32 v229, a47
    v_mul_f32 v226, v226, v225
    v_mul_f32 v227, v227, v225
    v_mul_f32 v228, v228, v225
    v_mul_f32 v229, v229, v225
    v_accvgpr_write_b32 a44, v226
    v_accvgpr_write_b32 a45, v227
    v_accvgpr_write_b32 a46, v228
    v_accvgpr_write_b32 a47, v229
    v_accvgpr_read_b32 v226, a60
    v_accvgpr_read_b32 v227, a61
    v_accvgpr_read_b32 v228, a62
    v_accvgpr_read_b32 v229, a63
    v_mul_f32 v226, v226, v225
    v_mul_f32 v227, v227, v225
    v_mul_f32 v228, v228, v225
    v_mul_f32 v229, v229, v225
    v_accvgpr_write_b32 a60, v226
    v_accvgpr_write_b32 a61, v227
    v_accvgpr_write_b32 a62, v228
    v_accvgpr_write_b32 a63, v229
    v_accvgpr_read_b32 v226, a76
    v_accvgpr_read_b32 v227, a77
    v_accvgpr_read_b32 v228, a78
    v_accvgpr_read_b32 v229, a79
    v_mul_f32 v226, v226, v225
    v_mul_f32 v227, v227, v225
    v_mul_f32 v228, v228, v225
    v_mul_f32 v229, v229, v225
    v_accvgpr_write_b32 a76, v226
    v_accvgpr_write_b32 a77, v227
    v_accvgpr_write_b32 a78, v228
    v_accvgpr_write_b32 a79, v229
    v_accvgpr_read_b32 v226, a92
    v_accvgpr_read_b32 v227, a93
    v_accvgpr_read_b32 v228, a94
    v_accvgpr_read_b32 v229, a95
    v_mul_f32 v226, v226, v225
    v_mul_f32 v227, v227, v225
    v_mul_f32 v228, v228, v225
    v_mul_f32 v229, v229, v225
    v_accvgpr_write_b32 a92, v226
    v_accvgpr_write_b32 a93, v227
    v_accvgpr_write_b32 a94, v228
    v_accvgpr_write_b32 a95, v229
    v_accvgpr_read_b32 v226, a108
    v_accvgpr_read_b32 v227, a109
    v_accvgpr_read_b32 v228, a110
    v_accvgpr_read_b32 v229, a111
    v_mul_f32 v226, v226, v225
    v_mul_f32 v227, v227, v225
    v_mul_f32 v228, v228, v225
    v_mul_f32 v229, v229, v225
    v_accvgpr_write_b32 a108, v226
    v_accvgpr_write_b32 a109, v227
    v_accvgpr_write_b32 a110, v228
    v_accvgpr_write_b32 a111, v229
    v_accvgpr_read_b32 v226, a124
    v_accvgpr_read_b32 v227, a125
    v_accvgpr_read_b32 v228, a126
    v_accvgpr_read_b32 v229, a127
    v_mul_f32 v226, v226, v225
    v_mul_f32 v227, v227, v225
    v_mul_f32 v228, v228, v225
    v_mul_f32 v229, v229, v225
    v_accvgpr_write_b32 a124, v226
    v_accvgpr_write_b32 a125, v227
    v_accvgpr_write_b32 a126, v228
    v_accvgpr_write_b32 a127, v229
    v_exp_f32 v226, v88
    v_exp_f32 v227, v89
    s_nop 0
    v_add_f32 v23, v226, v227
    v_cvt_pk_bf16_f32 v204, v226, v227
    v_exp_f32 v226, v90
    v_exp_f32 v227, v91
    s_nop 0
    v_add_f32 v23, v23, v226
    v_add_f32 v23, v23, v227
    v_cvt_pk_bf16_f32 v205, v226, v227
    v_exp_f32 v226, v92
    v_exp_f32 v227, v93
    s_nop 0
    v_add_f32 v23, v23, v226
    v_add_f32 v23, v23, v227
    v_cvt_pk_bf16_f32 v206, v226, v227
    v_exp_f32 v226, v94
    v_exp_f32 v227, v95
    s_nop 0
    v_add_f32 v23, v23, v226
    v_add_f32 v23, v23, v227
    v_cvt_pk_bf16_f32 v207, v226, v227
    s_nop 7
    s_setpc_b64 s[30:31]
rare_path_1:
    s_nop 15
    v_max3_f32 v224, v96, v97, v98
    v_max3_f32 v224, v224, v99, v100
    v_max3_f32 v224, v224, v101, v102
    v_max_f32 v224, v224, v103
    v_mov_b32 v225, v224
    s_nop 1
    v_permlane16_swap_b32 v224, v225
    s_nop 1
    v_max_f32 v224, v224, v225
    v_mov_b32 v225, v224
    s_nop 1
    v_permlane32_swap_b32 v224, v225
    s_nop 1
    v_max_f32 v224, v224, v225
    v_max_f32 v224, 0, v224
    v_sub_f32 v225, 0, v224
    v_exp_f32 v225, v225
    v_sub_f32 v40, v40, v224
    v_sub_f32 v41, v41, v224
    v_sub_f32 v42, v42, v224
    v_sub_f32 v43, v43, v224
    v_sub_f32 v96, v96, v224
    v_sub_f32 v64, v64, v224
    v_sub_f32 v97, v97, v224
    v_sub_f32 v65, v65, v224
    v_sub_f32 v98, v98, v224
    v_sub_f32 v66, v66, v224
    v_sub_f32 v99, v99, v224
    v_sub_f32 v67, v67, v224
    v_sub_f32 v100, v100, v224
    v_sub_f32 v68, v68, v224
    v_sub_f32 v101, v101, v224
    v_sub_f32 v69, v69, v224
    v_sub_f32 v102, v102, v224
    v_sub_f32 v70, v70, v224
    v_sub_f32 v103, v103, v224
    v_sub_f32 v71, v71, v224
    v_mul_f32 v16, v16, v225
    v_accvgpr_read_b32 v226, a0
    v_accvgpr_read_b32 v227, a1
    v_accvgpr_read_b32 v228, a2
    v_accvgpr_read_b32 v229, a3
    v_mul_f32 v226, v226, v225
    v_mul_f32 v227, v227, v225
    v_mul_f32 v228, v228, v225
    v_mul_f32 v229, v229, v225
    v_accvgpr_write_b32 a0, v226
    v_accvgpr_write_b32 a1, v227
    v_accvgpr_write_b32 a2, v228
    v_accvgpr_write_b32 a3, v229
    v_accvgpr_read_b32 v226, a16
    v_accvgpr_read_b32 v227, a17
    v_accvgpr_read_b32 v228, a18
    v_accvgpr_read_b32 v229, a19
    v_mul_f32 v226, v226, v225
    v_mul_f32 v227, v227, v225
    v_mul_f32 v228, v228, v225
    v_mul_f32 v229, v229, v225
    v_accvgpr_write_b32 a16, v226
    v_accvgpr_write_b32 a17, v227
    v_accvgpr_write_b32 a18, v228
    v_accvgpr_write_b32 a19, v229
    v_accvgpr_read_b32 v226, a32
    v_accvgpr_read_b32 v227, a33
    v_accvgpr_read_b32 v228, a34
    v_accvgpr_read_b32 v229, a35
    v_mul_f32 v226, v226, v225
    v_mul_f32 v227, v227, v225
    v_mul_f32 v228, v228, v225
    v_mul_f32 v229, v229, v225
    v_accvgpr_write_b32 a32, v226
    v_accvgpr_write_b32 a33, v227
    v_accvgpr_write_b32 a34, v228
    v_accvgpr_write_b32 a35, v229
    v_accvgpr_read_b32 v226, a48
    v_accvgpr_read_b32 v227, a49
    v_accvgpr_read_b32 v228, a50
    v_accvgpr_read_b32 v229, a51
    v_mul_f32 v226, v226, v225
    v_mul_f32 v227, v227, v225
    v_mul_f32 v228, v228, v225
    v_mul_f32 v229, v229, v225
    v_accvgpr_write_b32 a48, v226
    v_accvgpr_write_b32 a49, v227
    v_accvgpr_write_b32 a50, v228
    v_accvgpr_write_b32 a51, v229
    v_accvgpr_read_b32 v226, a64
    v_accvgpr_read_b32 v227, a65
    v_accvgpr_read_b32 v228, a66
    v_accvgpr_read_b32 v229, a67
    v_mul_f32 v226, v226, v225
    v_mul_f32 v227, v227, v225
    v_mul_f32 v228, v228, v225
    v_mul_f32 v229, v229, v225
    v_accvgpr_write_b32 a64, v226
    v_accvgpr_write_b32 a65, v227
    v_accvgpr_write_b32 a66, v228
    v_accvgpr_write_b32 a67, v229
    v_accvgpr_read_b32 v226, a80
    v_accvgpr_read_b32 v227, a81
    v_accvgpr_read_b32 v228, a82
    v_accvgpr_read_b32 v229, a83
    v_mul_f32 v226, v226, v225
    v_mul_f32 v227, v227, v225
    v_mul_f32 v228, v228, v225
    v_mul_f32 v229, v229, v225
    v_accvgpr_write_b32 a80, v226
    v_accvgpr_write_b32 a81, v227
    v_accvgpr_write_b32 a82, v228
    v_accvgpr_write_b32 a83, v229
    v_accvgpr_read_b32 v226, a96
    v_accvgpr_read_b32 v227, a97
    v_accvgpr_read_b32 v228, a98
    v_accvgpr_read_b32 v229, a99
    v_mul_f32 v226, v226, v225
    v_mul_f32 v227, v227, v225
    v_mul_f32 v228, v228, v225
    v_mul_f32 v229, v229, v225
    v_accvgpr_write_b32 a96, v226
    v_accvgpr_write_b32 a97, v227
    v_accvgpr_write_b32 a98, v228
    v_accvgpr_write_b32 a99, v229
    v_accvgpr_read_b32 v226, a112
    v_accvgpr_read_b32 v227, a113
    v_accvgpr_read_b32 v228, a114
    v_accvgpr_read_b32 v229, a115
    v_mul_f32 v226, v226, v225
    v_mul_f32 v227, v227, v225
    v_mul_f32 v228, v228, v225
    v_mul_f32 v229, v229, v225
    v_accvgpr_write_b32 a112, v226
    v_accvgpr_write_b32 a113, v227
    v_accvgpr_write_b32 a114, v228
    v_accvgpr_write_b32 a115, v229
    v_exp_f32 v226, v96
    v_exp_f32 v227, v97
    s_nop 0
    v_add_f32 v20, v226, v227
    v_cvt_pk_bf16_f32 v208, v226, v227
    v_exp_f32 v226, v98
    v_exp_f32 v227, v99
    s_nop 0
    v_add_f32 v20, v20, v226
    v_add_f32 v20, v20, v227
    v_cvt_pk_bf16_f32 v209, v226, v227
    v_exp_f32 v226, v100
    v_exp_f32 v227, v101
    s_nop 0
    v_add_f32 v20, v20, v226
    v_add_f32 v20, v20, v227
    v_cvt_pk_bf16_f32 v210, v226, v227
    v_exp_f32 v226, v102
    v_exp_f32 v227, v103
    s_nop 0
    v_add_f32 v20, v20, v226
    v_add_f32 v20, v20, v227
    v_cvt_pk_bf16_f32 v211, v226, v227
    v_max3_f32 v224, v104, v105, v106
    v_max3_f32 v224, v224, v107, v108
    v_max3_f32 v224, v224, v109, v110
    v_max_f32 v224, v224, v111
    v_mov_b32 v225, v224
    s_nop 1
    v_permlane16_swap_b32 v224, v225
    s_nop 1
    v_max_f32 v224, v224, v225
    v_mov_b32 v225, v224
    s_nop 1
    v_permlane32_swap_b32 v224, v225
    s_nop 1
    v_max_f32 v224, v224, v225
    v_max_f32 v224, 0, v224
    v_sub_f32 v225, 0, v224
    v_exp_f32 v225, v225
    v_sub_f32 v44, v44, v224
    v_sub_f32 v45, v45, v224
    v_sub_f32 v46, v46, v224
    v_sub_f32 v47, v47, v224
    v_sub_f32 v104, v104, v224
    v_sub_f32 v72, v72, v224
    v_sub_f32 v105, v105, v224
    v_sub_f32 v73, v73, v224
    v_sub_f32 v106, v106, v224
    v_sub_f32 v74, v74, v224
    v_sub_f32 v107, v107, v224
    v_sub_f32 v75, v75, v224
    v_sub_f32 v108, v108, v224
    v_sub_f32 v76, v76, v224
    v_sub_f32 v109, v109, v224
    v_sub_f32 v77, v77, v224
    v_sub_f32 v110, v110, v224
    v_sub_f32 v78, v78, v224
    v_sub_f32 v111, v111, v224
    v_sub_f32 v79, v79, v224
    v_mul_f32 v17, v17, v225
    v_accvgpr_read_b32 v226, a4
    v_accvgpr_read_b32 v227, a5
    v_accvgpr_read_b32 v228, a6
    v_accvgpr_read_b32 v229, a7
    v_mul_f32 v226, v226, v225
    v_mul_f32 v227, v227, v225
    v_mul_f32 v228, v228, v225
    v_mul_f32 v229, v229, v225
    v_accvgpr_write_b32 a4, v226
    v_accvgpr_write_b32 a5, v227
    v_accvgpr_write_b32 a6, v228
    v_accvgpr_write_b32 a7, v229
    v_accvgpr_read_b32 v226, a20
    v_accvgpr_read_b32 v227, a21
    v_accvgpr_read_b32 v228, a22
    v_accvgpr_read_b32 v229, a23
    v_mul_f32 v226, v226, v225
    v_mul_f32 v227, v227, v225
    v_mul_f32 v228, v228, v225
    v_mul_f32 v229, v229, v225
    v_accvgpr_write_b32 a20, v226
    v_accvgpr_write_b32 a21, v227
    v_accvgpr_write_b32 a22, v228
    v_accvgpr_write_b32 a23, v229
    v_accvgpr_read_b32 v226, a36
    v_accvgpr_read_b32 v227, a37
    v_accvgpr_read_b32 v228, a38
    v_accvgpr_read_b32 v229, a39
    v_mul_f32 v226, v226, v225
    v_mul_f32 v227, v227, v225
    v_mul_f32 v228, v228, v225
    v_mul_f32 v229, v229, v225
    v_accvgpr_write_b32 a36, v226
    v_accvgpr_write_b32 a37, v227
    v_accvgpr_write_b32 a38, v228
    v_accvgpr_write_b32 a39, v229
    v_accvgpr_read_b32 v226, a52
    v_accvgpr_read_b32 v227, a53
    v_accvgpr_read_b32 v228, a54
    v_accvgpr_read_b32 v229, a55
    v_mul_f32 v226, v226, v225
    v_mul_f32 v227, v227, v225
    v_mul_f32 v228, v228, v225
    v_mul_f32 v229, v229, v225
    v_accvgpr_write_b32 a52, v226
    v_accvgpr_write_b32 a53, v227
    v_accvgpr_write_b32 a54, v228
    v_accvgpr_write_b32 a55, v229
    v_accvgpr_read_b32 v226, a68
    v_accvgpr_read_b32 v227, a69
    v_accvgpr_read_b32 v228, a70
    v_accvgpr_read_b32 v229, a71
    v_mul_f32 v226, v226, v225
    v_mul_f32 v227, v227, v225
    v_mul_f32 v228, v228, v225
    v_mul_f32 v229, v229, v225
    v_accvgpr_write_b32 a68, v226
    v_accvgpr_write_b32 a69, v227
    v_accvgpr_write_b32 a70, v228
    v_accvgpr_write_b32 a71, v229
    v_accvgpr_read_b32 v226, a84
    v_accvgpr_read_b32 v227, a85
    v_accvgpr_read_b32 v228, a86
    v_accvgpr_read_b32 v229, a87
    v_mul_f32 v226, v226, v225
    v_mul_f32 v227, v227, v225
    v_mul_f32 v228, v228, v225
    v_mul_f32 v229, v229, v225
    v_accvgpr_write_b32 a84, v226
    v_accvgpr_write_b32 a85, v227
    v_accvgpr_write_b32 a86, v228
    v_accvgpr_write_b32 a87, v229
    v_accvgpr_read_b32 v226, a100
    v_accvgpr_read_b32 v227, a101
    v_accvgpr_read_b32 v228, a102
    v_accvgpr_read_b32 v229, a103
    v_mul_f32 v226, v226, v225
    v_mul_f32 v227, v227, v225
    v_mul_f32 v228, v228, v225
    v_mul_f32 v229, v229, v225
    v_accvgpr_write_b32 a100, v226
    v_accvgpr_write_b32 a101, v227
    v_accvgpr_write_b32 a102, v228
    v_accvgpr_write_b32 a103, v229
    v_accvgpr_read_b32 v226, a116
    v_accvgpr_read_b32 v227, a117
    v_accvgpr_read_b32 v228, a118
    v_accvgpr_read_b32 v229, a119
    v_mul_f32 v226, v226, v225
    v_mul_f32 v227, v227, v225
    v_mul_f32 v228, v228, v225
    v_mul_f32 v229, v229, v225
    v_accvgpr_write_b32 a116, v226
    v_accvgpr_write_b32 a117, v227
    v_accvgpr_write_b32 a118, v228
    v_accvgpr_write_b32 a119, v229
    v_exp_f32 v226, v104
    v_exp_f32 v227, v105
    s_nop 0
    v_add_f32 v21, v226, v227
    v_cvt_pk_bf16_f32 v212, v226, v227
    v_exp_f32 v226, v106
    v_exp_f32 v227, v107
    s_nop 0
    v_add_f32 v21, v21, v226
    v_add_f32 v21, v21, v227
    v_cvt_pk_bf16_f32 v213, v226, v227
    v_exp_f32 v226, v108
    v_exp_f32 v227, v109
    s_nop 0
    v_add_f32 v21, v21, v226
    v_add_f32 v21, v21, v227
    v_cvt_pk_bf16_f32 v214, v226, v227
    v_exp_f32 v226, v110
    v_exp_f32 v227, v111
    s_nop 0
    v_add_f32 v21, v21, v226
    v_add_f32 v21, v21, v227
    v_cvt_pk_bf16_f32 v215, v226, v227
    v_max3_f32 v224, v112, v113, v114
    v_max3_f32 v224, v224, v115, v116
    v_max3_f32 v224, v224, v117, v118
    v_max_f32 v224, v224, v119
    v_mov_b32 v225, v224
    s_nop 1
    v_permlane16_swap_b32 v224, v225
    s_nop 1
    v_max_f32 v224, v224, v225
    v_mov_b32 v225, v224
    s_nop 1
    v_permlane32_swap_b32 v224, v225
    s_nop 1
    v_max_f32 v224, v224, v225
    v_max_f32 v224, 0, v224
    v_sub_f32 v225, 0, v224
    v_exp_f32 v225, v225
    v_sub_f32 v48, v48, v224
    v_sub_f32 v49, v49, v224
    v_sub_f32 v50, v50, v224
    v_sub_f32 v51, v51, v224
    v_sub_f32 v112, v112, v224
    v_sub_f32 v80, v80, v224
    v_sub_f32 v113, v113, v224
    v_sub_f32 v81, v81, v224
    v_sub_f32 v114, v114, v224
    v_sub_f32 v82, v82, v224
    v_sub_f32 v115, v115, v224
    v_sub_f32 v83, v83, v224
    v_sub_f32 v116, v116, v224
    v_sub_f32 v84, v84, v224
    v_sub_f32 v117, v117, v224
    v_sub_f32 v85, v85, v224
    v_sub_f32 v118, v118, v224
    v_sub_f32 v86, v86, v224
    v_sub_f32 v119, v119, v224
    v_sub_f32 v87, v87, v224
    v_mul_f32 v18, v18, v225
    v_accvgpr_read_b32 v226, a8
    v_accvgpr_read_b32 v227, a9
    v_accvgpr_read_b32 v228, a10
    v_accvgpr_read_b32 v229, a11
    v_mul_f32 v226, v226, v225
    v_mul_f32 v227, v227, v225
    v_mul_f32 v228, v228, v225
    v_mul_f32 v229, v229, v225
    v_accvgpr_write_b32 a8, v226
    v_accvgpr_write_b32 a9, v227
    v_accvgpr_write_b32 a10, v228
    v_accvgpr_write_b32 a11, v229
    v_accvgpr_read_b32 v226, a24
    v_accvgpr_read_b32 v227, a25
    v_accvgpr_read_b32 v228, a26
    v_accvgpr_read_b32 v229, a27
    v_mul_f32 v226, v226, v225
    v_mul_f32 v227, v227, v225
    v_mul_f32 v228, v228, v225
    v_mul_f32 v229, v229, v225
    v_accvgpr_write_b32 a24, v226
    v_accvgpr_write_b32 a25, v227
    v_accvgpr_write_b32 a26, v228
    v_accvgpr_write_b32 a27, v229
    v_accvgpr_read_b32 v226, a40
    v_accvgpr_read_b32 v227, a41
    v_accvgpr_read_b32 v228, a42
    v_accvgpr_read_b32 v229, a43
    v_mul_f32 v226, v226, v225
    v_mul_f32 v227, v227, v225
    v_mul_f32 v228, v228, v225
    v_mul_f32 v229, v229, v225
    v_accvgpr_write_b32 a40, v226
    v_accvgpr_write_b32 a41, v227
    v_accvgpr_write_b32 a42, v228
    v_accvgpr_write_b32 a43, v229
    v_accvgpr_read_b32 v226, a56
    v_accvgpr_read_b32 v227, a57
    v_accvgpr_read_b32 v228, a58
    v_accvgpr_read_b32 v229, a59
    v_mul_f32 v226, v226, v225
    v_mul_f32 v227, v227, v225
    v_mul_f32 v228, v228, v225
    v_mul_f32 v229, v229, v225
    v_accvgpr_write_b32 a56, v226
    v_accvgpr_write_b32 a57, v227
    v_accvgpr_write_b32 a58, v228
    v_accvgpr_write_b32 a59, v229
    v_accvgpr_read_b32 v226, a72
    v_accvgpr_read_b32 v227, a73
    v_accvgpr_read_b32 v228, a74
    v_accvgpr_read_b32 v229, a75
    v_mul_f32 v226, v226, v225
    v_mul_f32 v227, v227, v225
    v_mul_f32 v228, v228, v225
    v_mul_f32 v229, v229, v225
    v_accvgpr_write_b32 a72, v226
    v_accvgpr_write_b32 a73, v227
    v_accvgpr_write_b32 a74, v228
    v_accvgpr_write_b32 a75, v229
    v_accvgpr_read_b32 v226, a88
    v_accvgpr_read_b32 v227, a89
    v_accvgpr_read_b32 v228, a90
    v_accvgpr_read_b32 v229, a91
    v_mul_f32 v226, v226, v225
    v_mul_f32 v227, v227, v225
    v_mul_f32 v228, v228, v225
    v_mul_f32 v229, v229, v225
    v_accvgpr_write_b32 a88, v226
    v_accvgpr_write_b32 a89, v227
    v_accvgpr_write_b32 a90, v228
    v_accvgpr_write_b32 a91, v229
    v_accvgpr_read_b32 v226, a104
    v_accvgpr_read_b32 v227, a105
    v_accvgpr_read_b32 v228, a106
    v_accvgpr_read_b32 v229, a107
    v_mul_f32 v226, v226, v225
    v_mul_f32 v227, v227, v225
    v_mul_f32 v228, v228, v225
    v_mul_f32 v229, v229, v225
    v_accvgpr_write_b32 a104, v226
    v_accvgpr_write_b32 a105, v227
    v_accvgpr_write_b32 a106, v228
    v_accvgpr_write_b32 a107, v229
    v_accvgpr_read_b32 v226, a120
    v_accvgpr_read_b32 v227, a121
    v_accvgpr_read_b32 v228, a122
    v_accvgpr_read_b32 v229, a123
    v_mul_f32 v226, v226, v225
    v_mul_f32 v227, v227, v225
    v_mul_f32 v228, v228, v225
    v_mul_f32 v229, v229, v225
    v_accvgpr_write_b32 a120, v226
    v_accvgpr_write_b32 a121, v227
    v_accvgpr_write_b32 a122, v228
    v_accvgpr_write_b32 a123, v229
    v_exp_f32 v226, v112
    v_exp_f32 v227, v113
    s_nop 0
    v_add_f32 v22, v226, v227
    v_cvt_pk_bf16_f32 v216, v226, v227
    v_exp_f32 v226, v114
    v_exp_f32 v227, v115
    s_nop 0
    v_add_f32 v22, v22, v226
    v_add_f32 v22, v22, v227
    v_cvt_pk_bf16_f32 v217, v226, v227
    v_exp_f32 v226, v116
    v_exp_f32 v227, v117
    s_nop 0
    v_add_f32 v22, v22, v226
    v_add_f32 v22, v22, v227
    v_cvt_pk_bf16_f32 v218, v226, v227
    v_exp_f32 v226, v118
    v_exp_f32 v227, v119
    s_nop 0
    v_add_f32 v22, v22, v226
    v_add_f32 v22, v22, v227
    v_cvt_pk_bf16_f32 v219, v226, v227
    v_max3_f32 v224, v120, v121, v122
    v_max3_f32 v224, v224, v123, v124
    v_max3_f32 v224, v224, v125, v126
    v_max_f32 v224, v224, v127
    v_mov_b32 v225, v224
    s_nop 1
    v_permlane16_swap_b32 v224, v225
    s_nop 1
    v_max_f32 v224, v224, v225
    v_mov_b32 v225, v224
    s_nop 1
    v_permlane32_swap_b32 v224, v225
    s_nop 1
    v_max_f32 v224, v224, v225
    v_max_f32 v224, 0, v224
    v_sub_f32 v225, 0, v224
    v_exp_f32 v225, v225
    v_sub_f32 v52, v52, v224
    v_sub_f32 v53, v53, v224
    v_sub_f32 v54, v54, v224
    v_sub_f32 v55, v55, v224
    v_sub_f32 v120, v120, v224
    v_sub_f32 v88, v88, v224
    v_sub_f32 v121, v121, v224
    v_sub_f32 v89, v89, v224
    v_sub_f32 v122, v122, v224
    v_sub_f32 v90, v90, v224
    v_sub_f32 v123, v123, v224
    v_sub_f32 v91, v91, v224
    v_sub_f32 v124, v124, v224
    v_sub_f32 v92, v92, v224
    v_sub_f32 v125, v125, v224
    v_sub_f32 v93, v93, v224
    v_sub_f32 v126, v126, v224
    v_sub_f32 v94, v94, v224
    v_sub_f32 v127, v127, v224
    v_sub_f32 v95, v95, v224
    v_mul_f32 v19, v19, v225
    v_accvgpr_read_b32 v226, a12
    v_accvgpr_read_b32 v227, a13
    v_accvgpr_read_b32 v228, a14
    v_accvgpr_read_b32 v229, a15
    v_mul_f32 v226, v226, v225
    v_mul_f32 v227, v227, v225
    v_mul_f32 v228, v228, v225
    v_mul_f32 v229, v229, v225
    v_accvgpr_write_b32 a12, v226
    v_accvgpr_write_b32 a13, v227
    v_accvgpr_write_b32 a14, v228
    v_accvgpr_write_b32 a15, v229
    v_accvgpr_read_b32 v226, a28
    v_accvgpr_read_b32 v227, a29
    v_accvgpr_read_b32 v228, a30
    v_accvgpr_read_b32 v229, a31
    v_mul_f32 v226, v226, v225
    v_mul_f32 v227, v227, v225
    v_mul_f32 v228, v228, v225
    v_mul_f32 v229, v229, v225
    v_accvgpr_write_b32 a28, v226
    v_accvgpr_write_b32 a29, v227
    v_accvgpr_write_b32 a30, v228
    v_accvgpr_write_b32 a31, v229
    v_accvgpr_read_b32 v226, a44
    v_accvgpr_read_b32 v227, a45
    v_accvgpr_read_b32 v228, a46
    v_accvgpr_read_b32 v229, a47
    v_mul_f32 v226, v226, v225
    v_mul_f32 v227, v227, v225
    v_mul_f32 v228, v228, v225
    v_mul_f32 v229, v229, v225
    v_accvgpr_write_b32 a44, v226
    v_accvgpr_write_b32 a45, v227
    v_accvgpr_write_b32 a46, v228
    v_accvgpr_write_b32 a47, v229
    v_accvgpr_read_b32 v226, a60
    v_accvgpr_read_b32 v227, a61
    v_accvgpr_read_b32 v228, a62
    v_accvgpr_read_b32 v229, a63
    v_mul_f32 v226, v226, v225
    v_mul_f32 v227, v227, v225
    v_mul_f32 v228, v228, v225
    v_mul_f32 v229, v229, v225
    v_accvgpr_write_b32 a60, v226
    v_accvgpr_write_b32 a61, v227
    v_accvgpr_write_b32 a62, v228
    v_accvgpr_write_b32 a63, v229
    v_accvgpr_read_b32 v226, a76
    v_accvgpr_read_b32 v227, a77
    v_accvgpr_read_b32 v228, a78
    v_accvgpr_read_b32 v229, a79
    v_mul_f32 v226, v226, v225
    v_mul_f32 v227, v227, v225
    v_mul_f32 v228, v228, v225
    v_mul_f32 v229, v229, v225
    v_accvgpr_write_b32 a76, v226
    v_accvgpr_write_b32 a77, v227
    v_accvgpr_write_b32 a78, v228
    v_accvgpr_write_b32 a79, v229
    v_accvgpr_read_b32 v226, a92
    v_accvgpr_read_b32 v227, a93
    v_accvgpr_read_b32 v228, a94
    v_accvgpr_read_b32 v229, a95
    v_mul_f32 v226, v226, v225
    v_mul_f32 v227, v227, v225
    v_mul_f32 v228, v228, v225
    v_mul_f32 v229, v229, v225
    v_accvgpr_write_b32 a92, v226
    v_accvgpr_write_b32 a93, v227
    v_accvgpr_write_b32 a94, v228
    v_accvgpr_write_b32 a95, v229
    v_accvgpr_read_b32 v226, a108
    v_accvgpr_read_b32 v227, a109
    v_accvgpr_read_b32 v228, a110
    v_accvgpr_read_b32 v229, a111
    v_mul_f32 v226, v226, v225
    v_mul_f32 v227, v227, v225
    v_mul_f32 v228, v228, v225
    v_mul_f32 v229, v229, v225
    v_accvgpr_write_b32 a108, v226
    v_accvgpr_write_b32 a109, v227
    v_accvgpr_write_b32 a110, v228
    v_accvgpr_write_b32 a111, v229
    v_accvgpr_read_b32 v226, a124
    v_accvgpr_read_b32 v227, a125
    v_accvgpr_read_b32 v228, a126
    v_accvgpr_read_b32 v229, a127
    v_mul_f32 v226, v226, v225
    v_mul_f32 v227, v227, v225
    v_mul_f32 v228, v228, v225
    v_mul_f32 v229, v229, v225
    v_accvgpr_write_b32 a124, v226
    v_accvgpr_write_b32 a125, v227
    v_accvgpr_write_b32 a126, v228
    v_accvgpr_write_b32 a127, v229
    v_exp_f32 v226, v120
    v_exp_f32 v227, v121
    s_nop 0
    v_add_f32 v23, v226, v227
    v_cvt_pk_bf16_f32 v220, v226, v227
    v_exp_f32 v226, v122
    v_exp_f32 v227, v123
    s_nop 0
    v_add_f32 v23, v23, v226
    v_add_f32 v23, v23, v227
    v_cvt_pk_bf16_f32 v221, v226, v227
    v_exp_f32 v226, v124
    v_exp_f32 v227, v125
    s_nop 0
    v_add_f32 v23, v23, v226
    v_add_f32 v23, v23, v227
    v_cvt_pk_bf16_f32 v222, v226, v227
    v_exp_f32 v226, v126
    v_exp_f32 v227, v127
    s_nop 0
    v_add_f32 v23, v23, v226
    v_add_f32 v23, v23, v227
    v_cvt_pk_bf16_f32 v223, v226, v227
    s_nop 7
    s_setpc_b64 s[30:31]
    s_endpgm
code_end:
.section .rodata,"a"
.p2align 6
.amdhsa_kernel recurrent_scan__mha_block_cached__dense_activation_relu__prompt_kernel
  .amdhsa_next_free_vgpr 512
  .amdhsa_next_free_sgpr 102
  .amdhsa_accum_offset 256
  .amdhsa_group_segment_fixed_size 0
  .amdhsa_kernarg_size 88
  .amdhsa_user_sgpr_count 2
  .amdhsa_user_sgpr_kernarg_segment_ptr 1
  .amdhsa_system_sgpr_workgroup_id_x 1
  .amdhsa_float_denorm_mode_32 3
.end_amdhsa_kernel
```
